```python
import torch

def _softmax(x, axis=-1):
    return torch.softmax(x, dim=axis)
def _gelu(x):
    return torch.nn.functional.gelu(x, approximate="tanh")
def _silu(x):
    return torch.nn.functional.silu(x)
def _sigmoid(x):
    return torch.sigmoid(x)
def _layernorm(x, axis=-1, eps=1e-5):
    m = x.mean(dim=axis, keepdim=True)
    v = x.var(dim=axis, keepdim=True, unbiased=False)
    return (x - m) / torch.sqrt(v + eps)
def _scatter_add(tgt, idx, src, axis=0):
    return tgt.clone().index_add_(axis, idx, src)
def _segment_sum(src, seg, n):
    out = torch.zeros((n,) + src.shape[1:], dtype=src.dtype)
    return out.index_add_(0, seg, src)
def _pad(x, pw):
    flat = tuple(v for pair in reversed(pw) for v in pair)
    return torch.nn.functional.pad(x, flat)

kernel_name = 'sequential_preLN__softmax_full_mha__glu_gated_glu__prompt'

def setup_inputs():

    _w = (lambda a: (lambda t: t.to(torch.bfloat16) if t.is_floating_point() else t)(torch.as_tensor(a)))
    def _A_setup():
        B, S, D = 1, 2048, 1024
        return {
            "x": _w((lambda *s: torch.randn(*s, dtype=torch.bfloat16) * 0.05)(B, S, D)),
            "wqkv": _w((lambda *s: torch.randn(*s, dtype=torch.bfloat16) * 0.05)(D, 3 * D)),
            "wo": _w((lambda *s: torch.randn(*s, dtype=torch.bfloat16) * 0.05)(D, D)),
        }
    _A_in = _A_setup()

    def _B_setup():
        B, S, D, F = 1, 2048, 1024, 3584
        return {
            "x": _w((lambda *s: torch.randn(*s, dtype=torch.bfloat16) * 0.05)(B, S, D)),
            "w_gate": _w((lambda *s: torch.randn(*s, dtype=torch.bfloat16) * 0.05)(D, F)),
            "w_up": _w((lambda *s: torch.randn(*s, dtype=torch.bfloat16) * 0.05)(D, F)),
            "w_down": _w((lambda *s: torch.randn(*s, dtype=torch.bfloat16) * 0.05)(F, D)),
        }
    _B_in = _B_setup()

    return {
        "A_x": _A_in["x"],
        "A_wqkv": _A_in["wqkv"],
        "A_wo": _A_in["wo"],
        "B_x": _B_in["x"],
        "B_w_gate": _B_in["w_gate"],
        "B_w_up": _B_in["w_up"],
        "B_w_down": _B_in["w_down"],
    }

def reference(A_x, A_wqkv, A_wo, B_x, B_w_gate, B_w_up, B_w_down):
    def _A_ref(x, wqkv, wo):
        B, S, D = x.shape
        H = 32; Dh = D // H
        qkv = (lambda x, *d: x.permute(*d))((x @ wqkv).reshape(B, S, 3, H, Dh), 2, 0, 3, 1, 4)
        q, k, v = qkv[0], qkv[1], qkv[2]
        scale = Dh ** -0.5
        scores = torch.einsum("bhqd,bhkd->bhqk", q, k) * scale
        p = _softmax(scores, axis=-1)
        o = torch.einsum("bhqk,bhkd->bhqd", p, v)
        return (lambda x, *d: x.permute(*d))(o, 0, 2, 1, 3).reshape(B, S, D) @ wo

    def _B_ref(x, w_gate, w_up, w_down):
        g = torch.einsum("bsd,df->bsf", x, w_gate)
        u = torch.einsum("bsd,df->bsf", x, w_up)
        h = _sigmoid(g) * u
        return torch.einsum("bsf,fd->bsd", h, w_down)

    x = A_x
    h = x + _A_ref(_layernorm(x, axis=-1), A_wqkv, A_wo)
    h2 = h + _B_ref(_layernorm(h, axis=-1), B_w_gate, B_w_up, B_w_down)
    return h2
```

```asm
; @launch kernel=qkv_kernel grid=(256,1,1) block=(768,1,1) lds=163840
; @launch kernel=attn_kernel grid=(256,1,1) block=(512,1,1) lds=131072
; @launch kernel=mlp_kernel grid=(256,1,1) block=(256,1,1) lds=163840
.amdgcn_target "amdgcn-amd-amdhsa--gfx950"
.text
.p2align 8
.globl qkv_kernel
.type qkv_kernel,@function
qkv_kernel:
    s_cmp_lt_u32 s2, 256
    s_cbranch_scc1 go_qkv_kernel_1
    s_endpgm
go_qkv_kernel_1:
    s_load_dwordx4 s[4:7], s[0:1], 0
    s_load_dwordx2 s[36:37], s[0:1], 72
    v_lshrrev_b32 v136, 6, v0
    s_nop 0
    v_readfirstlane_b32 s16, v136
    v_and_b32 v136, 63, v0
    s_and_b32 s17, s2, 1
    s_lshl_b32 s17, s17, 3
    s_bfe_u32 s18, s2, 0x30003
    s_add_u32 s17, s17, s18
    s_bfe_u32 s18, s2, 0x20001
    s_lshl_b32 s18, s18, 2
    s_lshr_b32 s19, s2, 6
    s_add_u32 s18, s18, s19
    s_cmp_lt_u32 s16, 4
    s_cbranch_scc1 main_qkv_kernel_2
    s_cmp_ge_u32 s16, 8
    s_cbranch_scc1 stat_qkv_kernel_3
    s_sub_u32 s16, s16, 4
    s_lshl_b32 s22, s17, 2
    s_add_u32 s22, s22, s16
    s_lshl_b32 s22, s22, 16
    v_lshrrev_b32 v1, 3, v136
    v_and_b32 v2, 7, v136
    v_lshrrev_b32 v3, 4, v136
    v_xor_b32 v3, v2, v3
    v_lshlrev_b32 v4, 11, v1
    v_lshl_add_u32 v4, v3, 4, v4
    v_add_u32 v8, s22, v4
    v_xor_b32 v4, 64, v8
    v_add_u32 v9, 0x4000, v4
    v_add_u32 v10, 0x8000, v8
    v_add_u32 v11, 0xc000, v4
    v_bfe_u32 v3, v136, 4, 1
    v_lshlrev_b32 v3, 2, v3
    v_xor_b32 v2, v2, v3
    v_mul_u32_u24 v1, 6144, v1
    v_lshl_add_u32 v1, v2, 4, v1
    s_mul_i32 s22, s16, 98304
    s_lshl_b32 s23, s18, 7
    s_add_u32 s22, s22, s23
    v_add_u32 v1, s22, v1
    v_add_u32 v12, 0, v1
    v_add_u32 v13, 2048, v1
    v_add_u32 v14, 4096, v1
    v_add_u32 v15, 49152, v1
    v_add_u32 v16, 51200, v1
    v_add_u32 v17, 53248, v1
    s_lshl_b32 s24, s16, 12
    s_mul_i32 s25, s16, 6144
    s_add_u32 s25, s25, 16384
    s_mov_b32 s26, 0
    s_mov_b32 s27, 0
    s_waitcnt lgkmcnt(0)
    s_mov_b32 s8, s4
    s_and_b32 s9, s5, 0xffff
    s_mov_b32 s10, 4194304
    s_mov_b32 s11, 0x00020000
    s_mov_b32 s12, s6
    s_and_b32 s13, s7, 0xffff
    s_mov_b32 s14, 6291456
    s_mov_b32 s15, 0x00020000
    s_add_u32 m0, s24, 0
    s_nop 0
    buffer_load_dwordx4 v8, s[8:11], s26 offen lds
    s_add_u32 m0, s24, 1024
    s_nop 0
    buffer_load_dwordx4 v9, s[8:11], s26 offen lds
    s_add_u32 m0, s24, 2048
    s_nop 0
    buffer_load_dwordx4 v10, s[8:11], s26 offen lds
    s_add_u32 m0, s24, 3072
    s_nop 0
    buffer_load_dwordx4 v11, s[8:11], s26 offen lds
    s_add_u32 m0, s25, 0
    s_nop 0
    buffer_load_dwordx4 v12, s[12:15], s27 offen lds
    s_add_u32 m0, s25, 1024
    s_nop 0
    buffer_load_dwordx4 v13, s[12:15], s27 offen lds
    s_add_u32 m0, s25, 2048
    s_nop 0
    buffer_load_dwordx4 v14, s[12:15], s27 offen lds
    s_add_u32 m0, s25, 3072
    s_nop 0
    buffer_load_dwordx4 v15, s[12:15], s27 offen lds
    s_add_u32 m0, s25, 4096
    s_nop 0
    buffer_load_dwordx4 v16, s[12:15], s27 offen lds
    s_add_u32 m0, s25, 5120
    s_nop 0
    buffer_load_dwordx4 v17, s[12:15], s27 offen lds
    s_add_u32 s26, s26, 128
    s_add_u32 s27, s27, 393216
    s_add_u32 m0, s24, 40960
    s_nop 0
    buffer_load_dwordx4 v8, s[8:11], s26 offen lds
    s_add_u32 m0, s24, 41984
    s_nop 0
    buffer_load_dwordx4 v9, s[8:11], s26 offen lds
    s_add_u32 m0, s24, 43008
    s_nop 0
    buffer_load_dwordx4 v10, s[8:11], s26 offen lds
    s_add_u32 m0, s24, 44032
    s_nop 0
    buffer_load_dwordx4 v11, s[8:11], s26 offen lds
    s_add_u32 m0, s25, 40960
    s_nop 0
    buffer_load_dwordx4 v12, s[12:15], s27 offen lds
    s_add_u32 m0, s25, 41984
    s_nop 0
    buffer_load_dwordx4 v13, s[12:15], s27 offen lds
    s_add_u32 m0, s25, 43008
    s_nop 0
    buffer_load_dwordx4 v14, s[12:15], s27 offen lds
    s_add_u32 m0, s25, 44032
    s_nop 0
    buffer_load_dwordx4 v15, s[12:15], s27 offen lds
    s_add_u32 m0, s25, 45056
    s_nop 0
    buffer_load_dwordx4 v16, s[12:15], s27 offen lds
    s_add_u32 m0, s25, 46080
    s_nop 0
    buffer_load_dwordx4 v17, s[12:15], s27 offen lds
    s_add_u32 s26, s26, 128
    s_add_u32 s27, s27, 393216
    s_add_u32 m0, s24, 81920
    s_nop 0
    buffer_load_dwordx4 v8, s[8:11], s26 offen lds
    s_add_u32 m0, s24, 82944
    s_nop 0
    buffer_load_dwordx4 v9, s[8:11], s26 offen lds
    s_add_u32 m0, s24, 83968
    s_nop 0
    buffer_load_dwordx4 v10, s[8:11], s26 offen lds
    s_add_u32 m0, s24, 84992
    s_nop 0
    buffer_load_dwordx4 v11, s[8:11], s26 offen lds
    s_add_u32 m0, s25, 81920
    s_nop 0
    buffer_load_dwordx4 v12, s[12:15], s27 offen lds
    s_add_u32 m0, s25, 82944
    s_nop 0
    buffer_load_dwordx4 v13, s[12:15], s27 offen lds
    s_add_u32 m0, s25, 83968
    s_nop 0
    buffer_load_dwordx4 v14, s[12:15], s27 offen lds
    s_add_u32 m0, s25, 84992
    s_nop 0
    buffer_load_dwordx4 v15, s[12:15], s27 offen lds
    s_add_u32 m0, s25, 86016
    s_nop 0
    buffer_load_dwordx4 v16, s[12:15], s27 offen lds
    s_add_u32 m0, s25, 87040
    s_nop 0
    buffer_load_dwordx4 v17, s[12:15], s27 offen lds
    s_add_u32 s26, s26, 128
    s_add_u32 s27, s27, 393216
    s_add_u32 m0, s24, 122880
    s_nop 0
    buffer_load_dwordx4 v8, s[8:11], s26 offen lds
    s_add_u32 m0, s24, 123904
    s_nop 0
    buffer_load_dwordx4 v9, s[8:11], s26 offen lds
    s_add_u32 m0, s24, 124928
    s_nop 0
    buffer_load_dwordx4 v10, s[8:11], s26 offen lds
    s_add_u32 m0, s24, 125952
    s_nop 0
    buffer_load_dwordx4 v11, s[8:11], s26 offen lds
    s_add_u32 m0, s25, 122880
    s_nop 0
    buffer_load_dwordx4 v12, s[12:15], s27 offen lds
    s_add_u32 m0, s25, 123904
    s_nop 0
    buffer_load_dwordx4 v13, s[12:15], s27 offen lds
    s_add_u32 m0, s25, 124928
    s_nop 0
    buffer_load_dwordx4 v14, s[12:15], s27 offen lds
    s_add_u32 m0, s25, 125952
    s_nop 0
    buffer_load_dwordx4 v15, s[12:15], s27 offen lds
    s_add_u32 m0, s25, 126976
    s_nop 0
    buffer_load_dwordx4 v16, s[12:15], s27 offen lds
    s_add_u32 m0, s25, 128000
    s_nop 0
    buffer_load_dwordx4 v17, s[12:15], s27 offen lds
    s_add_u32 s26, s26, 128
    s_add_u32 s27, s27, 393216
    s_waitcnt vmcnt(30)
    s_barrier
    s_waitcnt vmcnt(20)
    s_barrier
    s_mov_b32 s28, 3
lloop_qkv_kernel_4:
    s_add_u32 m0, s24, 0
    s_nop 0
    buffer_load_dwordx4 v8, s[8:11], s26 offen lds
    s_add_u32 m0, s24, 1024
    s_nop 0
    buffer_load_dwordx4 v9, s[8:11], s26 offen lds
    s_add_u32 m0, s24, 2048
    s_nop 0
    buffer_load_dwordx4 v10, s[8:11], s26 offen lds
    s_add_u32 m0, s24, 3072
    s_nop 0
    buffer_load_dwordx4 v11, s[8:11], s26 offen lds
    s_add_u32 m0, s25, 0
    s_nop 0
    buffer_load_dwordx4 v12, s[12:15], s27 offen lds
    s_add_u32 m0, s25, 1024
    s_nop 0
    buffer_load_dwordx4 v13, s[12:15], s27 offen lds
    s_add_u32 m0, s25, 2048
    s_nop 0
    buffer_load_dwordx4 v14, s[12:15], s27 offen lds
    s_add_u32 m0, s25, 3072
    s_nop 0
    buffer_load_dwordx4 v15, s[12:15], s27 offen lds
    s_add_u32 m0, s25, 4096
    s_nop 0
    buffer_load_dwordx4 v16, s[12:15], s27 offen lds
    s_add_u32 m0, s25, 5120
    s_nop 0
    buffer_load_dwordx4 v17, s[12:15], s27 offen lds
    s_add_u32 s26, s26, 128
    s_add_u32 s27, s27, 393216
    s_waitcnt vmcnt(20)
    s_barrier
    s_add_u32 m0, s24, 40960
    s_nop 0
    buffer_load_dwordx4 v8, s[8:11], s26 offen lds
    s_add_u32 m0, s24, 41984
    s_nop 0
    buffer_load_dwordx4 v9, s[8:11], s26 offen lds
    s_add_u32 m0, s24, 43008
    s_nop 0
    buffer_load_dwordx4 v10, s[8:11], s26 offen lds
    s_add_u32 m0, s24, 44032
    s_nop 0
    buffer_load_dwordx4 v11, s[8:11], s26 offen lds
    s_add_u32 m0, s25, 40960
    s_nop 0
    buffer_load_dwordx4 v12, s[12:15], s27 offen lds
    s_add_u32 m0, s25, 41984
    s_nop 0
    buffer_load_dwordx4 v13, s[12:15], s27 offen lds
    s_add_u32 m0, s25, 43008
    s_nop 0
    buffer_load_dwordx4 v14, s[12:15], s27 offen lds
    s_add_u32 m0, s25, 44032
    s_nop 0
    buffer_load_dwordx4 v15, s[12:15], s27 offen lds
    s_add_u32 m0, s25, 45056
    s_nop 0
    buffer_load_dwordx4 v16, s[12:15], s27 offen lds
    s_add_u32 m0, s25, 46080
    s_nop 0
    buffer_load_dwordx4 v17, s[12:15], s27 offen lds
    s_add_u32 s26, s26, 128
    s_add_u32 s27, s27, 393216
    s_waitcnt vmcnt(20)
    s_barrier
    s_add_u32 m0, s24, 81920
    s_nop 0
    buffer_load_dwordx4 v8, s[8:11], s26 offen lds
    s_add_u32 m0, s24, 82944
    s_nop 0
    buffer_load_dwordx4 v9, s[8:11], s26 offen lds
    s_add_u32 m0, s24, 83968
    s_nop 0
    buffer_load_dwordx4 v10, s[8:11], s26 offen lds
    s_add_u32 m0, s24, 84992
    s_nop 0
    buffer_load_dwordx4 v11, s[8:11], s26 offen lds
    s_add_u32 m0, s25, 81920
    s_nop 0
    buffer_load_dwordx4 v12, s[12:15], s27 offen lds
    s_add_u32 m0, s25, 82944
    s_nop 0
    buffer_load_dwordx4 v13, s[12:15], s27 offen lds
    s_add_u32 m0, s25, 83968
    s_nop 0
    buffer_load_dwordx4 v14, s[12:15], s27 offen lds
    s_add_u32 m0, s25, 84992
    s_nop 0
    buffer_load_dwordx4 v15, s[12:15], s27 offen lds
    s_add_u32 m0, s25, 86016
    s_nop 0
    buffer_load_dwordx4 v16, s[12:15], s27 offen lds
    s_add_u32 m0, s25, 87040
    s_nop 0
    buffer_load_dwordx4 v17, s[12:15], s27 offen lds
    s_add_u32 s26, s26, 128
    s_add_u32 s27, s27, 393216
    s_waitcnt vmcnt(20)
    s_barrier
    s_add_u32 m0, s24, 122880
    s_nop 0
    buffer_load_dwordx4 v8, s[8:11], s26 offen lds
    s_add_u32 m0, s24, 123904
    s_nop 0
    buffer_load_dwordx4 v9, s[8:11], s26 offen lds
    s_add_u32 m0, s24, 124928
    s_nop 0
    buffer_load_dwordx4 v10, s[8:11], s26 offen lds
    s_add_u32 m0, s24, 125952
    s_nop 0
    buffer_load_dwordx4 v11, s[8:11], s26 offen lds
    s_add_u32 m0, s25, 122880
    s_nop 0
    buffer_load_dwordx4 v12, s[12:15], s27 offen lds
    s_add_u32 m0, s25, 123904
    s_nop 0
    buffer_load_dwordx4 v13, s[12:15], s27 offen lds
    s_add_u32 m0, s25, 124928
    s_nop 0
    buffer_load_dwordx4 v14, s[12:15], s27 offen lds
    s_add_u32 m0, s25, 125952
    s_nop 0
    buffer_load_dwordx4 v15, s[12:15], s27 offen lds
    s_add_u32 m0, s25, 126976
    s_nop 0
    buffer_load_dwordx4 v16, s[12:15], s27 offen lds
    s_add_u32 m0, s25, 128000
    s_nop 0
    buffer_load_dwordx4 v17, s[12:15], s27 offen lds
    s_add_u32 s26, s26, 128
    s_add_u32 s27, s27, 393216
    s_waitcnt vmcnt(20)
    s_barrier
    s_sub_u32 s28, s28, 1
    s_cmp_lg_u32 s28, 0
    s_cbranch_scc1 lloop_qkv_kernel_4
    s_waitcnt vmcnt(10)
    s_barrier
    s_waitcnt vmcnt(0)
    s_barrier
    s_endpgm
stat_qkv_kernel_3:
    s_sub_u32 s16, s16, 8
    s_lshl_b32 s22, s16, 5
    v_and_b32 v150, 31, v136
    v_bfe_u32 v151, v136, 1, 3
    v_lshrrev_b32 v152, 5, v136
    v_xor_b32 v151, v151, v152
    v_add_u32 v150, s22, v150
    v_lshlrev_b32 v150, 7, v150
    v_lshl_add_u32 v137, v151, 4, v150
    v_xor_b32 v138, 32, v137
    v_xor_b32 v139, 64, v137
    v_xor_b32 v140, 96, v137
    v_add_u32 v141, 81920, v137
    v_add_u32 v142, 81920, v138
    v_add_u32 v143, 81920, v139
    v_add_u32 v144, 81920, v140
    v_lshrrev_b32 v1, 4, v136
    v_mul_u32_u24 v1, 3072, v1
    v_bfe_u32 v2, v136, 2, 2
    v_lshl_add_u32 v1, v2, 7, v1
    v_and_b32 v3, 1, v136
    v_lshl_add_u32 v1, v3, 3, v1
    v_lshrrev_b32 v2, 1, v2
    v_lshlrev_b32 v2, 2, v2
    v_bfe_u32 v3, v136, 1, 1
    v_xor_b32 v2, v2, v3
    s_mul_i32 s22, s16, 3
    s_add_u32 s22, s22, 0
    s_and_b32 s23, s22, 3
    s_lshl_b32 s23, s23, 1
    s_lshr_b32 s22, s22, 2
    s_lshl_b32 s22, s22, 10
    s_add_u32 s22, s22, 16384
    v_xor_b32 v3, s23, v2
    v_lshl_add_u32 v3, v3, 4, v1
    v_add_u32 v3, s22, v3
    v_add_u32 v84, 0, v3
    v_add_u32 v85, 40960, v3
    v_add_u32 v86, 81920, v3
    v_add_u32 v87, 122880, v3
    s_mul_i32 s22, s16, 3
    s_add_u32 s22, s22, 1
    s_and_b32 s23, s22, 3
    s_lshl_b32 s23, s23, 1
    s_lshr_b32 s22, s22, 2
    s_lshl_b32 s22, s22, 10
    s_add_u32 s22, s22, 16384
    v_xor_b32 v3, s23, v2
    v_lshl_add_u32 v3, v3, 4, v1
    v_add_u32 v3, s22, v3
    v_add_u32 v88, 0, v3
    v_add_u32 v89, 40960, v3
    v_add_u32 v90, 81920, v3
    v_add_u32 v91, 122880, v3
    s_mul_i32 s22, s16, 3
    s_add_u32 s22, s22, 2
    s_and_b32 s23, s22, 3
    s_lshl_b32 s23, s23, 1
    s_lshr_b32 s22, s22, 2
    s_lshl_b32 s22, s22, 10
    s_add_u32 s22, s22, 16384
    v_xor_b32 v3, s23, v2
    v_lshl_add_u32 v3, v3, 4, v1
    v_add_u32 v3, s22, v3
    v_add_u32 v92, 0, v3
    v_add_u32 v93, 40960, v3
    v_add_u32 v94, 81920, v3
    v_add_u32 v95, 122880, v3
    v_mov_b32 v100, 0
    v_mov_b32 v101, 0
    v_mov_b32 v102, 0
    v_mov_b32 v103, 0
    v_mov_b32 v104, 0
    v_mov_b32 v105, 0
    v_mov_b32 v106, 0
    v_mov_b32 v107, 0
    v_mov_b32 v108, 0
    v_mov_b32 v109, 0
    v_mov_b32 v110, 0x3f803f80
    s_waitcnt lgkmcnt(0)
    s_barrier
    ds_read_b128 v[4:7], v137 offset:0
    ds_read_b128 v[8:11], v138 offset:0
    ds_read_b128 v[12:15], v139 offset:0
    ds_read_b128 v[16:19], v140 offset:0
    ds_read_b64_tr_b16 v[20:21], v84 offset:0
    ds_read_b64_tr_b16 v[22:23], v84 offset:512
    ds_read_b64_tr_b16 v[24:25], v84 offset:12288
    ds_read_b64_tr_b16 v[26:27], v84 offset:12800
    ds_read_b64_tr_b16 v[28:29], v88 offset:0
    ds_read_b64_tr_b16 v[30:31], v88 offset:512
    ds_read_b64_tr_b16 v[32:33], v88 offset:12288
    ds_read_b64_tr_b16 v[34:35], v88 offset:12800
    ds_read_b64_tr_b16 v[36:37], v92 offset:0
    ds_read_b64_tr_b16 v[38:39], v92 offset:512
    ds_read_b64_tr_b16 v[40:41], v92 offset:12288
    ds_read_b64_tr_b16 v[42:43], v92 offset:12800
    s_waitcnt lgkmcnt(0)
    s_barrier
    s_mov_b32 s28, 3
wloop_qkv_kernel_5:
    ds_read_b128 v[44:47], v137 offset:40960
    ds_read_b128 v[48:51], v138 offset:40960
    ds_read_b128 v[52:55], v139 offset:40960
    ds_read_b128 v[56:59], v140 offset:40960
    ds_read_b64_tr_b16 v[60:61], v85 offset:0
    ds_read_b64_tr_b16 v[62:63], v85 offset:512
    ds_read_b64_tr_b16 v[64:65], v85 offset:12288
    ds_read_b64_tr_b16 v[66:67], v85 offset:12800
    ds_read_b64_tr_b16 v[68:69], v89 offset:0
    ds_read_b64_tr_b16 v[70:71], v89 offset:512
    ds_read_b64_tr_b16 v[72:73], v89 offset:12288
    ds_read_b64_tr_b16 v[74:75], v89 offset:12800
    ds_read_b64_tr_b16 v[76:77], v93 offset:0
    ds_read_b64_tr_b16 v[78:79], v93 offset:512
    ds_read_b64_tr_b16 v[80:81], v93 offset:12288
    ds_read_b64_tr_b16 v[82:83], v93 offset:12800
    v_dot2c_f32_bf16 v100, v4, v110
    v_dot2c_f32_bf16 v102, v4, v4
    v_dot2c_f32_bf16 v101, v5, v110
    v_dot2c_f32_bf16 v103, v5, v5
    v_dot2c_f32_bf16 v100, v6, v110
    v_dot2c_f32_bf16 v102, v6, v6
    v_dot2c_f32_bf16 v101, v7, v110
    v_dot2c_f32_bf16 v103, v7, v7
    v_dot2c_f32_bf16 v100, v8, v110
    v_dot2c_f32_bf16 v102, v8, v8
    v_dot2c_f32_bf16 v101, v9, v110
    v_dot2c_f32_bf16 v103, v9, v9
    v_dot2c_f32_bf16 v100, v10, v110
    v_dot2c_f32_bf16 v102, v10, v10
    v_dot2c_f32_bf16 v101, v11, v110
    v_dot2c_f32_bf16 v103, v11, v11
    v_dot2c_f32_bf16 v100, v12, v110
    v_dot2c_f32_bf16 v102, v12, v12
    v_dot2c_f32_bf16 v101, v13, v110
    v_dot2c_f32_bf16 v103, v13, v13
    v_dot2c_f32_bf16 v100, v14, v110
    v_dot2c_f32_bf16 v102, v14, v14
    v_dot2c_f32_bf16 v101, v15, v110
    v_dot2c_f32_bf16 v103, v15, v15
    v_dot2c_f32_bf16 v100, v16, v110
    v_dot2c_f32_bf16 v102, v16, v16
    v_dot2c_f32_bf16 v101, v17, v110
    v_dot2c_f32_bf16 v103, v17, v17
    v_dot2c_f32_bf16 v100, v18, v110
    v_dot2c_f32_bf16 v102, v18, v18
    v_dot2c_f32_bf16 v101, v19, v110
    v_dot2c_f32_bf16 v103, v19, v19
    v_dot2c_f32_bf16 v104, v20, v110
    v_dot2c_f32_bf16 v106, v28, v110
    v_dot2c_f32_bf16 v108, v36, v110
    v_dot2c_f32_bf16 v105, v21, v110
    v_dot2c_f32_bf16 v107, v29, v110
    v_dot2c_f32_bf16 v109, v37, v110
    v_dot2c_f32_bf16 v104, v22, v110
    v_dot2c_f32_bf16 v106, v30, v110
    v_dot2c_f32_bf16 v108, v38, v110
    v_dot2c_f32_bf16 v105, v23, v110
    v_dot2c_f32_bf16 v107, v31, v110
    v_dot2c_f32_bf16 v109, v39, v110
    v_dot2c_f32_bf16 v104, v24, v110
    v_dot2c_f32_bf16 v106, v32, v110
    v_dot2c_f32_bf16 v108, v40, v110
    v_dot2c_f32_bf16 v105, v25, v110
    v_dot2c_f32_bf16 v107, v33, v110
    v_dot2c_f32_bf16 v109, v41, v110
    v_dot2c_f32_bf16 v104, v26, v110
    v_dot2c_f32_bf16 v106, v34, v110
    v_dot2c_f32_bf16 v108, v42, v110
    v_dot2c_f32_bf16 v105, v27, v110
    v_dot2c_f32_bf16 v107, v35, v110
    v_dot2c_f32_bf16 v109, v43, v110
    s_waitcnt lgkmcnt(0)
    s_barrier
    ds_read_b128 v[4:7], v141 offset:0
    ds_read_b128 v[8:11], v142 offset:0
    ds_read_b128 v[12:15], v143 offset:0
    ds_read_b128 v[16:19], v144 offset:0
    ds_read_b64_tr_b16 v[20:21], v86 offset:0
    ds_read_b64_tr_b16 v[22:23], v86 offset:512
    ds_read_b64_tr_b16 v[24:25], v86 offset:12288
    ds_read_b64_tr_b16 v[26:27], v86 offset:12800
    ds_read_b64_tr_b16 v[28:29], v90 offset:0
    ds_read_b64_tr_b16 v[30:31], v90 offset:512
    ds_read_b64_tr_b16 v[32:33], v90 offset:12288
    ds_read_b64_tr_b16 v[34:35], v90 offset:12800
    ds_read_b64_tr_b16 v[36:37], v94 offset:0
    ds_read_b64_tr_b16 v[38:39], v94 offset:512
    ds_read_b64_tr_b16 v[40:41], v94 offset:12288
    ds_read_b64_tr_b16 v[42:43], v94 offset:12800
    v_dot2c_f32_bf16 v100, v44, v110
    v_dot2c_f32_bf16 v102, v44, v44
    v_dot2c_f32_bf16 v101, v45, v110
    v_dot2c_f32_bf16 v103, v45, v45
    v_dot2c_f32_bf16 v100, v46, v110
    v_dot2c_f32_bf16 v102, v46, v46
    v_dot2c_f32_bf16 v101, v47, v110
    v_dot2c_f32_bf16 v103, v47, v47
    v_dot2c_f32_bf16 v100, v48, v110
    v_dot2c_f32_bf16 v102, v48, v48
    v_dot2c_f32_bf16 v101, v49, v110
    v_dot2c_f32_bf16 v103, v49, v49
    v_dot2c_f32_bf16 v100, v50, v110
    v_dot2c_f32_bf16 v102, v50, v50
    v_dot2c_f32_bf16 v101, v51, v110
    v_dot2c_f32_bf16 v103, v51, v51
    v_dot2c_f32_bf16 v100, v52, v110
    v_dot2c_f32_bf16 v102, v52, v52
    v_dot2c_f32_bf16 v101, v53, v110
    v_dot2c_f32_bf16 v103, v53, v53
    v_dot2c_f32_bf16 v100, v54, v110
    v_dot2c_f32_bf16 v102, v54, v54
    v_dot2c_f32_bf16 v101, v55, v110
    v_dot2c_f32_bf16 v103, v55, v55
    v_dot2c_f32_bf16 v100, v56, v110
    v_dot2c_f32_bf16 v102, v56, v56
    v_dot2c_f32_bf16 v101, v57, v110
    v_dot2c_f32_bf16 v103, v57, v57
    v_dot2c_f32_bf16 v100, v58, v110
    v_dot2c_f32_bf16 v102, v58, v58
    v_dot2c_f32_bf16 v101, v59, v110
    v_dot2c_f32_bf16 v103, v59, v59
    v_dot2c_f32_bf16 v104, v60, v110
    v_dot2c_f32_bf16 v106, v68, v110
    v_dot2c_f32_bf16 v108, v76, v110
    v_dot2c_f32_bf16 v105, v61, v110
    v_dot2c_f32_bf16 v107, v69, v110
    v_dot2c_f32_bf16 v109, v77, v110
    v_dot2c_f32_bf16 v104, v62, v110
    v_dot2c_f32_bf16 v106, v70, v110
    v_dot2c_f32_bf16 v108, v78, v110
    v_dot2c_f32_bf16 v105, v63, v110
    v_dot2c_f32_bf16 v107, v71, v110
    v_dot2c_f32_bf16 v109, v79, v110
    v_dot2c_f32_bf16 v104, v64, v110
    v_dot2c_f32_bf16 v106, v72, v110
    v_dot2c_f32_bf16 v108, v80, v110
    v_dot2c_f32_bf16 v105, v65, v110
    v_dot2c_f32_bf16 v107, v73, v110
    v_dot2c_f32_bf16 v109, v81, v110
    v_dot2c_f32_bf16 v104, v66, v110
    v_dot2c_f32_bf16 v106, v74, v110
    v_dot2c_f32_bf16 v108, v82, v110
    v_dot2c_f32_bf16 v105, v67, v110
    v_dot2c_f32_bf16 v107, v75, v110
    v_dot2c_f32_bf16 v109, v83, v110
    s_waitcnt lgkmcnt(0)
    s_barrier
    ds_read_b128 v[44:47], v141 offset:40960
    ds_read_b128 v[48:51], v142 offset:40960
    ds_read_b128 v[52:55], v143 offset:40960
    ds_read_b128 v[56:59], v144 offset:40960
    ds_read_b64_tr_b16 v[60:61], v87 offset:0
    ds_read_b64_tr_b16 v[62:63], v87 offset:512
    ds_read_b64_tr_b16 v[64:65], v87 offset:12288
    ds_read_b64_tr_b16 v[66:67], v87 offset:12800
    ds_read_b64_tr_b16 v[68:69], v91 offset:0
    ds_read_b64_tr_b16 v[70:71], v91 offset:512
    ds_read_b64_tr_b16 v[72:73], v91 offset:12288
    ds_read_b64_tr_b16 v[74:75], v91 offset:12800
    ds_read_b64_tr_b16 v[76:77], v95 offset:0
    ds_read_b64_tr_b16 v[78:79], v95 offset:512
    ds_read_b64_tr_b16 v[80:81], v95 offset:12288
    ds_read_b64_tr_b16 v[82:83], v95 offset:12800
    v_dot2c_f32_bf16 v100, v4, v110
    v_dot2c_f32_bf16 v102, v4, v4
    v_dot2c_f32_bf16 v101, v5, v110
    v_dot2c_f32_bf16 v103, v5, v5
    v_dot2c_f32_bf16 v100, v6, v110
    v_dot2c_f32_bf16 v102, v6, v6
    v_dot2c_f32_bf16 v101, v7, v110
    v_dot2c_f32_bf16 v103, v7, v7
    v_dot2c_f32_bf16 v100, v8, v110
    v_dot2c_f32_bf16 v102, v8, v8
    v_dot2c_f32_bf16 v101, v9, v110
    v_dot2c_f32_bf16 v103, v9, v9
    v_dot2c_f32_bf16 v100, v10, v110
    v_dot2c_f32_bf16 v102, v10, v10
    v_dot2c_f32_bf16 v101, v11, v110
    v_dot2c_f32_bf16 v103, v11, v11
    v_dot2c_f32_bf16 v100, v12, v110
    v_dot2c_f32_bf16 v102, v12, v12
    v_dot2c_f32_bf16 v101, v13, v110
    v_dot2c_f32_bf16 v103, v13, v13
    v_dot2c_f32_bf16 v100, v14, v110
    v_dot2c_f32_bf16 v102, v14, v14
    v_dot2c_f32_bf16 v101, v15, v110
    v_dot2c_f32_bf16 v103, v15, v15
    v_dot2c_f32_bf16 v100, v16, v110
    v_dot2c_f32_bf16 v102, v16, v16
    v_dot2c_f32_bf16 v101, v17, v110
    v_dot2c_f32_bf16 v103, v17, v17
    v_dot2c_f32_bf16 v100, v18, v110
    v_dot2c_f32_bf16 v102, v18, v18
    v_dot2c_f32_bf16 v101, v19, v110
    v_dot2c_f32_bf16 v103, v19, v19
    v_dot2c_f32_bf16 v104, v20, v110
    v_dot2c_f32_bf16 v106, v28, v110
    v_dot2c_f32_bf16 v108, v36, v110
    v_dot2c_f32_bf16 v105, v21, v110
    v_dot2c_f32_bf16 v107, v29, v110
    v_dot2c_f32_bf16 v109, v37, v110
    v_dot2c_f32_bf16 v104, v22, v110
    v_dot2c_f32_bf16 v106, v30, v110
    v_dot2c_f32_bf16 v108, v38, v110
    v_dot2c_f32_bf16 v105, v23, v110
    v_dot2c_f32_bf16 v107, v31, v110
    v_dot2c_f32_bf16 v109, v39, v110
    v_dot2c_f32_bf16 v104, v24, v110
    v_dot2c_f32_bf16 v106, v32, v110
    v_dot2c_f32_bf16 v108, v40, v110
    v_dot2c_f32_bf16 v105, v25, v110
    v_dot2c_f32_bf16 v107, v33, v110
    v_dot2c_f32_bf16 v109, v41, v110
    v_dot2c_f32_bf16 v104, v26, v110
    v_dot2c_f32_bf16 v106, v34, v110
    v_dot2c_f32_bf16 v108, v42, v110
    v_dot2c_f32_bf16 v105, v27, v110
    v_dot2c_f32_bf16 v107, v35, v110
    v_dot2c_f32_bf16 v109, v43, v110
    s_waitcnt lgkmcnt(0)
    s_barrier
    ds_read_b128 v[4:7], v137 offset:0
    ds_read_b128 v[8:11], v138 offset:0
    ds_read_b128 v[12:15], v139 offset:0
    ds_read_b128 v[16:19], v140 offset:0
    ds_read_b64_tr_b16 v[20:21], v84 offset:0
    ds_read_b64_tr_b16 v[22:23], v84 offset:512
    ds_read_b64_tr_b16 v[24:25], v84 offset:12288
    ds_read_b64_tr_b16 v[26:27], v84 offset:12800
    ds_read_b64_tr_b16 v[28:29], v88 offset:0
    ds_read_b64_tr_b16 v[30:31], v88 offset:512
    ds_read_b64_tr_b16 v[32:33], v88 offset:12288
    ds_read_b64_tr_b16 v[34:35], v88 offset:12800
    ds_read_b64_tr_b16 v[36:37], v92 offset:0
    ds_read_b64_tr_b16 v[38:39], v92 offset:512
    ds_read_b64_tr_b16 v[40:41], v92 offset:12288
    ds_read_b64_tr_b16 v[42:43], v92 offset:12800
    v_dot2c_f32_bf16 v100, v44, v110
    v_dot2c_f32_bf16 v102, v44, v44
    v_dot2c_f32_bf16 v101, v45, v110
    v_dot2c_f32_bf16 v103, v45, v45
    v_dot2c_f32_bf16 v100, v46, v110
    v_dot2c_f32_bf16 v102, v46, v46
    v_dot2c_f32_bf16 v101, v47, v110
    v_dot2c_f32_bf16 v103, v47, v47
    v_dot2c_f32_bf16 v100, v48, v110
    v_dot2c_f32_bf16 v102, v48, v48
    v_dot2c_f32_bf16 v101, v49, v110
    v_dot2c_f32_bf16 v103, v49, v49
    v_dot2c_f32_bf16 v100, v50, v110
    v_dot2c_f32_bf16 v102, v50, v50
    v_dot2c_f32_bf16 v101, v51, v110
    v_dot2c_f32_bf16 v103, v51, v51
    v_dot2c_f32_bf16 v100, v52, v110
    v_dot2c_f32_bf16 v102, v52, v52
    v_dot2c_f32_bf16 v101, v53, v110
    v_dot2c_f32_bf16 v103, v53, v53
    v_dot2c_f32_bf16 v100, v54, v110
    v_dot2c_f32_bf16 v102, v54, v54
    v_dot2c_f32_bf16 v101, v55, v110
    v_dot2c_f32_bf16 v103, v55, v55
    v_dot2c_f32_bf16 v100, v56, v110
    v_dot2c_f32_bf16 v102, v56, v56
    v_dot2c_f32_bf16 v101, v57, v110
    v_dot2c_f32_bf16 v103, v57, v57
    v_dot2c_f32_bf16 v100, v58, v110
    v_dot2c_f32_bf16 v102, v58, v58
    v_dot2c_f32_bf16 v101, v59, v110
    v_dot2c_f32_bf16 v103, v59, v59
    v_dot2c_f32_bf16 v104, v60, v110
    v_dot2c_f32_bf16 v106, v68, v110
    v_dot2c_f32_bf16 v108, v76, v110
    v_dot2c_f32_bf16 v105, v61, v110
    v_dot2c_f32_bf16 v107, v69, v110
    v_dot2c_f32_bf16 v109, v77, v110
    v_dot2c_f32_bf16 v104, v62, v110
    v_dot2c_f32_bf16 v106, v70, v110
    v_dot2c_f32_bf16 v108, v78, v110
    v_dot2c_f32_bf16 v105, v63, v110
    v_dot2c_f32_bf16 v107, v71, v110
    v_dot2c_f32_bf16 v109, v79, v110
    v_dot2c_f32_bf16 v104, v64, v110
    v_dot2c_f32_bf16 v106, v72, v110
    v_dot2c_f32_bf16 v108, v80, v110
    v_dot2c_f32_bf16 v105, v65, v110
    v_dot2c_f32_bf16 v107, v73, v110
    v_dot2c_f32_bf16 v109, v81, v110
    v_dot2c_f32_bf16 v104, v66, v110
    v_dot2c_f32_bf16 v106, v74, v110
    v_dot2c_f32_bf16 v108, v82, v110
    v_dot2c_f32_bf16 v105, v67, v110
    v_dot2c_f32_bf16 v107, v75, v110
    v_dot2c_f32_bf16 v109, v83, v110
    s_waitcnt lgkmcnt(0)
    s_barrier
    s_sub_u32 s28, s28, 1
    s_cmp_lg_u32 s28, 0
    s_cbranch_scc1 wloop_qkv_kernel_5
    ds_read_b128 v[44:47], v137 offset:40960
    ds_read_b128 v[48:51], v138 offset:40960
    ds_read_b128 v[52:55], v139 offset:40960
    ds_read_b128 v[56:59], v140 offset:40960
    ds_read_b64_tr_b16 v[60:61], v85 offset:0
    ds_read_b64_tr_b16 v[62:63], v85 offset:512
    ds_read_b64_tr_b16 v[64:65], v85 offset:12288
    ds_read_b64_tr_b16 v[66:67], v85 offset:12800
    ds_read_b64_tr_b16 v[68:69], v89 offset:0
    ds_read_b64_tr_b16 v[70:71], v89 offset:512
    ds_read_b64_tr_b16 v[72:73], v89 offset:12288
    ds_read_b64_tr_b16 v[74:75], v89 offset:12800
    ds_read_b64_tr_b16 v[76:77], v93 offset:0
    ds_read_b64_tr_b16 v[78:79], v93 offset:512
    ds_read_b64_tr_b16 v[80:81], v93 offset:12288
    ds_read_b64_tr_b16 v[82:83], v93 offset:12800
    v_dot2c_f32_bf16 v100, v4, v110
    v_dot2c_f32_bf16 v102, v4, v4
    v_dot2c_f32_bf16 v101, v5, v110
    v_dot2c_f32_bf16 v103, v5, v5
    v_dot2c_f32_bf16 v100, v6, v110
    v_dot2c_f32_bf16 v102, v6, v6
    v_dot2c_f32_bf16 v101, v7, v110
    v_dot2c_f32_bf16 v103, v7, v7
    v_dot2c_f32_bf16 v100, v8, v110
    v_dot2c_f32_bf16 v102, v8, v8
    v_dot2c_f32_bf16 v101, v9, v110
    v_dot2c_f32_bf16 v103, v9, v9
    v_dot2c_f32_bf16 v100, v10, v110
    v_dot2c_f32_bf16 v102, v10, v10
    v_dot2c_f32_bf16 v101, v11, v110
    v_dot2c_f32_bf16 v103, v11, v11
    v_dot2c_f32_bf16 v100, v12, v110
    v_dot2c_f32_bf16 v102, v12, v12
    v_dot2c_f32_bf16 v101, v13, v110
    v_dot2c_f32_bf16 v103, v13, v13
    v_dot2c_f32_bf16 v100, v14, v110
    v_dot2c_f32_bf16 v102, v14, v14
    v_dot2c_f32_bf16 v101, v15, v110
    v_dot2c_f32_bf16 v103, v15, v15
    v_dot2c_f32_bf16 v100, v16, v110
    v_dot2c_f32_bf16 v102, v16, v16
    v_dot2c_f32_bf16 v101, v17, v110
    v_dot2c_f32_bf16 v103, v17, v17
    v_dot2c_f32_bf16 v100, v18, v110
    v_dot2c_f32_bf16 v102, v18, v18
    v_dot2c_f32_bf16 v101, v19, v110
    v_dot2c_f32_bf16 v103, v19, v19
    v_dot2c_f32_bf16 v104, v20, v110
    v_dot2c_f32_bf16 v106, v28, v110
    v_dot2c_f32_bf16 v108, v36, v110
    v_dot2c_f32_bf16 v105, v21, v110
    v_dot2c_f32_bf16 v107, v29, v110
    v_dot2c_f32_bf16 v109, v37, v110
    v_dot2c_f32_bf16 v104, v22, v110
    v_dot2c_f32_bf16 v106, v30, v110
    v_dot2c_f32_bf16 v108, v38, v110
    v_dot2c_f32_bf16 v105, v23, v110
    v_dot2c_f32_bf16 v107, v31, v110
    v_dot2c_f32_bf16 v109, v39, v110
    v_dot2c_f32_bf16 v104, v24, v110
    v_dot2c_f32_bf16 v106, v32, v110
    v_dot2c_f32_bf16 v108, v40, v110
    v_dot2c_f32_bf16 v105, v25, v110
    v_dot2c_f32_bf16 v107, v33, v110
    v_dot2c_f32_bf16 v109, v41, v110
    v_dot2c_f32_bf16 v104, v26, v110
    v_dot2c_f32_bf16 v106, v34, v110
    v_dot2c_f32_bf16 v108, v42, v110
    v_dot2c_f32_bf16 v105, v27, v110
    v_dot2c_f32_bf16 v107, v35, v110
    v_dot2c_f32_bf16 v109, v43, v110
    s_waitcnt lgkmcnt(0)
    s_barrier
    ds_read_b128 v[4:7], v141 offset:0
    ds_read_b128 v[8:11], v142 offset:0
    ds_read_b128 v[12:15], v143 offset:0
    ds_read_b128 v[16:19], v144 offset:0
    ds_read_b64_tr_b16 v[20:21], v86 offset:0
    ds_read_b64_tr_b16 v[22:23], v86 offset:512
    ds_read_b64_tr_b16 v[24:25], v86 offset:12288
    ds_read_b64_tr_b16 v[26:27], v86 offset:12800
    ds_read_b64_tr_b16 v[28:29], v90 offset:0
    ds_read_b64_tr_b16 v[30:31], v90 offset:512
    ds_read_b64_tr_b16 v[32:33], v90 offset:12288
    ds_read_b64_tr_b16 v[34:35], v90 offset:12800
    ds_read_b64_tr_b16 v[36:37], v94 offset:0
    ds_read_b64_tr_b16 v[38:39], v94 offset:512
    ds_read_b64_tr_b16 v[40:41], v94 offset:12288
    ds_read_b64_tr_b16 v[42:43], v94 offset:12800
    v_dot2c_f32_bf16 v100, v44, v110
    v_dot2c_f32_bf16 v102, v44, v44
    v_dot2c_f32_bf16 v101, v45, v110
    v_dot2c_f32_bf16 v103, v45, v45
    v_dot2c_f32_bf16 v100, v46, v110
    v_dot2c_f32_bf16 v102, v46, v46
    v_dot2c_f32_bf16 v101, v47, v110
    v_dot2c_f32_bf16 v103, v47, v47
    v_dot2c_f32_bf16 v100, v48, v110
    v_dot2c_f32_bf16 v102, v48, v48
    v_dot2c_f32_bf16 v101, v49, v110
    v_dot2c_f32_bf16 v103, v49, v49
    v_dot2c_f32_bf16 v100, v50, v110
    v_dot2c_f32_bf16 v102, v50, v50
    v_dot2c_f32_bf16 v101, v51, v110
    v_dot2c_f32_bf16 v103, v51, v51
    v_dot2c_f32_bf16 v100, v52, v110
    v_dot2c_f32_bf16 v102, v52, v52
    v_dot2c_f32_bf16 v101, v53, v110
    v_dot2c_f32_bf16 v103, v53, v53
    v_dot2c_f32_bf16 v100, v54, v110
    v_dot2c_f32_bf16 v102, v54, v54
    v_dot2c_f32_bf16 v101, v55, v110
    v_dot2c_f32_bf16 v103, v55, v55
    v_dot2c_f32_bf16 v100, v56, v110
    v_dot2c_f32_bf16 v102, v56, v56
    v_dot2c_f32_bf16 v101, v57, v110
    v_dot2c_f32_bf16 v103, v57, v57
    v_dot2c_f32_bf16 v100, v58, v110
    v_dot2c_f32_bf16 v102, v58, v58
    v_dot2c_f32_bf16 v101, v59, v110
    v_dot2c_f32_bf16 v103, v59, v59
    v_dot2c_f32_bf16 v104, v60, v110
    v_dot2c_f32_bf16 v106, v68, v110
    v_dot2c_f32_bf16 v108, v76, v110
    v_dot2c_f32_bf16 v105, v61, v110
    v_dot2c_f32_bf16 v107, v69, v110
    v_dot2c_f32_bf16 v109, v77, v110
    v_dot2c_f32_bf16 v104, v62, v110
    v_dot2c_f32_bf16 v106, v70, v110
    v_dot2c_f32_bf16 v108, v78, v110
    v_dot2c_f32_bf16 v105, v63, v110
    v_dot2c_f32_bf16 v107, v71, v110
    v_dot2c_f32_bf16 v109, v79, v110
    v_dot2c_f32_bf16 v104, v64, v110
    v_dot2c_f32_bf16 v106, v72, v110
    v_dot2c_f32_bf16 v108, v80, v110
    v_dot2c_f32_bf16 v105, v65, v110
    v_dot2c_f32_bf16 v107, v73, v110
    v_dot2c_f32_bf16 v109, v81, v110
    v_dot2c_f32_bf16 v104, v66, v110
    v_dot2c_f32_bf16 v106, v74, v110
    v_dot2c_f32_bf16 v108, v82, v110
    v_dot2c_f32_bf16 v105, v67, v110
    v_dot2c_f32_bf16 v107, v75, v110
    v_dot2c_f32_bf16 v109, v83, v110
    s_waitcnt lgkmcnt(0)
    s_barrier
    ds_read_b128 v[44:47], v141 offset:40960
    ds_read_b128 v[48:51], v142 offset:40960
    ds_read_b128 v[52:55], v143 offset:40960
    ds_read_b128 v[56:59], v144 offset:40960
    ds_read_b64_tr_b16 v[60:61], v87 offset:0
    ds_read_b64_tr_b16 v[62:63], v87 offset:512
    ds_read_b64_tr_b16 v[64:65], v87 offset:12288
    ds_read_b64_tr_b16 v[66:67], v87 offset:12800
    ds_read_b64_tr_b16 v[68:69], v91 offset:0
    ds_read_b64_tr_b16 v[70:71], v91 offset:512
    ds_read_b64_tr_b16 v[72:73], v91 offset:12288
    ds_read_b64_tr_b16 v[74:75], v91 offset:12800
    ds_read_b64_tr_b16 v[76:77], v95 offset:0
    ds_read_b64_tr_b16 v[78:79], v95 offset:512
    ds_read_b64_tr_b16 v[80:81], v95 offset:12288
    ds_read_b64_tr_b16 v[82:83], v95 offset:12800
    v_dot2c_f32_bf16 v100, v4, v110
    v_dot2c_f32_bf16 v102, v4, v4
    v_dot2c_f32_bf16 v101, v5, v110
    v_dot2c_f32_bf16 v103, v5, v5
    v_dot2c_f32_bf16 v100, v6, v110
    v_dot2c_f32_bf16 v102, v6, v6
    v_dot2c_f32_bf16 v101, v7, v110
    v_dot2c_f32_bf16 v103, v7, v7
    v_dot2c_f32_bf16 v100, v8, v110
    v_dot2c_f32_bf16 v102, v8, v8
    v_dot2c_f32_bf16 v101, v9, v110
    v_dot2c_f32_bf16 v103, v9, v9
    v_dot2c_f32_bf16 v100, v10, v110
    v_dot2c_f32_bf16 v102, v10, v10
    v_dot2c_f32_bf16 v101, v11, v110
    v_dot2c_f32_bf16 v103, v11, v11
    v_dot2c_f32_bf16 v100, v12, v110
    v_dot2c_f32_bf16 v102, v12, v12
    v_dot2c_f32_bf16 v101, v13, v110
    v_dot2c_f32_bf16 v103, v13, v13
    v_dot2c_f32_bf16 v100, v14, v110
    v_dot2c_f32_bf16 v102, v14, v14
    v_dot2c_f32_bf16 v101, v15, v110
    v_dot2c_f32_bf16 v103, v15, v15
    v_dot2c_f32_bf16 v100, v16, v110
    v_dot2c_f32_bf16 v102, v16, v16
    v_dot2c_f32_bf16 v101, v17, v110
    v_dot2c_f32_bf16 v103, v17, v17
    v_dot2c_f32_bf16 v100, v18, v110
    v_dot2c_f32_bf16 v102, v18, v18
    v_dot2c_f32_bf16 v101, v19, v110
    v_dot2c_f32_bf16 v103, v19, v19
    v_dot2c_f32_bf16 v104, v20, v110
    v_dot2c_f32_bf16 v106, v28, v110
    v_dot2c_f32_bf16 v108, v36, v110
    v_dot2c_f32_bf16 v105, v21, v110
    v_dot2c_f32_bf16 v107, v29, v110
    v_dot2c_f32_bf16 v109, v37, v110
    v_dot2c_f32_bf16 v104, v22, v110
    v_dot2c_f32_bf16 v106, v30, v110
    v_dot2c_f32_bf16 v108, v38, v110
    v_dot2c_f32_bf16 v105, v23, v110
    v_dot2c_f32_bf16 v107, v31, v110
    v_dot2c_f32_bf16 v109, v39, v110
    v_dot2c_f32_bf16 v104, v24, v110
    v_dot2c_f32_bf16 v106, v32, v110
    v_dot2c_f32_bf16 v108, v40, v110
    v_dot2c_f32_bf16 v105, v25, v110
    v_dot2c_f32_bf16 v107, v33, v110
    v_dot2c_f32_bf16 v109, v41, v110
    v_dot2c_f32_bf16 v104, v26, v110
    v_dot2c_f32_bf16 v106, v34, v110
    v_dot2c_f32_bf16 v108, v42, v110
    v_dot2c_f32_bf16 v105, v27, v110
    v_dot2c_f32_bf16 v107, v35, v110
    v_dot2c_f32_bf16 v109, v43, v110
    s_waitcnt lgkmcnt(0)
    v_dot2c_f32_bf16 v100, v44, v110
    v_dot2c_f32_bf16 v102, v44, v44
    v_dot2c_f32_bf16 v101, v45, v110
    v_dot2c_f32_bf16 v103, v45, v45
    v_dot2c_f32_bf16 v100, v46, v110
    v_dot2c_f32_bf16 v102, v46, v46
    v_dot2c_f32_bf16 v101, v47, v110
    v_dot2c_f32_bf16 v103, v47, v47
    v_dot2c_f32_bf16 v100, v48, v110
    v_dot2c_f32_bf16 v102, v48, v48
    v_dot2c_f32_bf16 v101, v49, v110
    v_dot2c_f32_bf16 v103, v49, v49
    v_dot2c_f32_bf16 v100, v50, v110
    v_dot2c_f32_bf16 v102, v50, v50
    v_dot2c_f32_bf16 v101, v51, v110
    v_dot2c_f32_bf16 v103, v51, v51
    v_dot2c_f32_bf16 v100, v52, v110
    v_dot2c_f32_bf16 v102, v52, v52
    v_dot2c_f32_bf16 v101, v53, v110
    v_dot2c_f32_bf16 v103, v53, v53
    v_dot2c_f32_bf16 v100, v54, v110
    v_dot2c_f32_bf16 v102, v54, v54
    v_dot2c_f32_bf16 v101, v55, v110
    v_dot2c_f32_bf16 v103, v55, v55
    v_dot2c_f32_bf16 v100, v56, v110
    v_dot2c_f32_bf16 v102, v56, v56
    v_dot2c_f32_bf16 v101, v57, v110
    v_dot2c_f32_bf16 v103, v57, v57
    v_dot2c_f32_bf16 v100, v58, v110
    v_dot2c_f32_bf16 v102, v58, v58
    v_dot2c_f32_bf16 v101, v59, v110
    v_dot2c_f32_bf16 v103, v59, v59
    v_dot2c_f32_bf16 v104, v60, v110
    v_dot2c_f32_bf16 v106, v68, v110
    v_dot2c_f32_bf16 v108, v76, v110
    v_dot2c_f32_bf16 v105, v61, v110
    v_dot2c_f32_bf16 v107, v69, v110
    v_dot2c_f32_bf16 v109, v77, v110
    v_dot2c_f32_bf16 v104, v62, v110
    v_dot2c_f32_bf16 v106, v70, v110
    v_dot2c_f32_bf16 v108, v78, v110
    v_dot2c_f32_bf16 v105, v63, v110
    v_dot2c_f32_bf16 v107, v71, v110
    v_dot2c_f32_bf16 v109, v79, v110
    v_dot2c_f32_bf16 v104, v64, v110
    v_dot2c_f32_bf16 v106, v72, v110
    v_dot2c_f32_bf16 v108, v80, v110
    v_dot2c_f32_bf16 v105, v65, v110
    v_dot2c_f32_bf16 v107, v73, v110
    v_dot2c_f32_bf16 v109, v81, v110
    v_dot2c_f32_bf16 v104, v66, v110
    v_dot2c_f32_bf16 v106, v74, v110
    v_dot2c_f32_bf16 v108, v82, v110
    v_dot2c_f32_bf16 v105, v67, v110
    v_dot2c_f32_bf16 v107, v75, v110
    v_dot2c_f32_bf16 v109, v83, v110
    s_nop 2
    v_add_f32 v100, v100, v101
    v_add_f32 v102, v102, v103
    v_add_f32 v104, v104, v105
    v_add_f32 v106, v106, v107
    v_add_f32 v108, v108, v109
    v_mov_b32 v101, v100
    s_nop 1
    v_permlane32_swap_b32 v101, v100
    s_nop 1
    v_add_f32 v100, v100, v101
    v_mov_b32 v103, v102
    s_nop 1
    v_permlane32_swap_b32 v103, v102
    s_nop 1
    v_add_f32 v102, v102, v103
    v_mov_b32 v105, v104
    s_nop 1
    v_permlane32_swap_b32 v105, v104
    s_nop 1
    v_add_f32 v104, v104, v105
    v_mov_b32 v107, v106
    s_nop 1
    v_permlane32_swap_b32 v107, v106
    s_nop 1
    v_add_f32 v106, v106, v107
    v_mov_b32 v109, v108
    s_nop 1
    v_permlane32_swap_b32 v109, v108
    s_nop 1
    v_add_f32 v108, v108, v109
    v_mov_b32 v105, v104
    s_nop 1
    v_permlane16_swap_b32 v105, v104
    s_nop 1
    v_add_f32 v104, v104, v105
    v_mov_b32 v107, v106
    s_nop 1
    v_permlane16_swap_b32 v107, v106
    s_nop 1
    v_add_f32 v106, v106, v107
    v_mov_b32 v109, v108
    s_nop 1
    v_permlane16_swap_b32 v109, v108
    s_nop 1
    v_add_f32 v108, v108, v109
    v_mul_f32 v100, 0x3a800000, v100
    v_mul_f32 v102, 0x3a800000, v102
    v_fma_f32 v102, -v100, v100, v102
    v_max_f32 v102, 0, v102
    v_add_f32 v102, 0x3727c5ac, v102
    v_rsq_f32 v102, v102
    v_and_b32 v1, 31, v136
    v_lshlrev_b32 v1, 2, v1
    s_lshl_b32 s22, s16, 7
    v_add_u32 v2, s22, v1
    v_mul_f32 v103, v100, v102
    v_sub_f32 v103, 0, v103
    ds_write2_b32 v2, v102, v103 offset0:0 offset1:128
    v_and_b32 v3, 15, v136
    v_lshlrev_b32 v3, 2, v3
    s_mul_i32 s23, s16, 192
    v_add_u32 v3, s23, v3
    ds_write_b32 v3, v104 offset:1024
    ds_write_b32 v3, v106 offset:1088
    ds_write_b32 v3, v108 offset:1152
    s_waitcnt lgkmcnt(0)
    s_barrier
    s_cmp_lg_u32 s18, 0
    s_cbranch_scc1 e_qkv_kernel_6
    s_add_u32 s8, s36, 46137344
    s_addc_u32 s9, s37, 0
    s_and_b32 s9, s9, 0xffff
    s_mov_b32 s10, 8192
    s_mov_b32 s11, 0x00020000
    s_lshl_b32 s23, s17, 9
    s_add_u32 s22, s22, s23
    buffer_store_dword v100, v1, s[8:11], s22 offen
e_qkv_kernel_6:
    s_endpgm
main_qkv_kernel_2:
    s_setprio 2
    s_and_b32 s20, s16, 1
    s_lshr_b32 s21, s16, 1
    s_lshr_b32 s22, s2, 3
    s_lshl_b32 s22, s22, 2
    s_add_u32 s22, s22, s16
    s_and_b32 s23, s2, 1
    s_bfe_u32 s24, s2, 0x20001
    s_lshl_b32 s25, s23, 2
    s_add_u32 s25, s25, s24
    s_lshl_b32 s25, s25, 7
    s_add_u32 s25, s25, s22
    s_lshl_b32 s25, s25, 12
    s_lshl_b32 s26, s23, 7
    s_add_u32 s26, s26, s22
    s_mul_i32 s26, s26, 6144
    s_lshl_b32 s24, s24, 9
    s_add_u32 s26, s26, s24
    v_lshrrev_b32 v153, 2, v136
    v_lshlrev_b32 v153, 11, v153
    v_and_b32 v152, 3, v136
    v_lshl_add_u32 v153, v152, 7, v153
    s_waitcnt lgkmcnt(0)
    s_mov_b32 s8, s4
    s_and_b32 s9, s5, 0xffff
    s_mov_b32 s10, 4194304
    s_mov_b32 s11, 0x00020000
    s_mov_b32 s12, s6
    s_and_b32 s13, s7, 0xffff
    s_mov_b32 s14, 6291456
    s_mov_b32 s15, 0x00020000
    s_lshl_b32 s22, s21, 6
    v_and_b32 v150, 31, v136
    v_bfe_u32 v151, v136, 1, 3
    v_lshrrev_b32 v152, 5, v136
    v_xor_b32 v151, v151, v152
    v_add_u32 v150, s22, v150
    v_lshlrev_b32 v150, 7, v150
    v_lshl_add_u32 v137, v151, 4, v150
    v_xor_b32 v138, 32, v137
    v_xor_b32 v139, 64, v137
    v_xor_b32 v140, 96, v137
    v_add_u32 v141, 81920, v137
    v_add_u32 v142, 81920, v138
    v_add_u32 v143, 81920, v139
    v_add_u32 v144, 81920, v140
    v_lshrrev_b32 v155, 4, v136
    v_bfe_u32 v156, v136, 2, 2
    v_and_b32 v157, 1, v136
    v_lshlrev_b32 v157, 1, v157
    v_bfe_u32 v158, v136, 1, 1
    v_or_b32 v157, v157, v158
    v_and_b32 v158, 1, v155
    v_lshlrev_b32 v158, 1, v158
    s_lshl_b32 s22, s20, 2
    v_add_u32 v158, s22, v158
    v_lshrrev_b32 v159, 1, v157
    v_add_u32 v158, v158, v159
    v_lshrrev_b32 v159, 1, v156
    v_lshlrev_b32 v159, 2, v159
    v_xor_b32 v158, v158, v159
    v_lshlrev_b32 v158, 4, v158
    v_and_b32 v159, 1, v157
    v_lshl_add_u32 v158, v159, 3, v158
    v_lshl_add_u32 v158, v156, 7, v158
    v_lshrrev_b32 v159, 1, v155
    v_mul_u32_u24 v159, 3072, v159
    v_add_u32 v158, v158, v159
    v_add_u32 v145, 16384, v158
    v_add_u32 v146, 57344, v158
    v_add_u32 v147, 98304, v158
    v_add_u32 v148, 139264, v158
    v_mov_b32 v0, 0
    v_mov_b32 v1, 0
    v_mov_b32 v2, 0
    v_mov_b32 v3, 0
    v_mov_b32 v4, 0
    v_mov_b32 v5, 0
    v_mov_b32 v6, 0
    v_mov_b32 v7, 0
    v_mov_b32 v8, 0
    v_mov_b32 v9, 0
    v_mov_b32 v10, 0
    v_mov_b32 v11, 0
    v_mov_b32 v12, 0
    v_mov_b32 v13, 0
    v_mov_b32 v14, 0
    v_mov_b32 v15, 0
    v_mov_b32 v16, 0
    v_mov_b32 v17, 0
    v_mov_b32 v18, 0
    v_mov_b32 v19, 0
    v_mov_b32 v20, 0
    v_mov_b32 v21, 0
    v_mov_b32 v22, 0
    v_mov_b32 v23, 0
    v_mov_b32 v24, 0
    v_mov_b32 v25, 0
    v_mov_b32 v26, 0
    v_mov_b32 v27, 0
    v_mov_b32 v28, 0
    v_mov_b32 v29, 0
    v_mov_b32 v30, 0
    v_mov_b32 v31, 0
    v_mov_b32 v32, 0
    v_mov_b32 v33, 0
    v_mov_b32 v34, 0
    v_mov_b32 v35, 0
    v_mov_b32 v36, 0
    v_mov_b32 v37, 0
    v_mov_b32 v38, 0
    v_mov_b32 v39, 0
    v_mov_b32 v40, 0
    v_mov_b32 v41, 0
    v_mov_b32 v42, 0
    v_mov_b32 v43, 0
    v_mov_b32 v44, 0
    v_mov_b32 v45, 0
    v_mov_b32 v46, 0
    v_mov_b32 v47, 0
    v_mov_b32 v48, 0
    v_mov_b32 v49, 0
    v_mov_b32 v50, 0
    v_mov_b32 v51, 0
    v_mov_b32 v52, 0
    v_mov_b32 v53, 0
    v_mov_b32 v54, 0
    v_mov_b32 v55, 0
    v_mov_b32 v56, 0
    v_mov_b32 v57, 0
    v_mov_b32 v58, 0
    v_mov_b32 v59, 0
    v_mov_b32 v60, 0
    v_mov_b32 v61, 0
    v_mov_b32 v62, 0
    v_mov_b32 v63, 0
    v_mov_b32 v64, 0
    v_mov_b32 v65, 0
    v_mov_b32 v66, 0
    v_mov_b32 v67, 0
    v_mov_b32 v68, 0
    v_mov_b32 v69, 0
    v_mov_b32 v70, 0
    v_mov_b32 v71, 0
    v_mov_b32 v72, 0
    v_mov_b32 v73, 0
    v_mov_b32 v74, 0
    v_mov_b32 v75, 0
    v_mov_b32 v76, 0
    v_mov_b32 v77, 0
    v_mov_b32 v78, 0
    v_mov_b32 v79, 0
    v_mov_b32 v80, 0
    v_mov_b32 v81, 0
    v_mov_b32 v82, 0
    v_mov_b32 v83, 0
    v_mov_b32 v84, 0
    v_mov_b32 v85, 0
    v_mov_b32 v86, 0
    v_mov_b32 v87, 0
    v_mov_b32 v88, 0
    v_mov_b32 v89, 0
    v_mov_b32 v90, 0
    v_mov_b32 v91, 0
    v_mov_b32 v92, 0
    v_mov_b32 v93, 0
    v_mov_b32 v94, 0
    v_mov_b32 v95, 0
    s_barrier
    ds_read_b128 v[96:99], v137 offset:0
    ds_read_b64_tr_b16 v[104:105], v145 offset:0
    ds_read_b64_tr_b16 v[106:107], v145 offset:512
    ds_read_b128 v[100:103], v137 offset:4096
    ds_read_b64_tr_b16 v[108:109], v145 offset:1024
    ds_read_b64_tr_b16 v[110:111], v145 offset:1536
    ds_read_b64_tr_b16 v[112:113], v145 offset:2048
    ds_read_b64_tr_b16 v[114:115], v145 offset:2560
    s_add_u32 s27, s26, 1572864
    s_mov_b64 exec, 0xfff
    buffer_load_dword v154, v153, s[12:15], s27 offen
    s_mov_b64 exec, 0xff
    buffer_load_dword v154, v153, s[8:11], s25 offen offset:512
    s_add_u32 s27, s26, 3145728
    s_mov_b64 exec, 0xfff
    buffer_load_dword v154, v153, s[12:15], s27 offen
    s_mov_b64 exec, 0xff
    buffer_load_dword v154, v153, s[8:11], s25 offen offset:1024
    s_add_u32 s27, s26, 4718592
    s_mov_b64 exec, 0xfff
    buffer_load_dword v154, v153, s[12:15], s27 offen
    s_mov_b64 exec, 0xff
    buffer_load_dword v154, v153, s[8:11], s25 offen offset:1536
    s_mov_b64 exec, -1
    s_mov_b32 s28, 3
loop_qkv_kernel_7:
    s_waitcnt lgkmcnt(5)
    v_mfma_f32_32x32x16_bf16 v[0:15], v[104:107], v[96:99], v[0:15]
    ds_read_b128 v[116:119], v138 offset:0
    ds_read_b64_tr_b16 v[124:125], v145 offset:6144
    s_waitcnt lgkmcnt(6)
    v_mfma_f32_32x32x16_bf16 v[16:31], v[104:107], v[100:103], v[16:31]
    ds_read_b64_tr_b16 v[126:127], v145 offset:6656
    ds_read_b128 v[120:123], v138 offset:4096
    s_waitcnt lgkmcnt(6)
    v_mfma_f32_32x32x16_bf16 v[32:47], v[108:111], v[96:99], v[32:47]
    ds_read_b64_tr_b16 v[128:129], v145 offset:7168
    ds_read_b64_tr_b16 v[130:131], v145 offset:7680
    v_mfma_f32_32x32x16_bf16 v[48:63], v[108:111], v[100:103], v[48:63]
    ds_read_b64_tr_b16 v[132:133], v145 offset:8192
    ds_read_b64_tr_b16 v[134:135], v145 offset:8704
    s_waitcnt lgkmcnt(8)
    v_mfma_f32_32x32x16_bf16 v[64:79], v[96:99], v[112:115], v[64:79]
    v_mfma_f32_32x32x16_bf16 v[80:95], v[100:103], v[112:115], v[80:95]
    s_waitcnt lgkmcnt(5)
    v_mfma_f32_32x32x16_bf16 v[0:15], v[124:127], v[116:119], v[0:15]
    ds_read_b128 v[96:99], v139 offset:0
    ds_read_b64_tr_b16 v[104:105], v145 offset:12288
    s_waitcnt lgkmcnt(6)
    v_mfma_f32_32x32x16_bf16 v[16:31], v[124:127], v[120:123], v[16:31]
    ds_read_b64_tr_b16 v[106:107], v145 offset:12800
    ds_read_b128 v[100:103], v139 offset:4096
    s_waitcnt lgkmcnt(6)
    v_mfma_f32_32x32x16_bf16 v[32:47], v[128:131], v[116:119], v[32:47]
    ds_read_b64_tr_b16 v[108:109], v145 offset:13312
    ds_read_b64_tr_b16 v[110:111], v145 offset:13824
    v_mfma_f32_32x32x16_bf16 v[48:63], v[128:131], v[120:123], v[48:63]
    ds_read_b64_tr_b16 v[112:113], v145 offset:14336
    ds_read_b64_tr_b16 v[114:115], v145 offset:14848
    s_waitcnt lgkmcnt(8)
    v_mfma_f32_32x32x16_bf16 v[64:79], v[116:119], v[132:135], v[64:79]
    v_mfma_f32_32x32x16_bf16 v[80:95], v[120:123], v[132:135], v[80:95]
    s_waitcnt lgkmcnt(5)
    v_mfma_f32_32x32x16_bf16 v[0:15], v[104:107], v[96:99], v[0:15]
    ds_read_b128 v[116:119], v140 offset:0
    ds_read_b64_tr_b16 v[124:125], v145 offset:18432
    s_waitcnt lgkmcnt(6)
    v_mfma_f32_32x32x16_bf16 v[16:31], v[104:107], v[100:103], v[16:31]
    ds_read_b64_tr_b16 v[126:127], v145 offset:18944
    ds_read_b128 v[120:123], v140 offset:4096
    s_waitcnt lgkmcnt(6)
    v_mfma_f32_32x32x16_bf16 v[32:47], v[108:111], v[96:99], v[32:47]
    ds_read_b64_tr_b16 v[128:129], v145 offset:19456
    ds_read_b64_tr_b16 v[130:131], v145 offset:19968
    v_mfma_f32_32x32x16_bf16 v[48:63], v[108:111], v[100:103], v[48:63]
    ds_read_b64_tr_b16 v[132:133], v145 offset:20480
    ds_read_b64_tr_b16 v[134:135], v145 offset:20992
    s_waitcnt lgkmcnt(8)
    v_mfma_f32_32x32x16_bf16 v[64:79], v[96:99], v[112:115], v[64:79]
    v_mfma_f32_32x32x16_bf16 v[80:95], v[100:103], v[112:115], v[80:95]
    s_waitcnt lgkmcnt(5)
    v_mfma_f32_32x32x16_bf16 v[0:15], v[124:127], v[116:119], v[0:15]
    s_waitcnt lgkmcnt(4)
    v_mfma_f32_32x32x16_bf16 v[16:31], v[124:127], v[120:123], v[16:31]
    s_waitcnt lgkmcnt(0)
    s_barrier
    ds_read_b128 v[96:99], v137 offset:40960
    ds_read_b64_tr_b16 v[104:105], v146 offset:0
    v_mfma_f32_32x32x16_bf16 v[32:47], v[128:131], v[116:119], v[32:47]
    ds_read_b64_tr_b16 v[106:107], v146 offset:512
    ds_read_b128 v[100:103], v137 offset:45056
    v_mfma_f32_32x32x16_bf16 v[48:63], v[128:131], v[120:123], v[48:63]
    ds_read_b64_tr_b16 v[108:109], v146 offset:1024
    ds_read_b64_tr_b16 v[110:111], v146 offset:1536
    v_mfma_f32_32x32x16_bf16 v[64:79], v[116:119], v[132:135], v[64:79]
    ds_read_b64_tr_b16 v[112:113], v146 offset:2048
    ds_read_b64_tr_b16 v[114:115], v146 offset:2560
    v_mfma_f32_32x32x16_bf16 v[80:95], v[120:123], v[132:135], v[80:95]
    s_waitcnt lgkmcnt(5)
    v_mfma_f32_32x32x16_bf16 v[0:15], v[104:107], v[96:99], v[0:15]
    ds_read_b128 v[116:119], v138 offset:40960
    ds_read_b64_tr_b16 v[124:125], v146 offset:6144
    s_waitcnt lgkmcnt(6)
    v_mfma_f32_32x32x16_bf16 v[16:31], v[104:107], v[100:103], v[16:31]
    ds_read_b64_tr_b16 v[126:127], v146 offset:6656
    ds_read_b128 v[120:123], v138 offset:45056
    s_waitcnt lgkmcnt(6)
    v_mfma_f32_32x32x16_bf16 v[32:47], v[108:111], v[96:99], v[32:47]
    ds_read_b64_tr_b16 v[128:129], v146 offset:7168
    ds_read_b64_tr_b16 v[130:131], v146 offset:7680
    v_mfma_f32_32x32x16_bf16 v[48:63], v[108:111], v[100:103], v[48:63]
    ds_read_b64_tr_b16 v[132:133], v146 offset:8192
    ds_read_b64_tr_b16 v[134:135], v146 offset:8704
    s_waitcnt lgkmcnt(8)
    v_mfma_f32_32x32x16_bf16 v[64:79], v[96:99], v[112:115], v[64:79]
    v_mfma_f32_32x32x16_bf16 v[80:95], v[100:103], v[112:115], v[80:95]
    s_waitcnt lgkmcnt(5)
    v_mfma_f32_32x32x16_bf16 v[0:15], v[124:127], v[116:119], v[0:15]
    ds_read_b128 v[96:99], v139 offset:40960
    ds_read_b64_tr_b16 v[104:105], v146 offset:12288
    s_waitcnt lgkmcnt(6)
    v_mfma_f32_32x32x16_bf16 v[16:31], v[124:127], v[120:123], v[16:31]
    ds_read_b64_tr_b16 v[106:107], v146 offset:12800
    ds_read_b128 v[100:103], v139 offset:45056
    s_waitcnt lgkmcnt(6)
    v_mfma_f32_32x32x16_bf16 v[32:47], v[128:131], v[116:119], v[32:47]
    ds_read_b64_tr_b16 v[108:109], v146 offset:13312
    ds_read_b64_tr_b16 v[110:111], v146 offset:13824
    v_mfma_f32_32x32x16_bf16 v[48:63], v[128:131], v[120:123], v[48:63]
    ds_read_b64_tr_b16 v[112:113], v146 offset:14336
    ds_read_b64_tr_b16 v[114:115], v146 offset:14848
    s_waitcnt lgkmcnt(8)
    v_mfma_f32_32x32x16_bf16 v[64:79], v[116:119], v[132:135], v[64:79]
    v_mfma_f32_32x32x16_bf16 v[80:95], v[120:123], v[132:135], v[80:95]
    s_waitcnt lgkmcnt(5)
    v_mfma_f32_32x32x16_bf16 v[0:15], v[104:107], v[96:99], v[0:15]
    ds_read_b128 v[116:119], v140 offset:40960
    ds_read_b64_tr_b16 v[124:125], v146 offset:18432
    s_waitcnt lgkmcnt(6)
    v_mfma_f32_32x32x16_bf16 v[16:31], v[104:107], v[100:103], v[16:31]
    ds_read_b64_tr_b16 v[126:127], v146 offset:18944
    ds_read_b128 v[120:123], v140 offset:45056
    s_waitcnt lgkmcnt(6)
    v_mfma_f32_32x32x16_bf16 v[32:47], v[108:111], v[96:99], v[32:47]
    ds_read_b64_tr_b16 v[128:129], v146 offset:19456
    ds_read_b64_tr_b16 v[130:131], v146 offset:19968
    v_mfma_f32_32x32x16_bf16 v[48:63], v[108:111], v[100:103], v[48:63]
    ds_read_b64_tr_b16 v[132:133], v146 offset:20480
    ds_read_b64_tr_b16 v[134:135], v146 offset:20992
    s_waitcnt lgkmcnt(8)
    v_mfma_f32_32x32x16_bf16 v[64:79], v[96:99], v[112:115], v[64:79]
    v_mfma_f32_32x32x16_bf16 v[80:95], v[100:103], v[112:115], v[80:95]
    s_waitcnt lgkmcnt(5)
    v_mfma_f32_32x32x16_bf16 v[0:15], v[124:127], v[116:119], v[0:15]
    s_waitcnt lgkmcnt(4)
    v_mfma_f32_32x32x16_bf16 v[16:31], v[124:127], v[120:123], v[16:31]
    s_waitcnt lgkmcnt(0)
    s_barrier
    ds_read_b128 v[96:99], v141 offset:0
    ds_read_b64_tr_b16 v[104:105], v147 offset:0
    v_mfma_f32_32x32x16_bf16 v[32:47], v[128:131], v[116:119], v[32:47]
    ds_read_b64_tr_b16 v[106:107], v147 offset:512
    ds_read_b128 v[100:103], v141 offset:4096
    v_mfma_f32_32x32x16_bf16 v[48:63], v[128:131], v[120:123], v[48:63]
    ds_read_b64_tr_b16 v[108:109], v147 offset:1024
    ds_read_b64_tr_b16 v[110:111], v147 offset:1536
    v_mfma_f32_32x32x16_bf16 v[64:79], v[116:119], v[132:135], v[64:79]
    ds_read_b64_tr_b16 v[112:113], v147 offset:2048
    ds_read_b64_tr_b16 v[114:115], v147 offset:2560
    v_mfma_f32_32x32x16_bf16 v[80:95], v[120:123], v[132:135], v[80:95]
    s_waitcnt lgkmcnt(5)
    v_mfma_f32_32x32x16_bf16 v[0:15], v[104:107], v[96:99], v[0:15]
    ds_read_b128 v[116:119], v142 offset:0
    ds_read_b64_tr_b16 v[124:125], v147 offset:6144
    s_waitcnt lgkmcnt(6)
    v_mfma_f32_32x32x16_bf16 v[16:31], v[104:107], v[100:103], v[16:31]
    ds_read_b64_tr_b16 v[126:127], v147 offset:6656
    ds_read_b128 v[120:123], v142 offset:4096
    s_waitcnt lgkmcnt(6)
    v_mfma_f32_32x32x16_bf16 v[32:47], v[108:111], v[96:99], v[32:47]
    ds_read_b64_tr_b16 v[128:129], v147 offset:7168
    ds_read_b64_tr_b16 v[130:131], v147 offset:7680
    v_mfma_f32_32x32x16_bf16 v[48:63], v[108:111], v[100:103], v[48:63]
    ds_read_b64_tr_b16 v[132:133], v147 offset:8192
    ds_read_b64_tr_b16 v[134:135], v147 offset:8704
    s_waitcnt lgkmcnt(8)
    v_mfma_f32_32x32x16_bf16 v[64:79], v[96:99], v[112:115], v[64:79]
    v_mfma_f32_32x32x16_bf16 v[80:95], v[100:103], v[112:115], v[80:95]
    s_waitcnt lgkmcnt(5)
    v_mfma_f32_32x32x16_bf16 v[0:15], v[124:127], v[116:119], v[0:15]
    ds_read_b128 v[96:99], v143 offset:0
    ds_read_b64_tr_b16 v[104:105], v147 offset:12288
    s_waitcnt lgkmcnt(6)
    v_mfma_f32_32x32x16_bf16 v[16:31], v[124:127], v[120:123], v[16:31]
    ds_read_b64_tr_b16 v[106:107], v147 offset:12800
    ds_read_b128 v[100:103], v143 offset:4096
    s_waitcnt lgkmcnt(6)
    v_mfma_f32_32x32x16_bf16 v[32:47], v[128:131], v[116:119], v[32:47]
    ds_read_b64_tr_b16 v[108:109], v147 offset:13312
    ds_read_b64_tr_b16 v[110:111], v147 offset:13824
    v_mfma_f32_32x32x16_bf16 v[48:63], v[128:131], v[120:123], v[48:63]
    ds_read_b64_tr_b16 v[112:113], v147 offset:14336
    ds_read_b64_tr_b16 v[114:115], v147 offset:14848
    s_waitcnt lgkmcnt(8)
    v_mfma_f32_32x32x16_bf16 v[64:79], v[116:119], v[132:135], v[64:79]
    v_mfma_f32_32x32x16_bf16 v[80:95], v[120:123], v[132:135], v[80:95]
    s_waitcnt lgkmcnt(5)
    v_mfma_f32_32x32x16_bf16 v[0:15], v[104:107], v[96:99], v[0:15]
    ds_read_b128 v[116:119], v144 offset:0
    ds_read_b64_tr_b16 v[124:125], v147 offset:18432
    s_waitcnt lgkmcnt(6)
    v_mfma_f32_32x32x16_bf16 v[16:31], v[104:107], v[100:103], v[16:31]
    ds_read_b64_tr_b16 v[126:127], v147 offset:18944
    ds_read_b128 v[120:123], v144 offset:4096
    s_waitcnt lgkmcnt(6)
    v_mfma_f32_32x32x16_bf16 v[32:47], v[108:111], v[96:99], v[32:47]
    ds_read_b64_tr_b16 v[128:129], v147 offset:19456
    ds_read_b64_tr_b16 v[130:131], v147 offset:19968
    v_mfma_f32_32x32x16_bf16 v[48:63], v[108:111], v[100:103], v[48:63]
    ds_read_b64_tr_b16 v[132:133], v147 offset:20480
    ds_read_b64_tr_b16 v[134:135], v147 offset:20992
    s_waitcnt lgkmcnt(8)
    v_mfma_f32_32x32x16_bf16 v[64:79], v[96:99], v[112:115], v[64:79]
    v_mfma_f32_32x32x16_bf16 v[80:95], v[100:103], v[112:115], v[80:95]
    s_waitcnt lgkmcnt(5)
    v_mfma_f32_32x32x16_bf16 v[0:15], v[124:127], v[116:119], v[0:15]
    s_waitcnt lgkmcnt(4)
    v_mfma_f32_32x32x16_bf16 v[16:31], v[124:127], v[120:123], v[16:31]
    s_waitcnt lgkmcnt(0)
    s_barrier
    ds_read_b128 v[96:99], v141 offset:40960
    ds_read_b64_tr_b16 v[104:105], v148 offset:0
    v_mfma_f32_32x32x16_bf16 v[32:47], v[128:131], v[116:119], v[32:47]
    ds_read_b64_tr_b16 v[106:107], v148 offset:512
    ds_read_b128 v[100:103], v141 offset:45056
    v_mfma_f32_32x32x16_bf16 v[48:63], v[128:131], v[120:123], v[48:63]
    ds_read_b64_tr_b16 v[108:109], v148 offset:1024
    ds_read_b64_tr_b16 v[110:111], v148 offset:1536
    v_mfma_f32_32x32x16_bf16 v[64:79], v[116:119], v[132:135], v[64:79]
    ds_read_b64_tr_b16 v[112:113], v148 offset:2048
    ds_read_b64_tr_b16 v[114:115], v148 offset:2560
    v_mfma_f32_32x32x16_bf16 v[80:95], v[120:123], v[132:135], v[80:95]
    s_waitcnt lgkmcnt(5)
    v_mfma_f32_32x32x16_bf16 v[0:15], v[104:107], v[96:99], v[0:15]
    ds_read_b128 v[116:119], v142 offset:40960
    ds_read_b64_tr_b16 v[124:125], v148 offset:6144
    s_waitcnt lgkmcnt(6)
    v_mfma_f32_32x32x16_bf16 v[16:31], v[104:107], v[100:103], v[16:31]
    ds_read_b64_tr_b16 v[126:127], v148 offset:6656
    ds_read_b128 v[120:123], v142 offset:45056
    s_waitcnt lgkmcnt(6)
    v_mfma_f32_32x32x16_bf16 v[32:47], v[108:111], v[96:99], v[32:47]
    ds_read_b64_tr_b16 v[128:129], v148 offset:7168
    ds_read_b64_tr_b16 v[130:131], v148 offset:7680
    v_mfma_f32_32x32x16_bf16 v[48:63], v[108:111], v[100:103], v[48:63]
    ds_read_b64_tr_b16 v[132:133], v148 offset:8192
    ds_read_b64_tr_b16 v[134:135], v148 offset:8704
    s_waitcnt lgkmcnt(8)
    v_mfma_f32_32x32x16_bf16 v[64:79], v[96:99], v[112:115], v[64:79]
    v_mfma_f32_32x32x16_bf16 v[80:95], v[100:103], v[112:115], v[80:95]
    s_waitcnt lgkmcnt(5)
    v_mfma_f32_32x32x16_bf16 v[0:15], v[124:127], v[116:119], v[0:15]
    ds_read_b128 v[96:99], v143 offset:40960
    ds_read_b64_tr_b16 v[104:105], v148 offset:12288
    s_waitcnt lgkmcnt(6)
    v_mfma_f32_32x32x16_bf16 v[16:31], v[124:127], v[120:123], v[16:31]
    ds_read_b64_tr_b16 v[106:107], v148 offset:12800
    ds_read_b128 v[100:103], v143 offset:45056
    s_waitcnt lgkmcnt(6)
    v_mfma_f32_32x32x16_bf16 v[32:47], v[128:131], v[116:119], v[32:47]
    ds_read_b64_tr_b16 v[108:109], v148 offset:13312
    ds_read_b64_tr_b16 v[110:111], v148 offset:13824
    v_mfma_f32_32x32x16_bf16 v[48:63], v[128:131], v[120:123], v[48:63]
    ds_read_b64_tr_b16 v[112:113], v148 offset:14336
    ds_read_b64_tr_b16 v[114:115], v148 offset:14848
    s_waitcnt lgkmcnt(8)
    v_mfma_f32_32x32x16_bf16 v[64:79], v[116:119], v[132:135], v[64:79]
    v_mfma_f32_32x32x16_bf16 v[80:95], v[120:123], v[132:135], v[80:95]
    s_waitcnt lgkmcnt(5)
    v_mfma_f32_32x32x16_bf16 v[0:15], v[104:107], v[96:99], v[0:15]
    ds_read_b128 v[116:119], v144 offset:40960
    ds_read_b64_tr_b16 v[124:125], v148 offset:18432
    s_waitcnt lgkmcnt(6)
    v_mfma_f32_32x32x16_bf16 v[16:31], v[104:107], v[100:103], v[16:31]
    ds_read_b64_tr_b16 v[126:127], v148 offset:18944
    ds_read_b128 v[120:123], v144 offset:45056
    s_waitcnt lgkmcnt(6)
    v_mfma_f32_32x32x16_bf16 v[32:47], v[108:111], v[96:99], v[32:47]
    ds_read_b64_tr_b16 v[128:129], v148 offset:19456
    ds_read_b64_tr_b16 v[130:131], v148 offset:19968
    v_mfma_f32_32x32x16_bf16 v[48:63], v[108:111], v[100:103], v[48:63]
    ds_read_b64_tr_b16 v[132:133], v148 offset:20480
    ds_read_b64_tr_b16 v[134:135], v148 offset:20992
    s_waitcnt lgkmcnt(8)
    v_mfma_f32_32x32x16_bf16 v[64:79], v[96:99], v[112:115], v[64:79]
    v_mfma_f32_32x32x16_bf16 v[80:95], v[100:103], v[112:115], v[80:95]
    s_waitcnt lgkmcnt(5)
    v_mfma_f32_32x32x16_bf16 v[0:15], v[124:127], v[116:119], v[0:15]
    s_waitcnt lgkmcnt(4)
    v_mfma_f32_32x32x16_bf16 v[16:31], v[124:127], v[120:123], v[16:31]
    s_waitcnt lgkmcnt(0)
    s_barrier
    ds_read_b128 v[96:99], v137 offset:0
    ds_read_b64_tr_b16 v[104:105], v145 offset:0
    v_mfma_f32_32x32x16_bf16 v[32:47], v[128:131], v[116:119], v[32:47]
    ds_read_b64_tr_b16 v[106:107], v145 offset:512
    ds_read_b128 v[100:103], v137 offset:4096
    v_mfma_f32_32x32x16_bf16 v[48:63], v[128:131], v[120:123], v[48:63]
    ds_read_b64_tr_b16 v[108:109], v145 offset:1024
    ds_read_b64_tr_b16 v[110:111], v145 offset:1536
    v_mfma_f32_32x32x16_bf16 v[64:79], v[116:119], v[132:135], v[64:79]
    ds_read_b64_tr_b16 v[112:113], v145 offset:2048
    ds_read_b64_tr_b16 v[114:115], v145 offset:2560
    v_mfma_f32_32x32x16_bf16 v[80:95], v[120:123], v[132:135], v[80:95]
    s_sub_u32 s28, s28, 1
    s_cmp_lg_u32 s28, 0
    s_cbranch_scc1 loop_qkv_kernel_7
    s_waitcnt lgkmcnt(5)
    v_mfma_f32_32x32x16_bf16 v[0:15], v[104:107], v[96:99], v[0:15]
    ds_read_b128 v[116:119], v138 offset:0
    ds_read_b64_tr_b16 v[124:125], v145 offset:6144
    s_waitcnt lgkmcnt(6)
    v_mfma_f32_32x32x16_bf16 v[16:31], v[104:107], v[100:103], v[16:31]
    ds_read_b64_tr_b16 v[126:127], v145 offset:6656
    ds_read_b128 v[120:123], v138 offset:4096
    s_waitcnt lgkmcnt(6)
    v_mfma_f32_32x32x16_bf16 v[32:47], v[108:111], v[96:99], v[32:47]
    ds_read_b64_tr_b16 v[128:129], v145 offset:7168
    ds_read_b64_tr_b16 v[130:131], v145 offset:7680
    v_mfma_f32_32x32x16_bf16 v[48:63], v[108:111], v[100:103], v[48:63]
    ds_read_b64_tr_b16 v[132:133], v145 offset:8192
    ds_read_b64_tr_b16 v[134:135], v145 offset:8704
    s_waitcnt lgkmcnt(8)
    v_mfma_f32_32x32x16_bf16 v[64:79], v[96:99], v[112:115], v[64:79]
    v_mfma_f32_32x32x16_bf16 v[80:95], v[100:103], v[112:115], v[80:95]
    s_waitcnt lgkmcnt(5)
    v_mfma_f32_32x32x16_bf16 v[0:15], v[124:127], v[116:119], v[0:15]
    ds_read_b128 v[96:99], v139 offset:0
    ds_read_b64_tr_b16 v[104:105], v145 offset:12288
    s_waitcnt lgkmcnt(6)
    v_mfma_f32_32x32x16_bf16 v[16:31], v[124:127], v[120:123], v[16:31]
    ds_read_b64_tr_b16 v[106:107], v145 offset:12800
    ds_read_b128 v[100:103], v139 offset:4096
    s_waitcnt lgkmcnt(6)
    v_mfma_f32_32x32x16_bf16 v[32:47], v[128:131], v[116:119], v[32:47]
    ds_read_b64_tr_b16 v[108:109], v145 offset:13312
    ds_read_b64_tr_b16 v[110:111], v145 offset:13824
    v_mfma_f32_32x32x16_bf16 v[48:63], v[128:131], v[120:123], v[48:63]
    ds_read_b64_tr_b16 v[112:113], v145 offset:14336
    ds_read_b64_tr_b16 v[114:115], v145 offset:14848
    s_waitcnt lgkmcnt(8)
    v_mfma_f32_32x32x16_bf16 v[64:79], v[116:119], v[132:135], v[64:79]
    v_mfma_f32_32x32x16_bf16 v[80:95], v[120:123], v[132:135], v[80:95]
    s_waitcnt lgkmcnt(5)
    v_mfma_f32_32x32x16_bf16 v[0:15], v[104:107], v[96:99], v[0:15]
    ds_read_b128 v[116:119], v140 offset:0
    ds_read_b64_tr_b16 v[124:125], v145 offset:18432
    s_waitcnt lgkmcnt(6)
    v_mfma_f32_32x32x16_bf16 v[16:31], v[104:107], v[100:103], v[16:31]
    ds_read_b64_tr_b16 v[126:127], v145 offset:18944
    ds_read_b128 v[120:123], v140 offset:4096
    s_waitcnt lgkmcnt(6)
    v_mfma_f32_32x32x16_bf16 v[32:47], v[108:111], v[96:99], v[32:47]
    ds_read_b64_tr_b16 v[128:129], v145 offset:19456
    ds_read_b64_tr_b16 v[130:131], v145 offset:19968
    v_mfma_f32_32x32x16_bf16 v[48:63], v[108:111], v[100:103], v[48:63]
    ds_read_b64_tr_b16 v[132:133], v145 offset:20480
    ds_read_b64_tr_b16 v[134:135], v145 offset:20992
    s_waitcnt lgkmcnt(8)
    v_mfma_f32_32x32x16_bf16 v[64:79], v[96:99], v[112:115], v[64:79]
    v_mfma_f32_32x32x16_bf16 v[80:95], v[100:103], v[112:115], v[80:95]
    s_waitcnt lgkmcnt(5)
    v_mfma_f32_32x32x16_bf16 v[0:15], v[124:127], v[116:119], v[0:15]
    s_waitcnt lgkmcnt(4)
    v_mfma_f32_32x32x16_bf16 v[16:31], v[124:127], v[120:123], v[16:31]
    s_waitcnt lgkmcnt(0)
    s_barrier
    ds_read_b128 v[96:99], v137 offset:40960
    ds_read_b64_tr_b16 v[104:105], v146 offset:0
    v_mfma_f32_32x32x16_bf16 v[32:47], v[128:131], v[116:119], v[32:47]
    ds_read_b64_tr_b16 v[106:107], v146 offset:512
    ds_read_b128 v[100:103], v137 offset:45056
    v_mfma_f32_32x32x16_bf16 v[48:63], v[128:131], v[120:123], v[48:63]
    ds_read_b64_tr_b16 v[108:109], v146 offset:1024
    ds_read_b64_tr_b16 v[110:111], v146 offset:1536
    v_mfma_f32_32x32x16_bf16 v[64:79], v[116:119], v[132:135], v[64:79]
    ds_read_b64_tr_b16 v[112:113], v146 offset:2048
    ds_read_b64_tr_b16 v[114:115], v146 offset:2560
    v_mfma_f32_32x32x16_bf16 v[80:95], v[120:123], v[132:135], v[80:95]
    s_waitcnt lgkmcnt(5)
    v_mfma_f32_32x32x16_bf16 v[0:15], v[104:107], v[96:99], v[0:15]
    ds_read_b128 v[116:119], v138 offset:40960
    ds_read_b64_tr_b16 v[124:125], v146 offset:6144
    s_waitcnt lgkmcnt(6)
    v_mfma_f32_32x32x16_bf16 v[16:31], v[104:107], v[100:103], v[16:31]
    ds_read_b64_tr_b16 v[126:127], v146 offset:6656
    ds_read_b128 v[120:123], v138 offset:45056
    s_waitcnt lgkmcnt(6)
    v_mfma_f32_32x32x16_bf16 v[32:47], v[108:111], v[96:99], v[32:47]
    ds_read_b64_tr_b16 v[128:129], v146 offset:7168
    ds_read_b64_tr_b16 v[130:131], v146 offset:7680
    v_mfma_f32_32x32x16_bf16 v[48:63], v[108:111], v[100:103], v[48:63]
    ds_read_b64_tr_b16 v[132:133], v146 offset:8192
    ds_read_b64_tr_b16 v[134:135], v146 offset:8704
    s_waitcnt lgkmcnt(8)
    v_mfma_f32_32x32x16_bf16 v[64:79], v[96:99], v[112:115], v[64:79]
    v_mfma_f32_32x32x16_bf16 v[80:95], v[100:103], v[112:115], v[80:95]
    s_waitcnt lgkmcnt(5)
    v_mfma_f32_32x32x16_bf16 v[0:15], v[124:127], v[116:119], v[0:15]
    ds_read_b128 v[96:99], v139 offset:40960
    ds_read_b64_tr_b16 v[104:105], v146 offset:12288
    s_waitcnt lgkmcnt(6)
    v_mfma_f32_32x32x16_bf16 v[16:31], v[124:127], v[120:123], v[16:31]
    ds_read_b64_tr_b16 v[106:107], v146 offset:12800
    ds_read_b128 v[100:103], v139 offset:45056
    s_waitcnt lgkmcnt(6)
    v_mfma_f32_32x32x16_bf16 v[32:47], v[128:131], v[116:119], v[32:47]
    ds_read_b64_tr_b16 v[108:109], v146 offset:13312
    ds_read_b64_tr_b16 v[110:111], v146 offset:13824
    v_mfma_f32_32x32x16_bf16 v[48:63], v[128:131], v[120:123], v[48:63]
    ds_read_b64_tr_b16 v[112:113], v146 offset:14336
    ds_read_b64_tr_b16 v[114:115], v146 offset:14848
    s_waitcnt lgkmcnt(8)
    v_mfma_f32_32x32x16_bf16 v[64:79], v[116:119], v[132:135], v[64:79]
    v_mfma_f32_32x32x16_bf16 v[80:95], v[120:123], v[132:135], v[80:95]
    s_waitcnt lgkmcnt(5)
    v_mfma_f32_32x32x16_bf16 v[0:15], v[104:107], v[96:99], v[0:15]
    ds_read_b128 v[116:119], v140 offset:40960
    ds_read_b64_tr_b16 v[124:125], v146 offset:18432
    s_waitcnt lgkmcnt(6)
    v_mfma_f32_32x32x16_bf16 v[16:31], v[104:107], v[100:103], v[16:31]
    ds_read_b64_tr_b16 v[126:127], v146 offset:18944
    ds_read_b128 v[120:123], v140 offset:45056
    s_waitcnt lgkmcnt(6)
    v_mfma_f32_32x32x16_bf16 v[32:47], v[108:111], v[96:99], v[32:47]
    ds_read_b64_tr_b16 v[128:129], v146 offset:19456
    ds_read_b64_tr_b16 v[130:131], v146 offset:19968
    v_mfma_f32_32x32x16_bf16 v[48:63], v[108:111], v[100:103], v[48:63]
    ds_read_b64_tr_b16 v[132:133], v146 offset:20480
    ds_read_b64_tr_b16 v[134:135], v146 offset:20992
    s_waitcnt lgkmcnt(8)
    v_mfma_f32_32x32x16_bf16 v[64:79], v[96:99], v[112:115], v[64:79]
    v_mfma_f32_32x32x16_bf16 v[80:95], v[100:103], v[112:115], v[80:95]
    s_waitcnt lgkmcnt(5)
    v_mfma_f32_32x32x16_bf16 v[0:15], v[124:127], v[116:119], v[0:15]
    s_waitcnt lgkmcnt(4)
    v_mfma_f32_32x32x16_bf16 v[16:31], v[124:127], v[120:123], v[16:31]
    s_waitcnt lgkmcnt(0)
    s_barrier
    ds_read_b128 v[96:99], v141 offset:0
    ds_read_b64_tr_b16 v[104:105], v147 offset:0
    v_mfma_f32_32x32x16_bf16 v[32:47], v[128:131], v[116:119], v[32:47]
    ds_read_b64_tr_b16 v[106:107], v147 offset:512
    ds_read_b128 v[100:103], v141 offset:4096
    v_mfma_f32_32x32x16_bf16 v[48:63], v[128:131], v[120:123], v[48:63]
    ds_read_b64_tr_b16 v[108:109], v147 offset:1024
    ds_read_b64_tr_b16 v[110:111], v147 offset:1536
    v_mfma_f32_32x32x16_bf16 v[64:79], v[116:119], v[132:135], v[64:79]
    ds_read_b64_tr_b16 v[112:113], v147 offset:2048
    ds_read_b64_tr_b16 v[114:115], v147 offset:2560
    v_mfma_f32_32x32x16_bf16 v[80:95], v[120:123], v[132:135], v[80:95]
    s_waitcnt lgkmcnt(5)
    v_mfma_f32_32x32x16_bf16 v[0:15], v[104:107], v[96:99], v[0:15]
    ds_read_b128 v[116:119], v142 offset:0
    ds_read_b64_tr_b16 v[124:125], v147 offset:6144
    s_waitcnt lgkmcnt(6)
    v_mfma_f32_32x32x16_bf16 v[16:31], v[104:107], v[100:103], v[16:31]
    ds_read_b64_tr_b16 v[126:127], v147 offset:6656
    ds_read_b128 v[120:123], v142 offset:4096
    s_waitcnt lgkmcnt(6)
    v_mfma_f32_32x32x16_bf16 v[32:47], v[108:111], v[96:99], v[32:47]
    ds_read_b64_tr_b16 v[128:129], v147 offset:7168
    ds_read_b64_tr_b16 v[130:131], v147 offset:7680
    v_mfma_f32_32x32x16_bf16 v[48:63], v[108:111], v[100:103], v[48:63]
    ds_read_b64_tr_b16 v[132:133], v147 offset:8192
    ds_read_b64_tr_b16 v[134:135], v147 offset:8704
    s_waitcnt lgkmcnt(8)
    v_mfma_f32_32x32x16_bf16 v[64:79], v[96:99], v[112:115], v[64:79]
    v_mfma_f32_32x32x16_bf16 v[80:95], v[100:103], v[112:115], v[80:95]
    s_waitcnt lgkmcnt(5)
    v_mfma_f32_32x32x16_bf16 v[0:15], v[124:127], v[116:119], v[0:15]
    ds_read_b128 v[96:99], v143 offset:0
    ds_read_b64_tr_b16 v[104:105], v147 offset:12288
    s_waitcnt lgkmcnt(6)
    v_mfma_f32_32x32x16_bf16 v[16:31], v[124:127], v[120:123], v[16:31]
    ds_read_b64_tr_b16 v[106:107], v147 offset:12800
    ds_read_b128 v[100:103], v143 offset:4096
    s_waitcnt lgkmcnt(6)
    v_mfma_f32_32x32x16_bf16 v[32:47], v[128:131], v[116:119], v[32:47]
    ds_read_b64_tr_b16 v[108:109], v147 offset:13312
    ds_read_b64_tr_b16 v[110:111], v147 offset:13824
    v_mfma_f32_32x32x16_bf16 v[48:63], v[128:131], v[120:123], v[48:63]
    ds_read_b64_tr_b16 v[112:113], v147 offset:14336
    ds_read_b64_tr_b16 v[114:115], v147 offset:14848
    s_waitcnt lgkmcnt(8)
    v_mfma_f32_32x32x16_bf16 v[64:79], v[116:119], v[132:135], v[64:79]
    v_mfma_f32_32x32x16_bf16 v[80:95], v[120:123], v[132:135], v[80:95]
    s_waitcnt lgkmcnt(5)
    v_mfma_f32_32x32x16_bf16 v[0:15], v[104:107], v[96:99], v[0:15]
    ds_read_b128 v[116:119], v144 offset:0
    ds_read_b64_tr_b16 v[124:125], v147 offset:18432
    s_waitcnt lgkmcnt(6)
    v_mfma_f32_32x32x16_bf16 v[16:31], v[104:107], v[100:103], v[16:31]
    ds_read_b64_tr_b16 v[126:127], v147 offset:18944
    ds_read_b128 v[120:123], v144 offset:4096
    s_waitcnt lgkmcnt(6)
    v_mfma_f32_32x32x16_bf16 v[32:47], v[108:111], v[96:99], v[32:47]
    ds_read_b64_tr_b16 v[128:129], v147 offset:19456
    ds_read_b64_tr_b16 v[130:131], v147 offset:19968
    v_mfma_f32_32x32x16_bf16 v[48:63], v[108:111], v[100:103], v[48:63]
    ds_read_b64_tr_b16 v[132:133], v147 offset:20480
    ds_read_b64_tr_b16 v[134:135], v147 offset:20992
    s_waitcnt lgkmcnt(8)
    v_mfma_f32_32x32x16_bf16 v[64:79], v[96:99], v[112:115], v[64:79]
    v_mfma_f32_32x32x16_bf16 v[80:95], v[100:103], v[112:115], v[80:95]
    s_waitcnt lgkmcnt(5)
    v_mfma_f32_32x32x16_bf16 v[0:15], v[124:127], v[116:119], v[0:15]
    s_waitcnt lgkmcnt(4)
    v_mfma_f32_32x32x16_bf16 v[16:31], v[124:127], v[120:123], v[16:31]
    s_waitcnt lgkmcnt(0)
    s_barrier
    ds_read_b128 v[96:99], v141 offset:40960
    ds_read_b64_tr_b16 v[104:105], v148 offset:0
    v_mfma_f32_32x32x16_bf16 v[32:47], v[128:131], v[116:119], v[32:47]
    ds_read_b64_tr_b16 v[106:107], v148 offset:512
    ds_read_b128 v[100:103], v141 offset:45056
    v_mfma_f32_32x32x16_bf16 v[48:63], v[128:131], v[120:123], v[48:63]
    ds_read_b64_tr_b16 v[108:109], v148 offset:1024
    ds_read_b64_tr_b16 v[110:111], v148 offset:1536
    v_mfma_f32_32x32x16_bf16 v[64:79], v[116:119], v[132:135], v[64:79]
    ds_read_b64_tr_b16 v[112:113], v148 offset:2048
    ds_read_b64_tr_b16 v[114:115], v148 offset:2560
    v_mfma_f32_32x32x16_bf16 v[80:95], v[120:123], v[132:135], v[80:95]
    s_waitcnt lgkmcnt(5)
    v_mfma_f32_32x32x16_bf16 v[0:15], v[104:107], v[96:99], v[0:15]
    ds_read_b128 v[116:119], v142 offset:40960
    ds_read_b64_tr_b16 v[124:125], v148 offset:6144
    s_waitcnt lgkmcnt(6)
    v_mfma_f32_32x32x16_bf16 v[16:31], v[104:107], v[100:103], v[16:31]
    ds_read_b64_tr_b16 v[126:127], v148 offset:6656
    ds_read_b128 v[120:123], v142 offset:45056
    s_waitcnt lgkmcnt(6)
    v_mfma_f32_32x32x16_bf16 v[32:47], v[108:111], v[96:99], v[32:47]
    ds_read_b64_tr_b16 v[128:129], v148 offset:7168
    ds_read_b64_tr_b16 v[130:131], v148 offset:7680
    v_mfma_f32_32x32x16_bf16 v[48:63], v[108:111], v[100:103], v[48:63]
    ds_read_b64_tr_b16 v[132:133], v148 offset:8192
    ds_read_b64_tr_b16 v[134:135], v148 offset:8704
    s_waitcnt lgkmcnt(8)
    v_mfma_f32_32x32x16_bf16 v[64:79], v[96:99], v[112:115], v[64:79]
    v_mfma_f32_32x32x16_bf16 v[80:95], v[100:103], v[112:115], v[80:95]
    s_waitcnt lgkmcnt(5)
    v_mfma_f32_32x32x16_bf16 v[0:15], v[124:127], v[116:119], v[0:15]
    ds_read_b128 v[96:99], v143 offset:40960
    ds_read_b64_tr_b16 v[104:105], v148 offset:12288
    s_waitcnt lgkmcnt(6)
    v_mfma_f32_32x32x16_bf16 v[16:31], v[124:127], v[120:123], v[16:31]
    ds_read_b64_tr_b16 v[106:107], v148 offset:12800
    ds_read_b128 v[100:103], v143 offset:45056
    s_waitcnt lgkmcnt(6)
    v_mfma_f32_32x32x16_bf16 v[32:47], v[128:131], v[116:119], v[32:47]
    ds_read_b64_tr_b16 v[108:109], v148 offset:13312
    ds_read_b64_tr_b16 v[110:111], v148 offset:13824
    v_mfma_f32_32x32x16_bf16 v[48:63], v[128:131], v[120:123], v[48:63]
    ds_read_b64_tr_b16 v[112:113], v148 offset:14336
    ds_read_b64_tr_b16 v[114:115], v148 offset:14848
    s_waitcnt lgkmcnt(8)
    v_mfma_f32_32x32x16_bf16 v[64:79], v[116:119], v[132:135], v[64:79]
    v_mfma_f32_32x32x16_bf16 v[80:95], v[120:123], v[132:135], v[80:95]
    s_waitcnt lgkmcnt(5)
    v_mfma_f32_32x32x16_bf16 v[0:15], v[104:107], v[96:99], v[0:15]
    ds_read_b128 v[116:119], v144 offset:40960
    ds_read_b64_tr_b16 v[124:125], v148 offset:18432
    s_waitcnt lgkmcnt(6)
    v_mfma_f32_32x32x16_bf16 v[16:31], v[104:107], v[100:103], v[16:31]
    ds_read_b64_tr_b16 v[126:127], v148 offset:18944
    ds_read_b128 v[120:123], v144 offset:45056
    s_waitcnt lgkmcnt(6)
    v_mfma_f32_32x32x16_bf16 v[32:47], v[108:111], v[96:99], v[32:47]
    ds_read_b64_tr_b16 v[128:129], v148 offset:19456
    ds_read_b64_tr_b16 v[130:131], v148 offset:19968
    v_mfma_f32_32x32x16_bf16 v[48:63], v[108:111], v[100:103], v[48:63]
    ds_read_b64_tr_b16 v[132:133], v148 offset:20480
    ds_read_b64_tr_b16 v[134:135], v148 offset:20992
    s_waitcnt lgkmcnt(8)
    v_mfma_f32_32x32x16_bf16 v[64:79], v[96:99], v[112:115], v[64:79]
    v_mfma_f32_32x32x16_bf16 v[80:95], v[100:103], v[112:115], v[80:95]
    s_waitcnt lgkmcnt(5)
    v_mfma_f32_32x32x16_bf16 v[0:15], v[124:127], v[116:119], v[0:15]
    s_waitcnt lgkmcnt(4)
    v_mfma_f32_32x32x16_bf16 v[16:31], v[124:127], v[120:123], v[16:31]
    s_waitcnt lgkmcnt(2)
    v_mfma_f32_32x32x16_bf16 v[32:47], v[128:131], v[116:119], v[32:47]
    v_mfma_f32_32x32x16_bf16 v[48:63], v[128:131], v[120:123], v[48:63]
    s_waitcnt lgkmcnt(0)
    v_mfma_f32_32x32x16_bf16 v[64:79], v[116:119], v[132:135], v[64:79]
    v_mfma_f32_32x32x16_bf16 v[80:95], v[120:123], v[132:135], v[80:95]
    s_waitcnt vmcnt(0) lgkmcnt(0)
    s_nop 14
    s_add_u32 s8, s36, 4194304
    s_addc_u32 s9, s37, 0
    s_and_b32 s9, s9, 0xffff
    s_mov_b32 s10, 12582912
    s_mov_b32 s11, 0x00020000
    s_lshl_b32 s22, s18, 1
    s_add_u32 s22, s22, s20
    s_lshl_b32 s22, s22, 6
    s_lshl_b32 s23, s17, 2
    s_add_u32 s22, s22, s23
    s_lshl_b32 s23, s21, 1
    s_add_u32 s22, s22, s23
    s_lshl_b32 s22, s22, 11
    v_lshlrev_b32 v137, 4, v136
    v_and_b32 v138, 31, v136
    v_lshrrev_b32 v139, 5, v136
    s_lshl_b32 s23, s21, 8
    s_lshl_b32 s24, s20, 7
    s_add_u32 s24, s24, 1024
    v_and_b32 v141, 0x13, v136
    v_bfe_u32 v150, v136, 2, 1
    v_lshl_add_u32 v141, v150, 3, v141
    v_bfe_u32 v150, v136, 3, 1
    v_lshl_add_u32 v141, v150, 2, v141
    v_lshl_add_u32 v141, v141, 2, s24
    v_lshl_add_u32 v138, v138, 2, s23
    v_lshl_add_u32 v140, v139, 4, s23
    v_lshl_add_u32 v139, v139, 5, s24
    s_barrier
    ds_read_b32 v128, v138 offset:0
    ds_read_b32 v130, v138 offset:512
    ds_read_b32 v132, v138 offset:128
    ds_read_b32 v134, v138 offset:640
    ds_read_b128 v[96:99], v139 offset:0
    ds_read_b128 v[100:103], v139 offset:16
    ds_read_b128 v[104:107], v139 offset:64
    ds_read_b128 v[108:111], v139 offset:80
    ds_read_b128 v[112:115], v139 offset:256
    ds_read_b128 v[116:119], v139 offset:272
    ds_read_b128 v[120:123], v139 offset:320
    ds_read_b128 v[124:127], v139 offset:336
    ds_read_b32 v150, v141 offset:512
    s_mov_b32 s29, 0x3e8293ee
    s_waitcnt lgkmcnt(0)
    s_add_u32 s22, s22, 4194304
    v_pk_mul_f32 v[32:33], v[32:33], v[128:129] op_sel_hi:[1,0]
    v_pk_fma_f32 v[32:33], v[112:113], v[130:131], v[32:33] op_sel_hi:[1,0,1]
    v_pk_mul_f32 v[34:35], v[34:35], v[128:129] op_sel_hi:[1,0]
    v_pk_fma_f32 v[34:35], v[114:115], v[130:131], v[34:35] op_sel_hi:[1,0,1]
    v_pk_mul_f32 v[36:37], v[36:37], v[128:129] op_sel_hi:[1,0]
    v_pk_fma_f32 v[36:37], v[116:117], v[130:131], v[36:37] op_sel_hi:[1,0,1]
    v_pk_mul_f32 v[38:39], v[38:39], v[128:129] op_sel_hi:[1,0]
    v_pk_fma_f32 v[38:39], v[118:119], v[130:131], v[38:39] op_sel_hi:[1,0,1]
    v_pk_mul_f32 v[40:41], v[40:41], v[128:129] op_sel_hi:[1,0]
    v_pk_fma_f32 v[40:41], v[120:121], v[130:131], v[40:41] op_sel_hi:[1,0,1]
    v_pk_mul_f32 v[42:43], v[42:43], v[128:129] op_sel_hi:[1,0]
    v_pk_fma_f32 v[42:43], v[122:123], v[130:131], v[42:43] op_sel_hi:[1,0,1]
    v_pk_mul_f32 v[44:45], v[44:45], v[128:129] op_sel_hi:[1,0]
    v_pk_fma_f32 v[44:45], v[124:125], v[130:131], v[44:45] op_sel_hi:[1,0,1]
    v_pk_mul_f32 v[46:47], v[46:47], v[128:129] op_sel_hi:[1,0]
    v_pk_fma_f32 v[46:47], v[126:127], v[130:131], v[46:47] op_sel_hi:[1,0,1]
    v_cvt_pk_bf16_f32 v32, v32, v33
    v_cvt_pk_bf16_f32 v33, v34, v35
    v_cvt_pk_bf16_f32 v34, v36, v37
    v_cvt_pk_bf16_f32 v35, v38, v39
    v_cvt_pk_bf16_f32 v36, v40, v41
    v_cvt_pk_bf16_f32 v37, v42, v43
    v_cvt_pk_bf16_f32 v38, v44, v45
    v_cvt_pk_bf16_f32 v39, v46, v47
    buffer_store_dwordx4 v[32:35], v137, s[8:11], s22 offen offset:0 sc1
    buffer_store_dwordx4 v[36:39], v137, s[8:11], s22 offen offset:1024 sc1
    v_pk_mul_f32 v[48:49], v[48:49], v[132:133] op_sel_hi:[1,0]
    v_pk_fma_f32 v[48:49], v[112:113], v[134:135], v[48:49] op_sel_hi:[1,0,1]
    v_pk_mul_f32 v[50:51], v[50:51], v[132:133] op_sel_hi:[1,0]
    v_pk_fma_f32 v[50:51], v[114:115], v[134:135], v[50:51] op_sel_hi:[1,0,1]
    v_pk_mul_f32 v[52:53], v[52:53], v[132:133] op_sel_hi:[1,0]
    v_pk_fma_f32 v[52:53], v[116:117], v[134:135], v[52:53] op_sel_hi:[1,0,1]
    v_pk_mul_f32 v[54:55], v[54:55], v[132:133] op_sel_hi:[1,0]
    v_pk_fma_f32 v[54:55], v[118:119], v[134:135], v[54:55] op_sel_hi:[1,0,1]
    v_pk_mul_f32 v[56:57], v[56:57], v[132:133] op_sel_hi:[1,0]
    v_pk_fma_f32 v[56:57], v[120:121], v[134:135], v[56:57] op_sel_hi:[1,0,1]
    v_pk_mul_f32 v[58:59], v[58:59], v[132:133] op_sel_hi:[1,0]
    v_pk_fma_f32 v[58:59], v[122:123], v[134:135], v[58:59] op_sel_hi:[1,0,1]
    v_pk_mul_f32 v[60:61], v[60:61], v[132:133] op_sel_hi:[1,0]
    v_pk_fma_f32 v[60:61], v[124:125], v[134:135], v[60:61] op_sel_hi:[1,0,1]
    v_pk_mul_f32 v[62:63], v[62:63], v[132:133] op_sel_hi:[1,0]
    v_pk_fma_f32 v[62:63], v[126:127], v[134:135], v[62:63] op_sel_hi:[1,0,1]
    v_cvt_pk_bf16_f32 v48, v48, v49
    v_cvt_pk_bf16_f32 v49, v50, v51
    v_cvt_pk_bf16_f32 v50, v52, v53
    v_cvt_pk_bf16_f32 v51, v54, v55
    v_cvt_pk_bf16_f32 v52, v56, v57
    v_cvt_pk_bf16_f32 v53, v58, v59
    v_cvt_pk_bf16_f32 v54, v60, v61
    v_cvt_pk_bf16_f32 v55, v62, v63
    buffer_store_dwordx4 v[48:51], v137, s[8:11], s22 offen offset:2048 sc1
    buffer_store_dwordx4 v[52:55], v137, s[8:11], s22 offen offset:3072 sc1
    s_sub_u32 s22, s22, 4194304
    v_mul_f32 v128, s29, v128
    v_mul_f32 v130, s29, v130
    v_mul_f32 v132, s29, v132
    v_mul_f32 v134, s29, v134
    v_pk_mul_f32 v[0:1], v[0:1], v[128:129] op_sel_hi:[1,0]
    v_pk_fma_f32 v[0:1], v[96:97], v[130:131], v[0:1] op_sel_hi:[1,0,1]
    v_pk_mul_f32 v[2:3], v[2:3], v[128:129] op_sel_hi:[1,0]
    v_pk_fma_f32 v[2:3], v[98:99], v[130:131], v[2:3] op_sel_hi:[1,0,1]
    v_pk_mul_f32 v[4:5], v[4:5], v[128:129] op_sel_hi:[1,0]
    v_pk_fma_f32 v[4:5], v[100:101], v[130:131], v[4:5] op_sel_hi:[1,0,1]
    v_pk_mul_f32 v[6:7], v[6:7], v[128:129] op_sel_hi:[1,0]
    v_pk_fma_f32 v[6:7], v[102:103], v[130:131], v[6:7] op_sel_hi:[1,0,1]
    v_pk_mul_f32 v[8:9], v[8:9], v[128:129] op_sel_hi:[1,0]
    v_pk_fma_f32 v[8:9], v[104:105], v[130:131], v[8:9] op_sel_hi:[1,0,1]
    v_pk_mul_f32 v[10:11], v[10:11], v[128:129] op_sel_hi:[1,0]
    v_pk_fma_f32 v[10:11], v[106:107], v[130:131], v[10:11] op_sel_hi:[1,0,1]
    v_pk_mul_f32 v[12:13], v[12:13], v[128:129] op_sel_hi:[1,0]
    v_pk_fma_f32 v[12:13], v[108:109], v[130:131], v[12:13] op_sel_hi:[1,0,1]
    v_pk_mul_f32 v[14:15], v[14:15], v[128:129] op_sel_hi:[1,0]
    v_pk_fma_f32 v[14:15], v[110:111], v[130:131], v[14:15] op_sel_hi:[1,0,1]
    v_cvt_pk_bf16_f32 v0, v0, v1
    v_cvt_pk_bf16_f32 v1, v2, v3
    v_cvt_pk_bf16_f32 v2, v4, v5
    v_cvt_pk_bf16_f32 v3, v6, v7
    v_cvt_pk_bf16_f32 v4, v8, v9
    v_cvt_pk_bf16_f32 v5, v10, v11
    v_cvt_pk_bf16_f32 v6, v12, v13
    v_cvt_pk_bf16_f32 v7, v14, v15
    buffer_store_dwordx4 v[0:3], v137, s[8:11], s22 offen offset:0 sc1
    buffer_store_dwordx4 v[4:7], v137, s[8:11], s22 offen offset:1024 sc1
    v_pk_mul_f32 v[16:17], v[16:17], v[132:133] op_sel_hi:[1,0]
    v_pk_fma_f32 v[16:17], v[96:97], v[134:135], v[16:17] op_sel_hi:[1,0,1]
    v_pk_mul_f32 v[18:19], v[18:19], v[132:133] op_sel_hi:[1,0]
    v_pk_fma_f32 v[18:19], v[98:99], v[134:135], v[18:19] op_sel_hi:[1,0,1]
    v_pk_mul_f32 v[20:21], v[20:21], v[132:133] op_sel_hi:[1,0]
    v_pk_fma_f32 v[20:21], v[100:101], v[134:135], v[20:21] op_sel_hi:[1,0,1]
    v_pk_mul_f32 v[22:23], v[22:23], v[132:133] op_sel_hi:[1,0]
    v_pk_fma_f32 v[22:23], v[102:103], v[134:135], v[22:23] op_sel_hi:[1,0,1]
    v_pk_mul_f32 v[24:25], v[24:25], v[132:133] op_sel_hi:[1,0]
    v_pk_fma_f32 v[24:25], v[104:105], v[134:135], v[24:25] op_sel_hi:[1,0,1]
    v_pk_mul_f32 v[26:27], v[26:27], v[132:133] op_sel_hi:[1,0]
    v_pk_fma_f32 v[26:27], v[106:107], v[134:135], v[26:27] op_sel_hi:[1,0,1]
    v_pk_mul_f32 v[28:29], v[28:29], v[132:133] op_sel_hi:[1,0]
    v_pk_fma_f32 v[28:29], v[108:109], v[134:135], v[28:29] op_sel_hi:[1,0,1]
    v_pk_mul_f32 v[30:31], v[30:31], v[132:133] op_sel_hi:[1,0]
    v_pk_fma_f32 v[30:31], v[110:111], v[134:135], v[30:31] op_sel_hi:[1,0,1]
    v_cvt_pk_bf16_f32 v16, v16, v17
    v_cvt_pk_bf16_f32 v17, v18, v19
    v_cvt_pk_bf16_f32 v18, v20, v21
    v_cvt_pk_bf16_f32 v19, v22, v23
    v_cvt_pk_bf16_f32 v20, v24, v25
    v_cvt_pk_bf16_f32 v21, v26, v27
    v_cvt_pk_bf16_f32 v22, v28, v29
    v_cvt_pk_bf16_f32 v23, v30, v31
    buffer_store_dwordx4 v[16:19], v137, s[8:11], s22 offen offset:2048 sc1
    buffer_store_dwordx4 v[20:23], v137, s[8:11], s22 offen offset:3072 sc1
    s_add_u32 s22, s22, 8388608
    ds_read_b128 v[96:99], v140 offset:0
    ds_read_b128 v[112:115], v140 offset:512
    ds_read_b128 v[100:103], v140 offset:32
    ds_read_b128 v[116:119], v140 offset:544
    ds_read_b128 v[104:107], v140 offset:64
    ds_read_b128 v[120:123], v140 offset:576
    ds_read_b128 v[108:111], v140 offset:96
    ds_read_b128 v[124:127], v140 offset:608
    s_waitcnt lgkmcnt(0)
    v_pk_mul_f32 v[64:65], v[64:65], v[96:97]
    v_pk_fma_f32 v[64:65], v[112:113], v[150:151], v[64:65] op_sel_hi:[1,0,1]
    v_pk_mul_f32 v[66:67], v[66:67], v[98:99]
    v_pk_fma_f32 v[66:67], v[114:115], v[150:151], v[66:67] op_sel_hi:[1,0,1]
    v_pk_mul_f32 v[68:69], v[68:69], v[100:101]
    v_pk_fma_f32 v[68:69], v[116:117], v[150:151], v[68:69] op_sel_hi:[1,0,1]
    v_pk_mul_f32 v[70:71], v[70:71], v[102:103]
    v_pk_fma_f32 v[70:71], v[118:119], v[150:151], v[70:71] op_sel_hi:[1,0,1]
    v_pk_mul_f32 v[72:73], v[72:73], v[104:105]
    v_pk_fma_f32 v[72:73], v[120:121], v[150:151], v[72:73] op_sel_hi:[1,0,1]
    v_pk_mul_f32 v[74:75], v[74:75], v[106:107]
    v_pk_fma_f32 v[74:75], v[122:123], v[150:151], v[74:75] op_sel_hi:[1,0,1]
    v_pk_mul_f32 v[76:77], v[76:77], v[108:109]
    v_pk_fma_f32 v[76:77], v[124:125], v[150:151], v[76:77] op_sel_hi:[1,0,1]
    v_pk_mul_f32 v[78:79], v[78:79], v[110:111]
    v_pk_fma_f32 v[78:79], v[126:127], v[150:151], v[78:79] op_sel_hi:[1,0,1]
    v_cvt_pk_bf16_f32 v64, v64, v65
    v_cvt_pk_bf16_f32 v65, v66, v67
    v_cvt_pk_bf16_f32 v66, v68, v69
    v_cvt_pk_bf16_f32 v67, v70, v71
    v_cvt_pk_bf16_f32 v68, v72, v73
    v_cvt_pk_bf16_f32 v69, v74, v75
    v_cvt_pk_bf16_f32 v70, v76, v77
    v_cvt_pk_bf16_f32 v71, v78, v79
    buffer_store_dwordx4 v[64:67], v137, s[8:11], s22 offen offset:0 sc1
    buffer_store_dwordx4 v[68:71], v137, s[8:11], s22 offen offset:1024 sc1
    ds_read_b128 v[96:99], v140 offset:128
    ds_read_b128 v[112:115], v140 offset:640
    ds_read_b128 v[100:103], v140 offset:160
    ds_read_b128 v[116:119], v140 offset:672
    ds_read_b128 v[104:107], v140 offset:192
    ds_read_b128 v[120:123], v140 offset:704
    ds_read_b128 v[108:111], v140 offset:224
    ds_read_b128 v[124:127], v140 offset:736
    s_waitcnt lgkmcnt(0)
    v_pk_mul_f32 v[80:81], v[80:81], v[96:97]
    v_pk_fma_f32 v[80:81], v[112:113], v[150:151], v[80:81] op_sel_hi:[1,0,1]
    v_pk_mul_f32 v[82:83], v[82:83], v[98:99]
    v_pk_fma_f32 v[82:83], v[114:115], v[150:151], v[82:83] op_sel_hi:[1,0,1]
    v_pk_mul_f32 v[84:85], v[84:85], v[100:101]
    v_pk_fma_f32 v[84:85], v[116:117], v[150:151], v[84:85] op_sel_hi:[1,0,1]
    v_pk_mul_f32 v[86:87], v[86:87], v[102:103]
    v_pk_fma_f32 v[86:87], v[118:119], v[150:151], v[86:87] op_sel_hi:[1,0,1]
    v_pk_mul_f32 v[88:89], v[88:89], v[104:105]
    v_pk_fma_f32 v[88:89], v[120:121], v[150:151], v[88:89] op_sel_hi:[1,0,1]
    v_pk_mul_f32 v[90:91], v[90:91], v[106:107]
    v_pk_fma_f32 v[90:91], v[122:123], v[150:151], v[90:91] op_sel_hi:[1,0,1]
    v_pk_mul_f32 v[92:93], v[92:93], v[108:109]
    v_pk_fma_f32 v[92:93], v[124:125], v[150:151], v[92:93] op_sel_hi:[1,0,1]
    v_pk_mul_f32 v[94:95], v[94:95], v[110:111]
    v_pk_fma_f32 v[94:95], v[126:127], v[150:151], v[94:95] op_sel_hi:[1,0,1]
    v_cvt_pk_bf16_f32 v80, v80, v81
    v_cvt_pk_bf16_f32 v81, v82, v83
    v_cvt_pk_bf16_f32 v82, v84, v85
    v_cvt_pk_bf16_f32 v83, v86, v87
    v_cvt_pk_bf16_f32 v84, v88, v89
    v_cvt_pk_bf16_f32 v85, v90, v91
    v_cvt_pk_bf16_f32 v86, v92, v93
    v_cvt_pk_bf16_f32 v87, v94, v95
    buffer_store_dwordx4 v[80:83], v137, s[8:11], s22 offen offset:2048 sc1
    buffer_store_dwordx4 v[84:87], v137, s[8:11], s22 offen offset:3072 sc1
    s_endpgm
.p2align 8
.globl attn_kernel
.type attn_kernel,@function
attn_kernel:
    s_cmp_lt_u32 s2, 256
    s_cbranch_scc1 go_attn_kernel_1
    s_endpgm
go_attn_kernel_1:
    s_load_dwordx2 s[4:5], s[0:1], 72
    v_lshrrev_b32 v172, 6, v0
    s_nop 0
    v_readfirstlane_b32 s16, v172
    v_and_b32 v172, 63, v0
    v_lshlrev_b32 v173, 4, v172
    s_and_b32 s17, s2, 7
    s_lshl_b32 s17, s17, 2
    s_bfe_u32 s18, s2, 0x20003
    s_add_u32 s17, s17, s18
    s_lshr_b32 s18, s2, 5
    s_lshl_b32 s24, s17, 17
    s_add_u32 s27, s24, 4194304
    s_cmp_ge_u32 s16, 4
    s_cbranch_scc1 help_attn_kernel_2
    s_lshl_b32 s21, s18, 3
    s_lshl_b32 s22, s16, 1
    s_add_u32 s22, s21, s22
    s_lshl_b32 s25, s22, 11
    s_add_u32 s25, s25, s24
    s_waitcnt lgkmcnt(0)
    s_add_u32 s8, s4, 4194304
    s_addc_u32 s9, s5, 0
    s_and_b32 s9, s9, 0xffff
    s_mov_b32 s10, 12582912
    s_mov_b32 s11, 0x00020000
    buffer_load_dwordx4 v[0:3], v173, s[8:11], s25 offen offset:0
    buffer_load_dwordx4 v[4:7], v173, s[8:11], s25 offen offset:1024
    buffer_load_dwordx4 v[8:11], v173, s[8:11], s25 offen offset:2048
    buffer_load_dwordx4 v[12:15], v173, s[8:11], s25 offen offset:3072
    s_add_u32 s12, s4, 16777216
    s_addc_u32 s13, s5, 0
    s_and_b32 s13, s13, 0xffff
    s_mov_b32 s14, 4194304
    s_mov_b32 s15, 0x00020000
    v_and_b32 v176, 3, v172
    v_bfe_u32 v177, v172, 2, 1
    v_bfe_u32 v178, v172, 4, 1
    v_xor_b32 v177, v177, v178
    v_or_b32 v176, v176, v177
    v_cmp_eq_u32 vcc, 0, v176
    v_mov_b32 v177, 0x3f803f80
    s_nop 1
    v_cndmask_b32 v168, 0, v177, vcc
    v_mov_b32 v169, v168
    v_mov_b32 v170, v168
    v_mov_b32 v171, v168
    v_mov_b32 v96, 0
    v_mov_b32 v97, 0
    v_mov_b32 v98, 0
    v_mov_b32 v99, 0
    v_mov_b32 v100, 0
    v_mov_b32 v101, 0
    v_mov_b32 v102, 0
    v_mov_b32 v103, 0
    v_mov_b32 v104, 0
    v_mov_b32 v105, 0
    v_mov_b32 v106, 0
    v_mov_b32 v107, 0
    v_mov_b32 v108, 0
    v_mov_b32 v109, 0
    v_mov_b32 v110, 0
    v_mov_b32 v111, 0
    v_mov_b32 v112, 0
    v_mov_b32 v113, 0
    v_mov_b32 v114, 0
    v_mov_b32 v115, 0
    v_mov_b32 v116, 0
    v_mov_b32 v117, 0
    v_mov_b32 v118, 0
    v_mov_b32 v119, 0
    v_mov_b32 v120, 0
    v_mov_b32 v121, 0
    v_mov_b32 v122, 0
    v_mov_b32 v123, 0
    v_mov_b32 v124, 0
    v_mov_b32 v125, 0
    v_mov_b32 v126, 0
    v_mov_b32 v127, 0
    v_mov_b32 v128, 0
    v_mov_b32 v129, 0
    v_mov_b32 v130, 0
    v_mov_b32 v131, 0
    v_mov_b32 v132, 0
    v_mov_b32 v133, 0
    v_mov_b32 v134, 0
    v_mov_b32 v135, 0
    v_mov_b32 v88, 0
    v_mov_b32 v40, 0
    v_mov_b32 v89, 0
    v_mov_b32 v41, 0
    v_mov_b32 v90, 0
    v_mov_b32 v42, 0
    v_mov_b32 v91, 0
    v_mov_b32 v43, 0
    v_mov_b32 v92, 0
    v_mov_b32 v44, 0
    v_mov_b32 v93, 0
    v_mov_b32 v45, 0
    v_mov_b32 v94, 0
    v_mov_b32 v46, 0
    v_mov_b32 v95, 0
    v_mov_b32 v47, 0
    v_mov_b32 v174, v173
    v_add_u32 v175, 0x8000, v173
    s_barrier
    ds_read_b128 v[16:19], v174 offset:0
    ds_read_b128 v[20:23], v174 offset:1024
    ds_read_b128 v[24:27], v174 offset:4096
    ds_read_b128 v[28:31], v174 offset:5120
    ds_read_b128 v[32:35], v174 offset:2048
    ds_read_b128 v[36:39], v174 offset:3072
    s_waitcnt vmcnt(0) lgkmcnt(4)
    v_mfma_f32_32x32x16_bf16 v[48:63], v[16:19], v[0:3], 0
    v_mfma_f32_32x32x16_bf16 v[48:63], v[20:23], v[4:7], v[48:63]
    v_mfma_f32_32x32x16_bf16 v[64:79], v[16:19], v[8:11], 0
    v_mfma_f32_32x32x16_bf16 v[64:79], v[20:23], v[12:15], v[64:79]
    s_nop 9
    v_max3_f32 v176, v48, v49, v50
    v_max3_f32 v176, v176, v51, v52
    v_max3_f32 v176, v176, v53, v54
    v_max3_f32 v176, v176, v55, v56
    v_max3_f32 v176, v176, v57, v58
    v_max3_f32 v176, v176, v59, v60
    v_max3_f32 v176, v176, v61, v62
    v_max_f32 v176, v176, v63
    v_mov_b32 v177, v176
    s_nop 1
    v_permlane32_swap_b32 v177, v176
    s_nop 1
    v_max_f32 v176, v176, v177
    v_sub_f32 v136, 0, v176
    v_sub_f32 v137, 0, v176
    v_sub_f32 v138, 0, v176
    v_sub_f32 v139, 0, v176
    v_sub_f32 v140, 0, v176
    v_sub_f32 v141, 0, v176
    v_sub_f32 v142, 0, v176
    v_sub_f32 v143, 0, v176
    v_sub_f32 v144, 0, v176
    v_sub_f32 v145, 0, v176
    v_sub_f32 v146, 0, v176
    v_sub_f32 v147, 0, v176
    v_sub_f32 v148, 0, v176
    v_sub_f32 v149, 0, v176
    v_sub_f32 v150, 0, v176
    v_sub_f32 v151, 0, v176
    v_sub_f32 v48, v48, v176
    v_sub_f32 v49, v49, v176
    v_sub_f32 v50, v50, v176
    v_sub_f32 v51, v51, v176
    v_sub_f32 v52, v52, v176
    v_sub_f32 v53, v53, v176
    v_sub_f32 v54, v54, v176
    v_sub_f32 v55, v55, v176
    v_sub_f32 v56, v56, v176
    v_sub_f32 v57, v57, v176
    v_sub_f32 v58, v58, v176
    v_sub_f32 v59, v59, v176
    v_sub_f32 v60, v60, v176
    v_sub_f32 v61, v61, v176
    v_sub_f32 v62, v62, v176
    v_sub_f32 v63, v63, v176
    v_max3_f32 v176, v64, v65, v66
    v_max3_f32 v176, v176, v67, v68
    v_max3_f32 v176, v176, v69, v70
    v_max3_f32 v176, v176, v71, v72
    v_max3_f32 v176, v176, v73, v74
    v_max3_f32 v176, v176, v75, v76
    v_max3_f32 v176, v176, v77, v78
    v_max_f32 v176, v176, v79
    v_mov_b32 v177, v176
    s_nop 1
    v_permlane32_swap_b32 v177, v176
    s_nop 1
    v_max_f32 v176, v176, v177
    v_sub_f32 v152, 0, v176
    v_sub_f32 v153, 0, v176
    v_sub_f32 v154, 0, v176
    v_sub_f32 v155, 0, v176
    v_sub_f32 v156, 0, v176
    v_sub_f32 v157, 0, v176
    v_sub_f32 v158, 0, v176
    v_sub_f32 v159, 0, v176
    v_sub_f32 v160, 0, v176
    v_sub_f32 v161, 0, v176
    v_sub_f32 v162, 0, v176
    v_sub_f32 v163, 0, v176
    v_sub_f32 v164, 0, v176
    v_sub_f32 v165, 0, v176
    v_sub_f32 v166, 0, v176
    v_sub_f32 v167, 0, v176
    s_mov_b32 s30, 8
    s_nop 0
loop_attn_kernel_3:
    v_mfma_f32_32x32x16_bf16 v[64:79], v[16:19], v[8:11], v[152:167]
    v_exp_f32 v48, v48
    v_exp_f32 v49, v49
    v_exp_f32 v50, v50
    v_mfma_f32_32x32x16_bf16 v[112:127], v[40:43], v[88:91], v[112:127]
    v_exp_f32 v51, v51
    v_exp_f32 v52, v52
    v_exp_f32 v53, v53
    v_cvt_pk_bf16_f32 v80, v48, v49
    v_mfma_f32_32x32x16_bf16 v[64:79], v[20:23], v[12:15], v[64:79]
    v_exp_f32 v54, v54
    v_exp_f32 v55, v55
    v_exp_f32 v56, v56
    v_cvt_pk_bf16_f32 v81, v50, v51
    v_cvt_pk_bf16_f32 v82, v52, v53
    v_mfma_f32_32x32x16_bf16 v[112:127], v[44:47], v[92:95], v[112:127]
    v_exp_f32 v57, v57
    v_exp_f32 v58, v58
    v_exp_f32 v59, v59
    v_cvt_pk_bf16_f32 v83, v54, v55
    v_mfma_f32_16x16x32_bf16 v[132:135], v[168:171], v[88:91], v[132:135]
    v_exp_f32 v60, v60
    v_exp_f32 v61, v61
    v_cvt_pk_bf16_f32 v84, v56, v57
    v_cvt_pk_bf16_f32 v85, v58, v59
    v_mfma_f32_16x16x32_bf16 v[132:135], v[168:171], v[92:95], v[132:135]
    v_exp_f32 v62, v62
    v_exp_f32 v63, v63
    v_cvt_pk_bf16_f32 v86, v60, v61
    v_cvt_pk_bf16_f32 v87, v62, v63
    s_waitcnt lgkmcnt(0)
    v_mfma_f32_32x32x16_bf16 v[48:63], v[24:27], v[0:3], v[136:151]
    v_exp_f32 v64, v64
    v_exp_f32 v65, v65
    v_exp_f32 v66, v66
    v_mfma_f32_32x32x16_bf16 v[96:111], v[32:35], v[80:83], v[96:111]
    v_exp_f32 v67, v67
    v_exp_f32 v68, v68
    v_exp_f32 v69, v69
    v_cvt_pk_bf16_f32 v88, v64, v65
    v_mfma_f32_32x32x16_bf16 v[48:63], v[28:31], v[4:7], v[48:63]
    ds_read_b128 v[16:19], v174 offset:8192
    v_exp_f32 v70, v70
    v_exp_f32 v71, v71
    v_exp_f32 v72, v72
    v_cvt_pk_bf16_f32 v89, v66, v67
    v_cvt_pk_bf16_f32 v90, v68, v69
    v_mfma_f32_32x32x16_bf16 v[96:111], v[36:39], v[84:87], v[96:111]
    ds_read_b128 v[20:23], v174 offset:9216
    v_exp_f32 v73, v73
    v_exp_f32 v74, v74
    v_exp_f32 v75, v75
    v_cvt_pk_bf16_f32 v91, v70, v71
    v_mfma_f32_16x16x32_bf16 v[128:131], v[168:171], v[80:83], v[128:131]
    ds_read_b128 v[40:43], v174 offset:6144
    v_exp_f32 v76, v76
    v_exp_f32 v77, v77
    v_cvt_pk_bf16_f32 v92, v72, v73
    v_cvt_pk_bf16_f32 v93, v74, v75
    v_mfma_f32_16x16x32_bf16 v[128:131], v[168:171], v[84:87], v[128:131]
    ds_read_b128 v[44:47], v174 offset:7168
    v_exp_f32 v78, v78
    v_exp_f32 v79, v79
    v_cvt_pk_bf16_f32 v94, v76, v77
    v_cvt_pk_bf16_f32 v95, v78, v79
    v_mfma_f32_32x32x16_bf16 v[64:79], v[24:27], v[8:11], v[152:167]
    v_exp_f32 v48, v48
    v_exp_f32 v49, v49
    v_exp_f32 v50, v50
    v_mfma_f32_32x32x16_bf16 v[112:127], v[32:35], v[88:91], v[112:127]
    v_exp_f32 v51, v51
    v_exp_f32 v52, v52
    v_exp_f32 v53, v53
    v_cvt_pk_bf16_f32 v80, v48, v49
    v_mfma_f32_32x32x16_bf16 v[64:79], v[28:31], v[12:15], v[64:79]
    v_exp_f32 v54, v54
    v_exp_f32 v55, v55
    v_exp_f32 v56, v56
    v_cvt_pk_bf16_f32 v81, v50, v51
    v_cvt_pk_bf16_f32 v82, v52, v53
    v_mfma_f32_32x32x16_bf16 v[112:127], v[36:39], v[92:95], v[112:127]
    v_exp_f32 v57, v57
    v_exp_f32 v58, v58
    v_exp_f32 v59, v59
    v_cvt_pk_bf16_f32 v83, v54, v55
    v_mfma_f32_16x16x32_bf16 v[132:135], v[168:171], v[88:91], v[132:135]
    v_exp_f32 v60, v60
    v_exp_f32 v61, v61
    v_cvt_pk_bf16_f32 v84, v56, v57
    v_cvt_pk_bf16_f32 v85, v58, v59
    v_mfma_f32_16x16x32_bf16 v[132:135], v[168:171], v[92:95], v[132:135]
    v_exp_f32 v62, v62
    v_exp_f32 v63, v63
    v_cvt_pk_bf16_f32 v86, v60, v61
    v_cvt_pk_bf16_f32 v87, v62, v63
    s_waitcnt lgkmcnt(0)
    v_mfma_f32_32x32x16_bf16 v[48:63], v[16:19], v[0:3], v[136:151]
    v_exp_f32 v64, v64
    v_exp_f32 v65, v65
    v_exp_f32 v66, v66
    v_mfma_f32_32x32x16_bf16 v[96:111], v[40:43], v[80:83], v[96:111]
    v_exp_f32 v67, v67
    v_exp_f32 v68, v68
    v_exp_f32 v69, v69
    v_cvt_pk_bf16_f32 v88, v64, v65
    v_mfma_f32_32x32x16_bf16 v[48:63], v[20:23], v[4:7], v[48:63]
    ds_read_b128 v[24:27], v174 offset:12288
    v_exp_f32 v70, v70
    v_exp_f32 v71, v71
    v_exp_f32 v72, v72
    v_cvt_pk_bf16_f32 v89, v66, v67
    v_cvt_pk_bf16_f32 v90, v68, v69
    v_mfma_f32_32x32x16_bf16 v[96:111], v[44:47], v[84:87], v[96:111]
    ds_read_b128 v[28:31], v174 offset:13312
    v_exp_f32 v73, v73
    v_exp_f32 v74, v74
    v_exp_f32 v75, v75
    v_cvt_pk_bf16_f32 v91, v70, v71
    v_mfma_f32_16x16x32_bf16 v[128:131], v[168:171], v[80:83], v[128:131]
    ds_read_b128 v[32:35], v174 offset:10240
    v_exp_f32 v76, v76
    v_exp_f32 v77, v77
    v_cvt_pk_bf16_f32 v92, v72, v73
    v_cvt_pk_bf16_f32 v93, v74, v75
    v_mfma_f32_16x16x32_bf16 v[128:131], v[168:171], v[84:87], v[128:131]
    ds_read_b128 v[36:39], v174 offset:11264
    v_exp_f32 v78, v78
    v_exp_f32 v79, v79
    v_cvt_pk_bf16_f32 v94, v76, v77
    v_cvt_pk_bf16_f32 v95, v78, v79
    v_mfma_f32_32x32x16_bf16 v[64:79], v[16:19], v[8:11], v[152:167]
    v_exp_f32 v48, v48
    v_exp_f32 v49, v49
    v_exp_f32 v50, v50
    v_mfma_f32_32x32x16_bf16 v[112:127], v[40:43], v[88:91], v[112:127]
    v_exp_f32 v51, v51
    v_exp_f32 v52, v52
    v_exp_f32 v53, v53
    v_cvt_pk_bf16_f32 v80, v48, v49
    v_mfma_f32_32x32x16_bf16 v[64:79], v[20:23], v[12:15], v[64:79]
    v_exp_f32 v54, v54
    v_exp_f32 v55, v55
    v_exp_f32 v56, v56
    v_cvt_pk_bf16_f32 v81, v50, v51
    v_cvt_pk_bf16_f32 v82, v52, v53
    v_mfma_f32_32x32x16_bf16 v[112:127], v[44:47], v[92:95], v[112:127]
    v_exp_f32 v57, v57
    v_exp_f32 v58, v58
    v_exp_f32 v59, v59
    v_cvt_pk_bf16_f32 v83, v54, v55
    v_mfma_f32_16x16x32_bf16 v[132:135], v[168:171], v[88:91], v[132:135]
    v_exp_f32 v60, v60
    v_exp_f32 v61, v61
    v_cvt_pk_bf16_f32 v84, v56, v57
    v_cvt_pk_bf16_f32 v85, v58, v59
    v_mfma_f32_16x16x32_bf16 v[132:135], v[168:171], v[92:95], v[132:135]
    v_exp_f32 v62, v62
    v_exp_f32 v63, v63
    v_cvt_pk_bf16_f32 v86, v60, v61
    v_cvt_pk_bf16_f32 v87, v62, v63
    s_waitcnt lgkmcnt(0)
    v_mfma_f32_32x32x16_bf16 v[48:63], v[24:27], v[0:3], v[136:151]
    v_exp_f32 v64, v64
    v_exp_f32 v65, v65
    v_exp_f32 v66, v66
    v_mfma_f32_32x32x16_bf16 v[96:111], v[32:35], v[80:83], v[96:111]
    v_exp_f32 v67, v67
    v_exp_f32 v68, v68
    v_exp_f32 v69, v69
    v_cvt_pk_bf16_f32 v88, v64, v65
    v_mfma_f32_32x32x16_bf16 v[48:63], v[28:31], v[4:7], v[48:63]
    ds_read_b128 v[16:19], v174 offset:16384
    v_exp_f32 v70, v70
    v_exp_f32 v71, v71
    v_exp_f32 v72, v72
    v_cvt_pk_bf16_f32 v89, v66, v67
    v_cvt_pk_bf16_f32 v90, v68, v69
    v_mfma_f32_32x32x16_bf16 v[96:111], v[36:39], v[84:87], v[96:111]
    ds_read_b128 v[20:23], v174 offset:17408
    v_exp_f32 v73, v73
    v_exp_f32 v74, v74
    v_exp_f32 v75, v75
    v_cvt_pk_bf16_f32 v91, v70, v71
    v_mfma_f32_16x16x32_bf16 v[128:131], v[168:171], v[80:83], v[128:131]
    ds_read_b128 v[40:43], v174 offset:14336
    v_exp_f32 v76, v76
    v_exp_f32 v77, v77
    v_cvt_pk_bf16_f32 v92, v72, v73
    v_cvt_pk_bf16_f32 v93, v74, v75
    v_mfma_f32_16x16x32_bf16 v[128:131], v[168:171], v[84:87], v[128:131]
    ds_read_b128 v[44:47], v174 offset:15360
    v_exp_f32 v78, v78
    v_exp_f32 v79, v79
    v_cvt_pk_bf16_f32 v94, v76, v77
    v_cvt_pk_bf16_f32 v95, v78, v79
    v_mfma_f32_32x32x16_bf16 v[64:79], v[24:27], v[8:11], v[152:167]
    v_exp_f32 v48, v48
    v_exp_f32 v49, v49
    v_exp_f32 v50, v50
    v_mfma_f32_32x32x16_bf16 v[112:127], v[32:35], v[88:91], v[112:127]
    v_exp_f32 v51, v51
    v_exp_f32 v52, v52
    v_exp_f32 v53, v53
    v_cvt_pk_bf16_f32 v80, v48, v49
    v_mfma_f32_32x32x16_bf16 v[64:79], v[28:31], v[12:15], v[64:79]
    v_exp_f32 v54, v54
    v_exp_f32 v55, v55
    v_exp_f32 v56, v56
    v_cvt_pk_bf16_f32 v81, v50, v51
    v_cvt_pk_bf16_f32 v82, v52, v53
    v_mfma_f32_32x32x16_bf16 v[112:127], v[36:39], v[92:95], v[112:127]
    v_exp_f32 v57, v57
    v_exp_f32 v58, v58
    v_exp_f32 v59, v59
    v_cvt_pk_bf16_f32 v83, v54, v55
    v_mfma_f32_16x16x32_bf16 v[132:135], v[168:171], v[88:91], v[132:135]
    v_exp_f32 v60, v60
    v_exp_f32 v61, v61
    v_cvt_pk_bf16_f32 v84, v56, v57
    v_cvt_pk_bf16_f32 v85, v58, v59
    v_mfma_f32_16x16x32_bf16 v[132:135], v[168:171], v[92:95], v[132:135]
    v_exp_f32 v62, v62
    v_exp_f32 v63, v63
    v_cvt_pk_bf16_f32 v86, v60, v61
    v_cvt_pk_bf16_f32 v87, v62, v63
    s_waitcnt lgkmcnt(0)
    v_mfma_f32_32x32x16_bf16 v[48:63], v[16:19], v[0:3], v[136:151]
    v_exp_f32 v64, v64
    v_exp_f32 v65, v65
    v_exp_f32 v66, v66
    v_mfma_f32_32x32x16_bf16 v[96:111], v[40:43], v[80:83], v[96:111]
    v_exp_f32 v67, v67
    v_exp_f32 v68, v68
    v_exp_f32 v69, v69
    v_cvt_pk_bf16_f32 v88, v64, v65
    v_mfma_f32_32x32x16_bf16 v[48:63], v[20:23], v[4:7], v[48:63]
    ds_read_b128 v[24:27], v174 offset:20480
    v_exp_f32 v70, v70
    v_exp_f32 v71, v71
    v_exp_f32 v72, v72
    v_cvt_pk_bf16_f32 v89, v66, v67
    v_cvt_pk_bf16_f32 v90, v68, v69
    v_mfma_f32_32x32x16_bf16 v[96:111], v[44:47], v[84:87], v[96:111]
    ds_read_b128 v[28:31], v174 offset:21504
    v_exp_f32 v73, v73
    v_exp_f32 v74, v74
    v_exp_f32 v75, v75
    v_cvt_pk_bf16_f32 v91, v70, v71
    v_mfma_f32_16x16x32_bf16 v[128:131], v[168:171], v[80:83], v[128:131]
    ds_read_b128 v[32:35], v174 offset:18432
    v_exp_f32 v76, v76
    v_exp_f32 v77, v77
    v_cvt_pk_bf16_f32 v92, v72, v73
    v_cvt_pk_bf16_f32 v93, v74, v75
    v_mfma_f32_16x16x32_bf16 v[128:131], v[168:171], v[84:87], v[128:131]
    ds_read_b128 v[36:39], v174 offset:19456
    v_exp_f32 v78, v78
    v_exp_f32 v79, v79
    v_cvt_pk_bf16_f32 v94, v76, v77
    v_cvt_pk_bf16_f32 v95, v78, v79
    v_mfma_f32_32x32x16_bf16 v[64:79], v[16:19], v[8:11], v[152:167]
    v_exp_f32 v48, v48
    v_exp_f32 v49, v49
    v_exp_f32 v50, v50
    v_mfma_f32_32x32x16_bf16 v[112:127], v[40:43], v[88:91], v[112:127]
    v_exp_f32 v51, v51
    v_exp_f32 v52, v52
    v_exp_f32 v53, v53
    v_cvt_pk_bf16_f32 v80, v48, v49
    v_mfma_f32_32x32x16_bf16 v[64:79], v[20:23], v[12:15], v[64:79]
    v_exp_f32 v54, v54
    v_exp_f32 v55, v55
    v_exp_f32 v56, v56
    v_cvt_pk_bf16_f32 v81, v50, v51
    v_cvt_pk_bf16_f32 v82, v52, v53
    v_mfma_f32_32x32x16_bf16 v[112:127], v[44:47], v[92:95], v[112:127]
    v_exp_f32 v57, v57
    v_exp_f32 v58, v58
    v_exp_f32 v59, v59
    v_cvt_pk_bf16_f32 v83, v54, v55
    v_mfma_f32_16x16x32_bf16 v[132:135], v[168:171], v[88:91], v[132:135]
    v_exp_f32 v60, v60
    v_exp_f32 v61, v61
    v_cvt_pk_bf16_f32 v84, v56, v57
    v_cvt_pk_bf16_f32 v85, v58, v59
    v_mfma_f32_16x16x32_bf16 v[132:135], v[168:171], v[92:95], v[132:135]
    v_exp_f32 v62, v62
    v_exp_f32 v63, v63
    v_cvt_pk_bf16_f32 v86, v60, v61
    v_cvt_pk_bf16_f32 v87, v62, v63
    s_waitcnt lgkmcnt(0)
    v_mfma_f32_32x32x16_bf16 v[48:63], v[24:27], v[0:3], v[136:151]
    v_exp_f32 v64, v64
    v_exp_f32 v65, v65
    v_exp_f32 v66, v66
    v_mfma_f32_32x32x16_bf16 v[96:111], v[32:35], v[80:83], v[96:111]
    v_exp_f32 v67, v67
    v_exp_f32 v68, v68
    v_exp_f32 v69, v69
    v_cvt_pk_bf16_f32 v88, v64, v65
    v_mfma_f32_32x32x16_bf16 v[48:63], v[28:31], v[4:7], v[48:63]
    ds_read_b128 v[16:19], v174 offset:24576
    v_exp_f32 v70, v70
    v_exp_f32 v71, v71
    v_exp_f32 v72, v72
    v_cvt_pk_bf16_f32 v89, v66, v67
    v_cvt_pk_bf16_f32 v90, v68, v69
    v_mfma_f32_32x32x16_bf16 v[96:111], v[36:39], v[84:87], v[96:111]
    ds_read_b128 v[20:23], v174 offset:25600
    v_exp_f32 v73, v73
    v_exp_f32 v74, v74
    v_exp_f32 v75, v75
    v_cvt_pk_bf16_f32 v91, v70, v71
    v_mfma_f32_16x16x32_bf16 v[128:131], v[168:171], v[80:83], v[128:131]
    ds_read_b128 v[40:43], v174 offset:22528
    v_exp_f32 v76, v76
    v_exp_f32 v77, v77
    v_cvt_pk_bf16_f32 v92, v72, v73
    v_cvt_pk_bf16_f32 v93, v74, v75
    v_mfma_f32_16x16x32_bf16 v[128:131], v[168:171], v[84:87], v[128:131]
    ds_read_b128 v[44:47], v174 offset:23552
    v_exp_f32 v78, v78
    v_exp_f32 v79, v79
    v_cvt_pk_bf16_f32 v94, v76, v77
    v_cvt_pk_bf16_f32 v95, v78, v79
    v_mfma_f32_32x32x16_bf16 v[64:79], v[24:27], v[8:11], v[152:167]
    v_exp_f32 v48, v48
    v_exp_f32 v49, v49
    v_exp_f32 v50, v50
    v_mfma_f32_32x32x16_bf16 v[112:127], v[32:35], v[88:91], v[112:127]
    v_exp_f32 v51, v51
    v_exp_f32 v52, v52
    v_exp_f32 v53, v53
    v_cvt_pk_bf16_f32 v80, v48, v49
    v_mfma_f32_32x32x16_bf16 v[64:79], v[28:31], v[12:15], v[64:79]
    v_exp_f32 v54, v54
    v_exp_f32 v55, v55
    v_exp_f32 v56, v56
    v_cvt_pk_bf16_f32 v81, v50, v51
    v_cvt_pk_bf16_f32 v82, v52, v53
    v_mfma_f32_32x32x16_bf16 v[112:127], v[36:39], v[92:95], v[112:127]
    v_exp_f32 v57, v57
    v_exp_f32 v58, v58
    v_exp_f32 v59, v59
    v_cvt_pk_bf16_f32 v83, v54, v55
    v_mfma_f32_16x16x32_bf16 v[132:135], v[168:171], v[88:91], v[132:135]
    v_exp_f32 v60, v60
    v_exp_f32 v61, v61
    v_cvt_pk_bf16_f32 v84, v56, v57
    v_cvt_pk_bf16_f32 v85, v58, v59
    v_mfma_f32_16x16x32_bf16 v[132:135], v[168:171], v[92:95], v[132:135]
    v_exp_f32 v62, v62
    v_exp_f32 v63, v63
    v_cvt_pk_bf16_f32 v86, v60, v61
    v_cvt_pk_bf16_f32 v87, v62, v63
    s_waitcnt lgkmcnt(0)
    v_mfma_f32_32x32x16_bf16 v[48:63], v[16:19], v[0:3], v[136:151]
    v_exp_f32 v64, v64
    v_exp_f32 v65, v65
    v_exp_f32 v66, v66
    v_mfma_f32_32x32x16_bf16 v[96:111], v[40:43], v[80:83], v[96:111]
    v_exp_f32 v67, v67
    v_exp_f32 v68, v68
    v_exp_f32 v69, v69
    v_cvt_pk_bf16_f32 v88, v64, v65
    v_mfma_f32_32x32x16_bf16 v[48:63], v[20:23], v[4:7], v[48:63]
    ds_read_b128 v[24:27], v174 offset:28672
    v_exp_f32 v70, v70
    v_exp_f32 v71, v71
    v_exp_f32 v72, v72
    v_cvt_pk_bf16_f32 v89, v66, v67
    v_cvt_pk_bf16_f32 v90, v68, v69
    v_mfma_f32_32x32x16_bf16 v[96:111], v[44:47], v[84:87], v[96:111]
    ds_read_b128 v[28:31], v174 offset:29696
    v_exp_f32 v73, v73
    v_exp_f32 v74, v74
    v_exp_f32 v75, v75
    v_cvt_pk_bf16_f32 v91, v70, v71
    v_mfma_f32_16x16x32_bf16 v[128:131], v[168:171], v[80:83], v[128:131]
    ds_read_b128 v[32:35], v174 offset:26624
    v_exp_f32 v76, v76
    v_exp_f32 v77, v77
    v_cvt_pk_bf16_f32 v92, v72, v73
    v_cvt_pk_bf16_f32 v93, v74, v75
    v_mfma_f32_16x16x32_bf16 v[128:131], v[168:171], v[84:87], v[128:131]
    ds_read_b128 v[36:39], v174 offset:27648
    v_exp_f32 v78, v78
    v_exp_f32 v79, v79
    v_cvt_pk_bf16_f32 v94, v76, v77
    v_cvt_pk_bf16_f32 v95, v78, v79
    v_mfma_f32_32x32x16_bf16 v[64:79], v[16:19], v[8:11], v[152:167]
    v_exp_f32 v48, v48
    v_exp_f32 v49, v49
    v_exp_f32 v50, v50
    v_mfma_f32_32x32x16_bf16 v[112:127], v[40:43], v[88:91], v[112:127]
    v_exp_f32 v51, v51
    v_exp_f32 v52, v52
    v_exp_f32 v53, v53
    v_cvt_pk_bf16_f32 v80, v48, v49
    v_mfma_f32_32x32x16_bf16 v[64:79], v[20:23], v[12:15], v[64:79]
    v_exp_f32 v54, v54
    v_exp_f32 v55, v55
    v_exp_f32 v56, v56
    v_cvt_pk_bf16_f32 v81, v50, v51
    v_cvt_pk_bf16_f32 v82, v52, v53
    v_mfma_f32_32x32x16_bf16 v[112:127], v[44:47], v[92:95], v[112:127]
    v_exp_f32 v57, v57
    v_exp_f32 v58, v58
    v_exp_f32 v59, v59
    v_cvt_pk_bf16_f32 v83, v54, v55
    v_mfma_f32_16x16x32_bf16 v[132:135], v[168:171], v[88:91], v[132:135]
    v_exp_f32 v60, v60
    v_exp_f32 v61, v61
    v_cvt_pk_bf16_f32 v84, v56, v57
    v_cvt_pk_bf16_f32 v85, v58, v59
    v_mfma_f32_16x16x32_bf16 v[132:135], v[168:171], v[92:95], v[132:135]
    v_exp_f32 v62, v62
    v_exp_f32 v63, v63
    v_cvt_pk_bf16_f32 v86, v60, v61
    v_cvt_pk_bf16_f32 v87, v62, v63
    s_waitcnt lgkmcnt(0)
    s_barrier
    v_mfma_f32_32x32x16_bf16 v[48:63], v[24:27], v[0:3], v[136:151]
    v_exp_f32 v64, v64
    v_exp_f32 v65, v65
    v_exp_f32 v66, v66
    v_mfma_f32_32x32x16_bf16 v[96:111], v[32:35], v[80:83], v[96:111]
    v_exp_f32 v67, v67
    v_exp_f32 v68, v68
    v_exp_f32 v69, v69
    v_cvt_pk_bf16_f32 v88, v64, v65
    v_mfma_f32_32x32x16_bf16 v[48:63], v[28:31], v[4:7], v[48:63]
    ds_read_b128 v[16:19], v175 offset:0
    v_exp_f32 v70, v70
    v_exp_f32 v71, v71
    v_exp_f32 v72, v72
    v_cvt_pk_bf16_f32 v89, v66, v67
    v_cvt_pk_bf16_f32 v90, v68, v69
    v_mfma_f32_32x32x16_bf16 v[96:111], v[36:39], v[84:87], v[96:111]
    ds_read_b128 v[20:23], v175 offset:1024
    v_exp_f32 v73, v73
    v_exp_f32 v74, v74
    v_exp_f32 v75, v75
    v_cvt_pk_bf16_f32 v91, v70, v71
    v_mfma_f32_16x16x32_bf16 v[128:131], v[168:171], v[80:83], v[128:131]
    ds_read_b128 v[40:43], v174 offset:30720
    v_exp_f32 v76, v76
    v_exp_f32 v77, v77
    v_cvt_pk_bf16_f32 v92, v72, v73
    v_cvt_pk_bf16_f32 v93, v74, v75
    v_mfma_f32_16x16x32_bf16 v[128:131], v[168:171], v[84:87], v[128:131]
    ds_read_b128 v[44:47], v174 offset:31744
    v_exp_f32 v78, v78
    v_exp_f32 v79, v79
    v_cvt_pk_bf16_f32 v94, v76, v77
    v_cvt_pk_bf16_f32 v95, v78, v79
    v_mfma_f32_32x32x16_bf16 v[64:79], v[24:27], v[8:11], v[152:167]
    v_exp_f32 v48, v48
    v_exp_f32 v49, v49
    v_exp_f32 v50, v50
    v_mfma_f32_32x32x16_bf16 v[112:127], v[32:35], v[88:91], v[112:127]
    v_exp_f32 v51, v51
    v_exp_f32 v52, v52
    v_exp_f32 v53, v53
    v_cvt_pk_bf16_f32 v80, v48, v49
    v_mfma_f32_32x32x16_bf16 v[64:79], v[28:31], v[12:15], v[64:79]
    v_exp_f32 v54, v54
    v_exp_f32 v55, v55
    v_exp_f32 v56, v56
    v_cvt_pk_bf16_f32 v81, v50, v51
    v_cvt_pk_bf16_f32 v82, v52, v53
    v_mfma_f32_32x32x16_bf16 v[112:127], v[36:39], v[92:95], v[112:127]
    v_exp_f32 v57, v57
    v_exp_f32 v58, v58
    v_exp_f32 v59, v59
    v_cvt_pk_bf16_f32 v83, v54, v55
    v_mfma_f32_16x16x32_bf16 v[132:135], v[168:171], v[88:91], v[132:135]
    v_exp_f32 v60, v60
    v_exp_f32 v61, v61
    v_cvt_pk_bf16_f32 v84, v56, v57
    v_cvt_pk_bf16_f32 v85, v58, v59
    v_mfma_f32_16x16x32_bf16 v[132:135], v[168:171], v[92:95], v[132:135]
    v_exp_f32 v62, v62
    v_exp_f32 v63, v63
    v_cvt_pk_bf16_f32 v86, v60, v61
    v_cvt_pk_bf16_f32 v87, v62, v63
    s_waitcnt lgkmcnt(0)
    v_mfma_f32_32x32x16_bf16 v[48:63], v[16:19], v[0:3], v[136:151]
    v_exp_f32 v64, v64
    v_exp_f32 v65, v65
    v_exp_f32 v66, v66
    v_mfma_f32_32x32x16_bf16 v[96:111], v[40:43], v[80:83], v[96:111]
    v_exp_f32 v67, v67
    v_exp_f32 v68, v68
    v_exp_f32 v69, v69
    v_cvt_pk_bf16_f32 v88, v64, v65
    v_mfma_f32_32x32x16_bf16 v[48:63], v[20:23], v[4:7], v[48:63]
    ds_read_b128 v[24:27], v175 offset:4096
    v_exp_f32 v70, v70
    v_exp_f32 v71, v71
    v_exp_f32 v72, v72
    v_cvt_pk_bf16_f32 v89, v66, v67
    v_cvt_pk_bf16_f32 v90, v68, v69
    v_mfma_f32_32x32x16_bf16 v[96:111], v[44:47], v[84:87], v[96:111]
    ds_read_b128 v[28:31], v175 offset:5120
    v_exp_f32 v73, v73
    v_exp_f32 v74, v74
    v_exp_f32 v75, v75
    v_cvt_pk_bf16_f32 v91, v70, v71
    v_mfma_f32_16x16x32_bf16 v[128:131], v[168:171], v[80:83], v[128:131]
    ds_read_b128 v[32:35], v175 offset:2048
    v_exp_f32 v76, v76
    v_exp_f32 v77, v77
    v_cvt_pk_bf16_f32 v92, v72, v73
    v_cvt_pk_bf16_f32 v93, v74, v75
    v_mfma_f32_16x16x32_bf16 v[128:131], v[168:171], v[84:87], v[128:131]
    ds_read_b128 v[36:39], v175 offset:3072
    v_exp_f32 v78, v78
    v_exp_f32 v79, v79
    v_cvt_pk_bf16_f32 v94, v76, v77
    v_cvt_pk_bf16_f32 v95, v78, v79
    v_mov_b32 v174, v175
    v_add_u32 v175, 0x8000, v175
    v_and_b32 v175, 0x1ffff, v175
    s_sub_u32 s30, s30, 1
    s_cmp_lg_u32 s30, 0
    s_cbranch_scc1 loop_attn_kernel_3
    v_mfma_f32_32x32x16_bf16 v[112:127], v[40:43], v[88:91], v[112:127]
    v_mfma_f32_32x32x16_bf16 v[112:127], v[44:47], v[92:95], v[112:127]
    v_mfma_f32_16x16x32_bf16 v[132:135], v[168:171], v[88:91], v[132:135]
    v_mfma_f32_16x16x32_bf16 v[132:135], v[168:171], v[92:95], v[132:135]
    s_lshl_b32 s21, s22, 16
    s_lshl_b32 s23, s17, 11
    s_add_u32 s21, s21, s23
    s_mov_b32 s31, 0
chk_attn_kernel_6:
    v_cmp_nge_f32 vcc, 0x5f800000, v128
    s_cbranch_vccnz slow_attn_kernel_5
fin_attn_kernel_4:
    v_rcp_f32 v176, v128
    s_nop 0
    v_mul_f32 v96, v96, v176
    v_mul_f32 v97, v97, v176
    v_mul_f32 v98, v98, v176
    v_mul_f32 v99, v99, v176
    v_mul_f32 v100, v100, v176
    v_mul_f32 v101, v101, v176
    v_mul_f32 v102, v102, v176
    v_mul_f32 v103, v103, v176
    v_mul_f32 v104, v104, v176
    v_mul_f32 v105, v105, v176
    v_mul_f32 v106, v106, v176
    v_mul_f32 v107, v107, v176
    v_mul_f32 v108, v108, v176
    v_mul_f32 v109, v109, v176
    v_mul_f32 v110, v110, v176
    v_mul_f32 v111, v111, v176
    v_cvt_pk_bf16_f32 v64, v96, v97
    v_cvt_pk_bf16_f32 v65, v98, v99
    v_cvt_pk_bf16_f32 v66, v100, v101
    v_cvt_pk_bf16_f32 v67, v102, v103
    v_cvt_pk_bf16_f32 v68, v104, v105
    v_cvt_pk_bf16_f32 v69, v106, v107
    v_cvt_pk_bf16_f32 v70, v108, v109
    v_cvt_pk_bf16_f32 v71, v110, v111
    buffer_store_dwordx4 v[64:67], v173, s[12:15], s21 offen offset:0 sc1
    buffer_store_dwordx4 v[68:71], v173, s[12:15], s21 offen offset:1024 sc1
    s_cmp_lg_u32 s31, 0
    s_cbranch_scc1 done_attn_kernel_7
    s_mov_b32 s31, 1
    s_add_u32 s21, s21, 0x10000
    v_mov_b32 v96, v112
    v_mov_b32 v97, v113
    v_mov_b32 v98, v114
    v_mov_b32 v99, v115
    v_mov_b32 v100, v116
    v_mov_b32 v101, v117
    v_mov_b32 v102, v118
    v_mov_b32 v103, v119
    v_mov_b32 v104, v120
    v_mov_b32 v105, v121
    v_mov_b32 v106, v122
    v_mov_b32 v107, v123
    v_mov_b32 v108, v124
    v_mov_b32 v109, v125
    v_mov_b32 v110, v126
    v_mov_b32 v111, v127
    v_mov_b32 v0, v8
    v_mov_b32 v1, v9
    v_mov_b32 v2, v10
    v_mov_b32 v3, v11
    v_mov_b32 v4, v12
    v_mov_b32 v5, v13
    v_mov_b32 v6, v14
    v_mov_b32 v7, v15
    v_mov_b32 v128, v132
    s_branch chk_attn_kernel_6
done_attn_kernel_7:
    s_endpgm
slow_attn_kernel_5:
    s_waitcnt vmcnt(0) lgkmcnt(0)
    v_mov_b32 v178, 0xff800000
    s_mov_b32 s28, s27
    s_mov_b32 s30, 64
s1_attn_kernel_8:
    buffer_load_dwordx4 v[16:19], v173, s[8:11], s28 offen offset:0
    buffer_load_dwordx4 v[20:23], v173, s[8:11], s28 offen offset:1024
    s_add_u32 s28, s28, 2048
    s_waitcnt vmcnt(0)
    v_mfma_f32_32x32x16_bf16 v[48:63], v[16:19], v[0:3], 0
    v_mfma_f32_32x32x16_bf16 v[48:63], v[20:23], v[4:7], v[48:63]
    s_nop 15
    v_max3_f32 v176, v48, v49, v50
    v_max3_f32 v176, v176, v51, v52
    v_max3_f32 v176, v176, v53, v54
    v_max3_f32 v176, v176, v55, v56
    v_max3_f32 v176, v176, v57, v58
    v_max3_f32 v176, v176, v59, v60
    v_max3_f32 v176, v176, v61, v62
    v_max_f32 v176, v176, v63
    v_max_f32 v178, v178, v176
    s_sub_u32 s30, s30, 1
    s_cmp_lg_u32 s30, 0
    s_cbranch_scc1 s1_attn_kernel_8
    v_mov_b32 v177, v178
    s_nop 1
    v_permlane32_swap_b32 v177, v178
    s_nop 1
    v_max_f32 v178, v178, v177
    v_sub_f32 v136, 0, v178
    v_mov_b32 v96, 0
    v_sub_f32 v137, 0, v178
    v_mov_b32 v97, 0
    v_sub_f32 v138, 0, v178
    v_mov_b32 v98, 0
    v_sub_f32 v139, 0, v178
    v_mov_b32 v99, 0
    v_sub_f32 v140, 0, v178
    v_mov_b32 v100, 0
    v_sub_f32 v141, 0, v178
    v_mov_b32 v101, 0
    v_sub_f32 v142, 0, v178
    v_mov_b32 v102, 0
    v_sub_f32 v143, 0, v178
    v_mov_b32 v103, 0
    v_sub_f32 v144, 0, v178
    v_mov_b32 v104, 0
    v_sub_f32 v145, 0, v178
    v_mov_b32 v105, 0
    v_sub_f32 v146, 0, v178
    v_mov_b32 v106, 0
    v_sub_f32 v147, 0, v178
    v_mov_b32 v107, 0
    v_sub_f32 v148, 0, v178
    v_mov_b32 v108, 0
    v_sub_f32 v149, 0, v178
    v_mov_b32 v109, 0
    v_sub_f32 v150, 0, v178
    v_mov_b32 v110, 0
    v_sub_f32 v151, 0, v178
    v_mov_b32 v111, 0
    v_mov_b32 v128, 0
    v_mov_b32 v129, 0
    v_mov_b32 v130, 0
    v_mov_b32 v131, 0
    s_mov_b32 s28, s27
    s_add_u32 s29, s27, 4194304
    s_mov_b32 s30, 64
s2_attn_kernel_9:
    buffer_load_dwordx4 v[16:19], v173, s[8:11], s28 offen offset:0
    buffer_load_dwordx4 v[20:23], v173, s[8:11], s28 offen offset:1024
    s_add_u32 s28, s28, 2048
    buffer_load_dwordx4 v[32:35], v173, s[8:11], s29 offen offset:0
    buffer_load_dwordx4 v[36:39], v173, s[8:11], s29 offen offset:1024
    s_add_u32 s29, s29, 2048
    s_waitcnt vmcnt(0)
    v_mfma_f32_32x32x16_bf16 v[48:63], v[16:19], v[0:3], v[136:151]
    v_mfma_f32_32x32x16_bf16 v[48:63], v[20:23], v[4:7], v[48:63]
    s_nop 15
    v_exp_f32 v48, v48
    v_exp_f32 v49, v49
    v_exp_f32 v50, v50
    v_exp_f32 v51, v51
    v_exp_f32 v52, v52
    v_exp_f32 v53, v53
    v_exp_f32 v54, v54
    v_exp_f32 v55, v55
    v_exp_f32 v56, v56
    v_exp_f32 v57, v57
    v_exp_f32 v58, v58
    v_exp_f32 v59, v59
    v_exp_f32 v60, v60
    v_exp_f32 v61, v61
    v_exp_f32 v62, v62
    v_exp_f32 v63, v63
    s_nop 0
    v_cvt_pk_bf16_f32 v80, v48, v49
    v_cvt_pk_bf16_f32 v81, v50, v51
    v_cvt_pk_bf16_f32 v82, v52, v53
    v_cvt_pk_bf16_f32 v83, v54, v55
    v_cvt_pk_bf16_f32 v84, v56, v57
    v_cvt_pk_bf16_f32 v85, v58, v59
    v_cvt_pk_bf16_f32 v86, v60, v61
    v_cvt_pk_bf16_f32 v87, v62, v63
    s_nop 1
    v_mfma_f32_32x32x16_bf16 v[96:111], v[32:35], v[80:83], v[96:111]
    v_mfma_f32_32x32x16_bf16 v[96:111], v[36:39], v[84:87], v[96:111]
    v_mfma_f32_16x16x32_bf16 v[128:131], v[168:171], v[80:83], v[128:131]
    v_mfma_f32_16x16x32_bf16 v[128:131], v[168:171], v[84:87], v[128:131]
    s_nop 15
    s_sub_u32 s30, s30, 1
    s_cmp_lg_u32 s30, 0
    s_cbranch_scc1 s2_attn_kernel_9
    s_branch fin_attn_kernel_4
help_attn_kernel_2:
    s_load_dwordx2 s[6:7], s[0:1], 16
    s_load_dwordx4 s[36:39], s[0:1], 32
    s_load_dwordx2 s[40:41], s[0:1], 48
    s_sub_u32 s16, s16, 4
    s_lshr_b32 s44, s16, 1
    s_lshl_b32 s44, s44, 22
    s_add_u32 s44, s44, s27
    s_and_b32 s45, s16, 1
    s_lshl_b32 s45, s45, 10
    s_add_u32 s44, s44, s45
    s_lshl_b32 s45, s16, 10
    s_lshl_b32 s17, s2, 2
    s_add_u32 s17, s17, s16
    s_lshl_b32 s18, s17, 11
    s_waitcnt lgkmcnt(0)
    s_add_u32 s48, s4, 4194304
    s_addc_u32 s49, s5, 0
    s_and_b32 s49, s49, 0xffff
    s_mov_b32 s50, 12582912
    s_mov_b32 s51, 0x00020000
    s_add_u32 m0, s45, 0
    s_nop 0
    buffer_load_dwordx4 v173, s[48:51], s44 offen lds
    s_add_u32 s44, s44, 2048
    s_add_u32 m0, s45, 4096
    s_nop 0
    buffer_load_dwordx4 v173, s[48:51], s44 offen lds
    s_add_u32 s44, s44, 2048
    s_add_u32 m0, s45, 8192
    s_nop 0
    buffer_load_dwordx4 v173, s[48:51], s44 offen lds
    s_add_u32 s44, s44, 2048
    s_add_u32 m0, s45, 12288
    s_nop 0
    buffer_load_dwordx4 v173, s[48:51], s44 offen lds
    s_add_u32 s44, s44, 2048
    s_add_u32 m0, s45, 16384
    s_nop 0
    buffer_load_dwordx4 v173, s[48:51], s44 offen lds
    s_add_u32 s44, s44, 2048
    s_add_u32 m0, s45, 20480
    s_nop 0
    buffer_load_dwordx4 v173, s[48:51], s44 offen lds
    s_add_u32 s44, s44, 2048
    s_add_u32 m0, s45, 24576
    s_nop 0
    buffer_load_dwordx4 v173, s[48:51], s44 offen lds
    s_add_u32 s44, s44, 2048
    s_add_u32 m0, s45, 28672
    s_nop 0
    buffer_load_dwordx4 v173, s[48:51], s44 offen lds
    s_add_u32 s44, s44, 2048
    s_mov_b32 s8, s6
    s_and_b32 s9, s7, 0xffff
    s_mov_b32 s10, 2097152
    s_mov_b32 s11, 0x00020000
    s_add_u32 s12, s4, 46153728
    s_addc_u32 s13, s5, 0
    s_and_b32 s13, s13, 0xffff
    s_mov_b32 s14, 2048
    s_mov_b32 s15, 0x00020000
    s_waitcnt vmcnt(0)
    s_barrier
    s_add_u32 m0, s45, 32768
    s_nop 0
    buffer_load_dwordx4 v173, s[48:51], s44 offen lds
    s_add_u32 s44, s44, 2048
    s_add_u32 m0, s45, 36864
    s_nop 0
    buffer_load_dwordx4 v173, s[48:51], s44 offen lds
    s_add_u32 s44, s44, 2048
    s_add_u32 m0, s45, 40960
    s_nop 0
    buffer_load_dwordx4 v173, s[48:51], s44 offen lds
    s_add_u32 s44, s44, 2048
    s_add_u32 m0, s45, 45056
    s_nop 0
    buffer_load_dwordx4 v173, s[48:51], s44 offen lds
    s_add_u32 s44, s44, 2048
    s_add_u32 m0, s45, 49152
    s_nop 0
    buffer_load_dwordx4 v173, s[48:51], s44 offen lds
    s_add_u32 s44, s44, 2048
    s_add_u32 m0, s45, 53248
    s_nop 0
    buffer_load_dwordx4 v173, s[48:51], s44 offen lds
    s_add_u32 s44, s44, 2048
    s_add_u32 m0, s45, 57344
    s_nop 0
    buffer_load_dwordx4 v173, s[48:51], s44 offen lds
    s_add_u32 s44, s44, 2048
    s_add_u32 m0, s45, 61440
    s_nop 0
    buffer_load_dwordx4 v173, s[48:51], s44 offen lds
    s_add_u32 s44, s44, 2048
    s_add_u32 m0, s45, 65536
    s_nop 0
    buffer_load_dwordx4 v173, s[48:51], s44 offen lds
    s_add_u32 s44, s44, 2048
    s_add_u32 m0, s45, 69632
    s_nop 0
    buffer_load_dwordx4 v173, s[48:51], s44 offen lds
    s_add_u32 s44, s44, 2048
    s_add_u32 m0, s45, 73728
    s_nop 0
    buffer_load_dwordx4 v173, s[48:51], s44 offen lds
    s_add_u32 s44, s44, 2048
    s_add_u32 m0, s45, 77824
    s_nop 0
    buffer_load_dwordx4 v173, s[48:51], s44 offen lds
    s_add_u32 s44, s44, 2048
    s_add_u32 m0, s45, 81920
    s_nop 0
    buffer_load_dwordx4 v173, s[48:51], s44 offen lds
    s_add_u32 s44, s44, 2048
    s_add_u32 m0, s45, 86016
    s_nop 0
    buffer_load_dwordx4 v173, s[48:51], s44 offen lds
    s_add_u32 s44, s44, 2048
    s_add_u32 m0, s45, 90112
    s_nop 0
    buffer_load_dwordx4 v173, s[48:51], s44 offen lds
    s_add_u32 s44, s44, 2048
    s_add_u32 m0, s45, 94208
    s_nop 0
    buffer_load_dwordx4 v173, s[48:51], s44 offen lds
    s_add_u32 s44, s44, 2048
    s_add_u32 m0, s45, 98304
    s_nop 0
    buffer_load_dwordx4 v173, s[48:51], s44 offen lds
    s_add_u32 s44, s44, 2048
    s_add_u32 m0, s45, 102400
    s_nop 0
    buffer_load_dwordx4 v173, s[48:51], s44 offen lds
    s_add_u32 s44, s44, 2048
    s_add_u32 m0, s45, 106496
    s_nop 0
    buffer_load_dwordx4 v173, s[48:51], s44 offen lds
    s_add_u32 s44, s44, 2048
    s_add_u32 m0, s45, 110592
    s_nop 0
    buffer_load_dwordx4 v173, s[48:51], s44 offen lds
    s_add_u32 s44, s44, 2048
    s_add_u32 m0, s45, 114688
    s_nop 0
    buffer_load_dwordx4 v173, s[48:51], s44 offen lds
    s_add_u32 s44, s44, 2048
    s_add_u32 m0, s45, 118784
    s_nop 0
    buffer_load_dwordx4 v173, s[48:51], s44 offen lds
    s_add_u32 s44, s44, 2048
    s_add_u32 m0, s45, 122880
    s_nop 0
    buffer_load_dwordx4 v173, s[48:51], s44 offen lds
    s_add_u32 s44, s44, 2048
    s_add_u32 m0, s45, 126976
    s_nop 0
    buffer_load_dwordx4 v173, s[48:51], s44 offen lds
    s_add_u32 s44, s44, 2048
    buffer_load_dwordx4 v[16:19], v173, s[8:11], s18 offen offset:0
    buffer_load_dwordx4 v[20:23], v173, s[8:11], s18 offen offset:1024
    s_mov_b32 s20, s36
    s_and_b32 s21, s37, 0xffff
    s_mov_b32 s22, 7340032
    s_mov_b32 s23, 0x00020000
    s_mov_b32 s24, s38
    s_and_b32 s25, s39, 0xffff
    s_mov_b32 s26, 7340032
    s_mov_b32 s27, 0x00020000
    s_mov_b32 s28, s40
    s_and_b32 s29, s41, 0xffff
    s_mov_b32 s30, 7340032
    s_mov_b32 s31, 0x00020000
    v_mul_u32_u24 v1, 4682, v172
    v_lshrrev_b32 v1, 16, v1
    v_mul_u32_u24 v2, 14, v1
    v_sub_u32 v2, v172, v2
    v_mul_u32_u24 v1, 7168, v1
    v_lshl_add_u32 v1, v2, 7, v1
    v_cmp_gt_u32 vcc, 56, v172
    v_mov_b32 v2, 0x7f000000
    v_lshlrev_b32 v3, 7, v172
    v_cndmask_b32 v1, v2, v1, vcc
    v_cndmask_b32 v3, v2, v3, vcc
    s_lshr_b32 s32, s2, 3
    s_lshl_b32 s32, s32, 2
    s_add_u32 s32, s32, s16
    s_and_b32 s33, s2, 1
    s_lshl_b32 s33, s33, 7
    s_add_u32 s33, s33, s32
    s_mul_i32 s33, s33, 28672
    s_bfe_u32 s34, s2, 0x20001
    s_mul_i32 s34, s34, 1792
    s_add_u32 s33, s33, s34
    s_mul_i32 s34, s17, 7168
    v_lshrrev_b32 v4, 3, v172
    v_lshlrev_b32 v4, 11, v4
    v_and_b32 v5, 7, v172
    v_lshl_add_u32 v4, v5, 7, v4
    s_lshl_b32 s35, s32, 14
    s_bfe_u32 s42, s2, 0x10002
    s_lshl_b32 s42, s42, 10
    s_add_u32 s35, s35, s42
    v_mov_b32 v6, 0
    v_mov_b32 v7, 0x3f803f80
    s_waitcnt vmcnt(18)
    s_barrier
    s_waitcnt vmcnt(0)
    buffer_load_dword v8, v3, s[28:31], s34 offen
    v_dot2c_f32_bf16 v6, v16, v7
    v_dot2c_f32_bf16 v6, v17, v7
    v_dot2c_f32_bf16 v6, v18, v7
    v_dot2c_f32_bf16 v6, v19, v7
    v_dot2c_f32_bf16 v6, v20, v7
    v_dot2c_f32_bf16 v6, v21, v7
    v_dot2c_f32_bf16 v6, v22, v7
    v_dot2c_f32_bf16 v6, v23, v7
    s_nop 2
    s_nop 1
    v_add_f32 v6, v6, v6 row_shr:1 row_mask:0xf bank_mask:0xf bound_ctrl:0
    s_nop 1
    v_add_f32 v6, v6, v6 row_shr:2 row_mask:0xf bank_mask:0xf bound_ctrl:0
    s_nop 1
    v_add_f32 v6, v6, v6 row_shr:4 row_mask:0xf bank_mask:0xf bound_ctrl:0
    s_nop 1
    v_add_f32 v6, v6, v6 row_shr:8 row_mask:0xf bank_mask:0xf bound_ctrl:0
    s_nop 1
    v_add_f32 v6, v6, v6 row_bcast:15 row_mask:0xa bank_mask:0xf
    s_nop 1
    v_add_f32 v6, v6, v6 row_bcast:31 row_mask:0xc bank_mask:0xf
    v_mul_f32 v6, 0x3a800000, v6
    v_cvt_pk_bf16_f32 v6, v6, v6
    v_mov_b32 v11, 0
    s_lshl_b32 s17, s17, 1
    s_mov_b32 exec_lo, 0
    s_mov_b32 exec_hi, 0x80000000
    buffer_store_short v6, v11, s[12:15], s17 offen
    s_mov_b64 exec, -1
    s_add_u32 s12, s4, 50331648
    s_addc_u32 s13, s5, 0
    s_and_b32 s13, s13, 0xffff
    s_mov_b32 s14, 4194304
    s_mov_b32 s15, 0x00020000
    s_lshl_b32 s43, s18, 1
    v_mov_b32 v24, -1
    v_mov_b32 v25, -1
    v_mov_b32 v26, -1
    v_mov_b32 v27, -1
    buffer_store_dwordx4 v[24:27], v173, s[12:15], s43 offen offset:0 sc1
    buffer_store_dwordx4 v[24:27], v173, s[12:15], s43 offen offset:1024 sc1
    buffer_store_dwordx4 v[24:27], v173, s[12:15], s43 offen offset:2048 sc1
    buffer_store_dwordx4 v[24:27], v173, s[12:15], s43 offen offset:3072 sc1
    s_add_u32 s12, s4, 48234496
    s_addc_u32 s13, s5, 0
    s_and_b32 s13, s13, 0xffff
    s_mov_b32 s14, 262144
    s_mov_b32 s15, 0x00020000
    s_lshr_b32 s43, s18, 3
    v_lshlrev_b32 v28, 2, v172
    buffer_store_dword v11, v28, s[12:15], s43 offen
    s_barrier
    s_add_u32 m0, s45, 0
    s_nop 0
    buffer_load_dwordx4 v173, s[48:51], s44 offen lds
    s_add_u32 s44, s44, 2048
    s_add_u32 m0, s45, 4096
    s_nop 0
    buffer_load_dwordx4 v173, s[48:51], s44 offen lds
    s_add_u32 s44, s44, 2048
    s_add_u32 m0, s45, 8192
    s_nop 0
    buffer_load_dwordx4 v173, s[48:51], s44 offen lds
    s_add_u32 s44, s44, 2048
    s_add_u32 m0, s45, 12288
    s_nop 0
    buffer_load_dwordx4 v173, s[48:51], s44 offen lds
    s_add_u32 s44, s44, 2048
    s_add_u32 m0, s45, 16384
    s_nop 0
    buffer_load_dwordx4 v173, s[48:51], s44 offen lds
    s_add_u32 s44, s44, 2048
    s_add_u32 m0, s45, 20480
    s_nop 0
    buffer_load_dwordx4 v173, s[48:51], s44 offen lds
    s_add_u32 s44, s44, 2048
    s_add_u32 m0, s45, 24576
    s_nop 0
    buffer_load_dwordx4 v173, s[48:51], s44 offen lds
    s_add_u32 s44, s44, 2048
    s_add_u32 m0, s45, 28672
    s_nop 0
    buffer_load_dwordx4 v173, s[48:51], s44 offen lds
    s_add_u32 s44, s44, 2048
    buffer_load_dword v9, v1, s[20:23], s33 offen
    s_barrier
    s_add_u32 m0, s45, 32768
    s_nop 0
    buffer_load_dwordx4 v173, s[48:51], s44 offen lds
    s_add_u32 s44, s44, 2048
    s_add_u32 m0, s45, 36864
    s_nop 0
    buffer_load_dwordx4 v173, s[48:51], s44 offen lds
    s_add_u32 s44, s44, 2048
    s_add_u32 m0, s45, 40960
    s_nop 0
    buffer_load_dwordx4 v173, s[48:51], s44 offen lds
    s_add_u32 s44, s44, 2048
    s_add_u32 m0, s45, 45056
    s_nop 0
    buffer_load_dwordx4 v173, s[48:51], s44 offen lds
    s_add_u32 s44, s44, 2048
    s_add_u32 m0, s45, 49152
    s_nop 0
    buffer_load_dwordx4 v173, s[48:51], s44 offen lds
    s_add_u32 s44, s44, 2048
    s_add_u32 m0, s45, 53248
    s_nop 0
    buffer_load_dwordx4 v173, s[48:51], s44 offen lds
    s_add_u32 s44, s44, 2048
    s_add_u32 m0, s45, 57344
    s_nop 0
    buffer_load_dwordx4 v173, s[48:51], s44 offen lds
    s_add_u32 s44, s44, 2048
    s_add_u32 m0, s45, 61440
    s_nop 0
    buffer_load_dwordx4 v173, s[48:51], s44 offen lds
    s_add_u32 s44, s44, 2048
    s_waitcnt vmcnt(9)
    s_barrier
    s_add_u32 m0, s45, 65536
    s_nop 0
    buffer_load_dwordx4 v173, s[48:51], s44 offen lds
    s_add_u32 s44, s44, 2048
    s_add_u32 m0, s45, 69632
    s_nop 0
    buffer_load_dwordx4 v173, s[48:51], s44 offen lds
    s_add_u32 s44, s44, 2048
    s_add_u32 m0, s45, 73728
    s_nop 0
    buffer_load_dwordx4 v173, s[48:51], s44 offen lds
    s_add_u32 s44, s44, 2048
    s_add_u32 m0, s45, 77824
    s_nop 0
    buffer_load_dwordx4 v173, s[48:51], s44 offen lds
    s_add_u32 s44, s44, 2048
    s_add_u32 m0, s45, 81920
    s_nop 0
    buffer_load_dwordx4 v173, s[48:51], s44 offen lds
    s_add_u32 s44, s44, 2048
    s_add_u32 m0, s45, 86016
    s_nop 0
    buffer_load_dwordx4 v173, s[48:51], s44 offen lds
    s_add_u32 s44, s44, 2048
    s_add_u32 m0, s45, 90112
    s_nop 0
    buffer_load_dwordx4 v173, s[48:51], s44 offen lds
    s_add_u32 s44, s44, 2048
    s_add_u32 m0, s45, 94208
    s_nop 0
    buffer_load_dwordx4 v173, s[48:51], s44 offen lds
    s_add_u32 s44, s44, 2048
    buffer_load_dword v10, v1, s[24:27], s33 offen
    s_waitcnt vmcnt(9)
    s_barrier
    s_add_u32 m0, s45, 98304
    s_nop 0
    buffer_load_dwordx4 v173, s[48:51], s44 offen lds
    s_add_u32 s44, s44, 2048
    s_add_u32 m0, s45, 102400
    s_nop 0
    buffer_load_dwordx4 v173, s[48:51], s44 offen lds
    s_add_u32 s44, s44, 2048
    s_add_u32 m0, s45, 106496
    s_nop 0
    buffer_load_dwordx4 v173, s[48:51], s44 offen lds
    s_add_u32 s44, s44, 2048
    s_add_u32 m0, s45, 110592
    s_nop 0
    buffer_load_dwordx4 v173, s[48:51], s44 offen lds
    s_add_u32 s44, s44, 2048
    s_add_u32 m0, s45, 114688
    s_nop 0
    buffer_load_dwordx4 v173, s[48:51], s44 offen lds
    s_add_u32 s44, s44, 2048
    s_add_u32 m0, s45, 118784
    s_nop 0
    buffer_load_dwordx4 v173, s[48:51], s44 offen lds
    s_add_u32 s44, s44, 2048
    s_add_u32 m0, s45, 122880
    s_nop 0
    buffer_load_dwordx4 v173, s[48:51], s44 offen lds
    s_add_u32 s44, s44, 2048
    s_add_u32 m0, s45, 126976
    s_nop 0
    buffer_load_dwordx4 v173, s[48:51], s44 offen lds
    s_add_u32 s44, s44, 2048
    s_waitcnt vmcnt(9)
    s_barrier
    buffer_load_dword v8, v4, s[8:11], s35 offen
    s_waitcnt vmcnt(1)
    s_barrier
    s_endpgm
.p2align 8
.globl mlp_kernel
.type mlp_kernel,@function
mlp_kernel:
    s_cmp_lt_u32 s2, 256
    s_cbranch_scc1 go_mlp_kernel_1
    s_endpgm
go_mlp_kernel_1:
    s_load_dwordx2 s[4:5], s[0:1], 72
    s_load_dwordx4 s[36:39], s[0:1], 32
    s_load_dwordx2 s[6:7], s[0:1], 16
    s_load_dwordx2 s[34:35], s[0:1], 0
    v_lshrrev_b32 v224, 6, v0
    s_nop 0
    v_readfirstlane_b32 s16, v224
    v_and_b32 v224, 63, v0
    s_and_b32 s17, s2, 3
    s_lshl_b32 s17, s17, 2
    s_bfe_u32 s18, s2, 0x20003
    s_add_u32 s17, s17, s18
    s_bfe_u32 s18, s2, 0x10002
    s_lshl_b32 s18, s18, 3
    s_lshr_b32 s19, s2, 5
    s_add_u32 s18, s18, s19
    s_lshl_b32 s30, s17, 2
    s_add_u32 s30, s30, s16
    s_lshl_b32 s22, s30, 16
    v_lshlrev_b32 v155, 4, v224
    v_add_u32 v144, s22, v155
    v_lshrrev_b32 v170, 3, v224
    v_and_b32 v171, 7, v224
    v_bfe_u32 v172, v224, 4, 1
    v_lshlrev_b32 v172, 2, v172
    v_xor_b32 v171, v171, v172
    v_lshlrev_b32 v170, 11, v170
    v_lshl_add_u32 v170, v171, 4, v170
    s_lshl_b32 s22, s16, 15
    s_lshl_b32 s23, s18, 7
    s_add_u32 s22, s22, s23
    v_add_u32 v145, s22, v170
    v_add_u32 v146, 0x4000, v145
    s_lshl_b32 s24, s16, 12
    s_lshl_b32 s25, s16, 11
    s_add_u32 s25, s25, 16384
    s_mov_b32 s26, 0
    s_mov_b32 s27, 0
    s_and_b32 s20, s16, 1
    s_lshr_b32 s21, s16, 1
    s_lshl_b32 s22, s20, 10
    s_add_u32 m0, s22, 147456
    s_add_u32 s22, s22, 16384
    s_waitcnt lgkmcnt(0)
    s_add_u32 s48, s4, 46137344
    s_addc_u32 s49, s5, 0
    s_and_b32 s49, s49, 0xffff
    s_mov_b32 s50, 327680
    s_mov_b32 s51, 0x00020000
    s_add_u32 s8, s4, 16777216
    s_addc_u32 s9, s5, 0
    s_and_b32 s9, s9, 0xffff
    s_mov_b32 s10, 4194304
    s_mov_b32 s11, 0x00020000
    s_mov_b32 s12, s6
    s_and_b32 s13, s7, 0xffff
    s_mov_b32 s14, 2097152
    s_mov_b32 s15, 0x00020000
    buffer_load_dwordx4 v155, s[48:51], s22 offen lds
    s_add_u32 m0, s25, 0
    s_nop 0
    buffer_load_dwordx4 v145, s[12:15], s27 offen lds
    s_add_u32 m0, s25, 1024
    s_nop 0
    buffer_load_dwordx4 v146, s[12:15], s27 offen lds
    s_add_u32 m0, s24, 0
    s_nop 0
    buffer_load_dwordx4 v144, s[8:11], s26 offen offset:0 lds
    buffer_load_dwordx4 v144, s[8:11], s26 offen offset:1024 lds
    s_add_u32 m0, s24, 0
    s_nop 0
    buffer_load_dwordx4 v144, s[8:11], s26 offen offset:2048 lds
    buffer_load_dwordx4 v144, s[8:11], s26 offen offset:3072 lds
    s_add_u32 s26, s26, 4096
    s_add_u32 s27, s27, 131072
    s_add_u32 m0, s25, 24576
    s_nop 0
    buffer_load_dwordx4 v145, s[12:15], s27 offen lds
    s_add_u32 m0, s25, 25600
    s_nop 0
    buffer_load_dwordx4 v146, s[12:15], s27 offen lds
    s_add_u32 m0, s24, 24576
    s_nop 0
    buffer_load_dwordx4 v144, s[8:11], s26 offen offset:0 lds
    buffer_load_dwordx4 v144, s[8:11], s26 offen offset:1024 lds
    s_add_u32 m0, s24, 24576
    s_nop 0
    buffer_load_dwordx4 v144, s[8:11], s26 offen offset:2048 lds
    buffer_load_dwordx4 v144, s[8:11], s26 offen offset:3072 lds
    s_add_u32 s26, s26, 4096
    s_add_u32 s27, s27, 131072
    s_add_u32 m0, s25, 49152
    s_nop 0
    buffer_load_dwordx4 v145, s[12:15], s27 offen lds
    s_add_u32 m0, s25, 50176
    s_nop 0
    buffer_load_dwordx4 v146, s[12:15], s27 offen lds
    s_add_u32 m0, s24, 49152
    s_nop 0
    buffer_load_dwordx4 v144, s[8:11], s26 offen offset:0 lds
    buffer_load_dwordx4 v144, s[8:11], s26 offen offset:1024 lds
    s_add_u32 m0, s24, 49152
    s_nop 0
    buffer_load_dwordx4 v144, s[8:11], s26 offen offset:2048 lds
    buffer_load_dwordx4 v144, s[8:11], s26 offen offset:3072 lds
    s_add_u32 s26, s26, 4096
    s_add_u32 s27, s27, 131072
    s_add_u32 m0, s25, 73728
    s_nop 0
    buffer_load_dwordx4 v145, s[12:15], s27 offen lds
    s_add_u32 m0, s25, 74752
    s_nop 0
    buffer_load_dwordx4 v146, s[12:15], s27 offen lds
    s_add_u32 m0, s24, 73728
    s_nop 0
    buffer_load_dwordx4 v144, s[8:11], s26 offen offset:0 lds
    buffer_load_dwordx4 v144, s[8:11], s26 offen offset:1024 lds
    s_add_u32 m0, s24, 73728
    s_nop 0
    buffer_load_dwordx4 v144, s[8:11], s26 offen offset:2048 lds
    buffer_load_dwordx4 v144, s[8:11], s26 offen offset:3072 lds
    s_add_u32 s26, s26, 4096
    s_add_u32 s27, s27, 131072
    s_add_u32 m0, s25, 98304
    s_nop 0
    buffer_load_dwordx4 v145, s[12:15], s27 offen lds
    s_add_u32 m0, s25, 99328
    s_nop 0
    buffer_load_dwordx4 v146, s[12:15], s27 offen lds
    s_add_u32 m0, s24, 98304
    s_nop 0
    buffer_load_dwordx4 v144, s[8:11], s26 offen offset:0 lds
    buffer_load_dwordx4 v144, s[8:11], s26 offen offset:1024 lds
    s_add_u32 m0, s24, 98304
    s_nop 0
    buffer_load_dwordx4 v144, s[8:11], s26 offen offset:2048 lds
    buffer_load_dwordx4 v144, s[8:11], s26 offen offset:3072 lds
    s_add_u32 s26, s26, 4096
    s_add_u32 s27, s27, 131072
    s_add_u32 m0, s25, 122880
    s_nop 0
    buffer_load_dwordx4 v145, s[12:15], s27 offen lds
    s_add_u32 m0, s25, 123904
    s_nop 0
    buffer_load_dwordx4 v146, s[12:15], s27 offen lds
    s_add_u32 m0, s24, 122880
    s_nop 0
    buffer_load_dwordx4 v144, s[8:11], s26 offen offset:0 lds
    buffer_load_dwordx4 v144, s[8:11], s26 offen offset:1024 lds
    s_lshl_b32 s22, s21, 13
    v_add_u32 v156, s22, v155
    s_lshl_b32 s30, s17, 2
    s_lshl_b32 s22, s21, 1
    s_add_u32 s30, s30, s22
    s_lshl_b32 s22, s30, 16
    s_lshl_b32 s23, s18, 1
    s_add_u32 s23, s23, s20
    s_lshl_b32 s29, s23, 6
    s_add_u32 s29, s29, s22
    v_and_b32 v154, 31, v224
    v_lshlrev_b32 v170, 11, v154
    v_lshrrev_b32 v171, 5, v224
    v_lshl_add_u32 v170, v171, 4, v170
    v_add_u32 v148, s29, v170
    v_add_u32 v149, 0x10000, v148
    s_lshl_b32 s29, s23, 11
    s_add_u32 s29, s29, s22
    v_add_u32 v150, s29, v155
    v_add_u32 v151, 0x10000, v150
    s_lshl_b32 s22, s16, 9
    s_add_u32 s22, s22, 149504
    v_lshl_add_u32 v170, v224, 3, s22
    v_mov_b32 v172, 0
    v_mov_b32 v173, 0
    ds_write_b64 v170, v[172:173]
    v_lshrrev_b32 v170, 2, v224
    v_xor_b32 v170, v170, v224
    v_bfe_u32 v170, v170, 2, 1
    v_lshl_add_u32 v171, v170, 7, v171
    v_lshlrev_b32 v155, 4, v171
    v_add_u32 v155, 147456, v155
    v_lshlrev_b32 v154, 2, v154
    s_lshl_b32 s31, s30, 7
    v_lshrrev_b32 v170, 4, v224
    v_bfe_u32 v171, v224, 2, 2
    v_and_b32 v172, 1, v224
    v_lshlrev_b32 v172, 1, v172
    v_bfe_u32 v173, v224, 1, 1
    v_or_b32 v172, v172, v173
    v_and_b32 v173, 1, v170
    v_lshlrev_b32 v173, 1, v173
    s_lshl_b32 s22, s20, 2
    v_add_u32 v173, s22, v173
    v_lshrrev_b32 v174, 1, v172
    v_add_u32 v173, v173, v174
    v_lshrrev_b32 v174, 1, v171
    v_lshlrev_b32 v174, 2, v174
    v_xor_b32 v173, v173, v174
    v_lshlrev_b32 v173, 4, v173
    v_and_b32 v174, 1, v172
    v_lshl_add_u32 v173, v174, 3, v173
    v_lshl_add_u32 v173, v171, 7, v173
    v_lshrrev_b32 v174, 1, v170
    v_lshl_add_u32 v160, v174, 10, v173
    v_add_u32 v157, 49152, v156
    v_add_u32 v161, 49152, v160
    v_add_u32 v158, 98304, v156
    v_add_u32 v162, 98304, v160
    s_add_u32 s40, s4, 25165824
    s_addc_u32 s41, s5, 0
    s_and_b32 s41, s41, 0xffff
    s_mov_b32 s42, 4194304
    s_mov_b32 s43, 0x00020000
    s_mov_b32 s44, s34
    s_and_b32 s45, s35, 0xffff
    s_mov_b32 s46, 4194304
    s_mov_b32 s47, 0x00020000
    s_waitcnt lgkmcnt(0)
    s_waitcnt vmcnt(28)
    s_barrier
    ds_read_b128 v[64:67], v156 offset:0
    ds_read_b64_tr_b16 v[72:73], v160 offset:16384
    ds_read_b64_tr_b16 v[74:75], v160 offset:16896
    ds_read_b128 v[68:71], v156 offset:4096
    ds_read_b128 v[76:79], v155 offset:0
    ds_read_b128 v[80:83], v156 offset:1024
    ds_read_b64_tr_b16 v[88:89], v160 offset:18432
    ds_read_b64_tr_b16 v[90:91], v160 offset:18944
    ds_read_b128 v[84:87], v156 offset:5120
    ds_read_b128 v[92:95], v155 offset:32
    s_waitcnt lgkmcnt(7)
    v_mfma_f32_32x32x16_bf16 v[0:15], v[72:75], v[64:67], 0
    ds_read_b128 v[96:99], v156 offset:2048
    s_waitcnt lgkmcnt(7)
    v_mfma_f32_32x32x16_bf16 v[16:31], v[72:75], v[68:71], 0
    ds_read_b64_tr_b16 v[104:105], v160 offset:20480
    ds_read_b64_tr_b16 v[106:107], v160 offset:20992
    s_waitcnt lgkmcnt(8)
    v_mfma_f32_16x16x32_bf16 v[32:35], v[76:79], v[64:67], 0
    ds_read_b128 v[100:103], v156 offset:6144
    ds_read_b128 v[108:111], v155 offset:64
    v_mfma_f32_16x16x32_bf16 v[48:51], v[76:79], v[68:71], 0
    ds_read_b128 v[112:115], v156 offset:3072
    s_waitcnt lgkmcnt(8)
    v_mfma_f32_32x32x16_bf16 v[0:15], v[88:91], v[80:83], v[0:15]
    ds_read_b64_tr_b16 v[120:121], v160 offset:22528
    ds_read_b64_tr_b16 v[122:123], v160 offset:23040
    s_add_u32 m0, s24, 122880
    s_nop 0
    buffer_load_dwordx4 v144, s[8:11], s26 offen offset:2048 lds
    s_waitcnt lgkmcnt(9)
    v_mfma_f32_32x32x16_bf16 v[16:31], v[88:91], v[84:87], v[16:31]
    ds_read_b128 v[116:119], v156 offset:7168
    ds_read_b128 v[124:127], v155 offset:96
    v_add_u32 v155, 128, v155
    s_waitcnt lgkmcnt(10)
    v_mfma_f32_16x16x32_bf16 v[32:35], v[92:95], v[80:83], v[32:35]
    v_mfma_f32_16x16x32_bf16 v[48:51], v[92:95], v[84:87], v[48:51]
    buffer_load_dwordx4 v144, s[8:11], s26 offen offset:3072 lds
    s_add_u32 s26, s26, 4096
    s_add_u32 s27, s27, 131072
    s_waitcnt lgkmcnt(7)
    v_mfma_f32_32x32x16_bf16 v[0:15], v[104:107], v[96:99], v[0:15]
    s_waitcnt lgkmcnt(6)
    v_mfma_f32_32x32x16_bf16 v[16:31], v[104:107], v[100:103], v[16:31]
    s_waitcnt vmcnt(24) lgkmcnt(0)
    s_barrier
    ds_read_b128 v[64:67], v156 offset:24576
    v_mfma_f32_16x16x32_bf16 v[32:35], v[108:111], v[96:99], v[32:35]
    ds_read_b64_tr_b16 v[72:73], v160 offset:40960
    ds_read_b64_tr_b16 v[74:75], v160 offset:41472
    s_add_u32 m0, s25, 0
    s_nop 0
    buffer_load_dwordx4 v145, s[12:15], s27 offen lds
    v_mfma_f32_16x16x32_bf16 v[48:51], v[108:111], v[100:103], v[48:51]
    ds_read_b128 v[68:71], v156 offset:28672
    ds_read_b128 v[76:79], v155 offset:0
    v_mfma_f32_32x32x16_bf16 v[0:15], v[120:123], v[112:115], v[0:15]
    ds_read_b128 v[80:83], v156 offset:25600
    s_add_u32 m0, s25, 1024
    s_nop 0
    buffer_load_dwordx4 v146, s[12:15], s27 offen lds
    v_mfma_f32_32x32x16_bf16 v[16:31], v[120:123], v[116:119], v[16:31]
    ds_read_b64_tr_b16 v[88:89], v160 offset:43008
    ds_read_b64_tr_b16 v[90:91], v160 offset:43520
    v_mfma_f32_16x16x32_bf16 v[32:35], v[124:127], v[112:115], v[32:35]
    ds_read_b128 v[84:87], v156 offset:29696
    ds_read_b128 v[92:95], v155 offset:32
    s_add_u32 m0, s24, 0
    s_nop 0
    buffer_load_dwordx4 v144, s[8:11], s26 offen offset:0 lds
    v_mfma_f32_16x16x32_bf16 v[48:51], v[124:127], v[116:119], v[48:51]
    buffer_load_dwordx4 v144, s[8:11], s26 offen offset:1024 lds
    s_waitcnt lgkmcnt(7)
    v_mfma_f32_32x32x16_bf16 v[0:15], v[72:75], v[64:67], v[0:15]
    ds_read_b128 v[96:99], v156 offset:26624
    s_waitcnt lgkmcnt(7)
    v_mfma_f32_32x32x16_bf16 v[16:31], v[72:75], v[68:71], v[16:31]
    ds_read_b64_tr_b16 v[104:105], v160 offset:45056
    ds_read_b64_tr_b16 v[106:107], v160 offset:45568
    s_waitcnt lgkmcnt(8)
    v_mfma_f32_16x16x32_bf16 v[32:35], v[76:79], v[64:67], v[32:35]
    ds_read_b128 v[100:103], v156 offset:30720
    ds_read_b128 v[108:111], v155 offset:64
    v_mfma_f32_16x16x32_bf16 v[48:51], v[76:79], v[68:71], v[48:51]
    ds_read_b128 v[112:115], v156 offset:27648
    s_waitcnt lgkmcnt(8)
    v_mfma_f32_32x32x16_bf16 v[0:15], v[88:91], v[80:83], v[0:15]
    ds_read_b64_tr_b16 v[120:121], v160 offset:47104
    ds_read_b64_tr_b16 v[122:123], v160 offset:47616
    s_add_u32 m0, s24, 0
    s_nop 0
    buffer_load_dwordx4 v144, s[8:11], s26 offen offset:2048 lds
    s_waitcnt lgkmcnt(9)
    v_mfma_f32_32x32x16_bf16 v[16:31], v[88:91], v[84:87], v[16:31]
    ds_read_b128 v[116:119], v156 offset:31744
    ds_read_b128 v[124:127], v155 offset:96
    v_add_u32 v155, 128, v155
    s_waitcnt lgkmcnt(10)
    v_mfma_f32_16x16x32_bf16 v[32:35], v[92:95], v[80:83], v[32:35]
    v_mfma_f32_16x16x32_bf16 v[48:51], v[92:95], v[84:87], v[48:51]
    buffer_load_dwordx4 v144, s[8:11], s26 offen offset:3072 lds
    s_add_u32 s26, s26, 4096
    s_add_u32 s27, s27, 131072
    s_waitcnt lgkmcnt(7)
    v_mfma_f32_32x32x16_bf16 v[0:15], v[104:107], v[96:99], v[0:15]
    s_waitcnt lgkmcnt(6)
    v_mfma_f32_32x32x16_bf16 v[16:31], v[104:107], v[100:103], v[16:31]
    s_waitcnt vmcnt(24) lgkmcnt(0)
    s_barrier
    ds_read_b128 v[64:67], v157 offset:0
    v_mfma_f32_16x16x32_bf16 v[32:35], v[108:111], v[96:99], v[32:35]
    ds_read_b64_tr_b16 v[72:73], v161 offset:16384
    ds_read_b64_tr_b16 v[74:75], v161 offset:16896
    s_add_u32 m0, s25, 24576
    s_nop 0
    buffer_load_dwordx4 v145, s[12:15], s27 offen lds
    v_mfma_f32_16x16x32_bf16 v[48:51], v[108:111], v[100:103], v[48:51]
    ds_read_b128 v[68:71], v157 offset:4096
    ds_read_b128 v[76:79], v155 offset:0
    v_mfma_f32_32x32x16_bf16 v[0:15], v[120:123], v[112:115], v[0:15]
    ds_read_b128 v[80:83], v157 offset:1024
    s_add_u32 m0, s25, 25600
    s_nop 0
    buffer_load_dwordx4 v146, s[12:15], s27 offen lds
    v_mfma_f32_32x32x16_bf16 v[16:31], v[120:123], v[116:119], v[16:31]
    ds_read_b64_tr_b16 v[88:89], v161 offset:18432
    ds_read_b64_tr_b16 v[90:91], v161 offset:18944
    v_mfma_f32_16x16x32_bf16 v[32:35], v[124:127], v[112:115], v[32:35]
    ds_read_b128 v[84:87], v157 offset:5120
    ds_read_b128 v[92:95], v155 offset:32
    s_add_u32 m0, s24, 24576
    s_nop 0
    buffer_load_dwordx4 v144, s[8:11], s26 offen offset:0 lds
    v_mfma_f32_16x16x32_bf16 v[48:51], v[124:127], v[116:119], v[48:51]
    buffer_load_dwordx4 v144, s[8:11], s26 offen offset:1024 lds
    s_waitcnt lgkmcnt(7)
    v_mfma_f32_32x32x16_bf16 v[0:15], v[72:75], v[64:67], v[0:15]
    ds_read_b128 v[96:99], v157 offset:2048
    s_waitcnt lgkmcnt(7)
    v_mfma_f32_32x32x16_bf16 v[16:31], v[72:75], v[68:71], v[16:31]
    ds_read_b64_tr_b16 v[104:105], v161 offset:20480
    ds_read_b64_tr_b16 v[106:107], v161 offset:20992
    s_waitcnt lgkmcnt(8)
    v_mfma_f32_16x16x32_bf16 v[32:35], v[76:79], v[64:67], v[32:35]
    ds_read_b128 v[100:103], v157 offset:6144
    ds_read_b128 v[108:111], v155 offset:64
    v_mfma_f32_16x16x32_bf16 v[48:51], v[76:79], v[68:71], v[48:51]
    ds_read_b128 v[112:115], v157 offset:3072
    s_waitcnt lgkmcnt(8)
    v_mfma_f32_32x32x16_bf16 v[0:15], v[88:91], v[80:83], v[0:15]
    ds_read_b64_tr_b16 v[120:121], v161 offset:22528
    ds_read_b64_tr_b16 v[122:123], v161 offset:23040
    s_add_u32 m0, s24, 24576
    s_nop 0
    buffer_load_dwordx4 v144, s[8:11], s26 offen offset:2048 lds
    s_waitcnt lgkmcnt(9)
    v_mfma_f32_32x32x16_bf16 v[16:31], v[88:91], v[84:87], v[16:31]
    ds_read_b128 v[116:119], v157 offset:7168
    ds_read_b128 v[124:127], v155 offset:96
    v_add_u32 v155, 128, v155
    s_waitcnt lgkmcnt(10)
    v_mfma_f32_16x16x32_bf16 v[32:35], v[92:95], v[80:83], v[32:35]
    v_mfma_f32_16x16x32_bf16 v[48:51], v[92:95], v[84:87], v[48:51]
    buffer_load_dwordx4 v144, s[8:11], s26 offen offset:3072 lds
    s_add_u32 s26, s26, 4096
    s_add_u32 s27, s27, 131072
    s_waitcnt lgkmcnt(7)
    v_mfma_f32_32x32x16_bf16 v[0:15], v[104:107], v[96:99], v[0:15]
    s_waitcnt lgkmcnt(6)
    v_mfma_f32_32x32x16_bf16 v[16:31], v[104:107], v[100:103], v[16:31]
    s_waitcnt vmcnt(24) lgkmcnt(0)
    s_barrier
    ds_read_b128 v[64:67], v157 offset:24576
    v_mfma_f32_16x16x32_bf16 v[32:35], v[108:111], v[96:99], v[32:35]
    ds_read_b64_tr_b16 v[72:73], v161 offset:40960
    ds_read_b64_tr_b16 v[74:75], v161 offset:41472
    s_add_u32 m0, s25, 49152
    s_nop 0
    buffer_load_dwordx4 v145, s[12:15], s27 offen lds
    v_mfma_f32_16x16x32_bf16 v[48:51], v[108:111], v[100:103], v[48:51]
    ds_read_b128 v[68:71], v157 offset:28672
    ds_read_b128 v[76:79], v155 offset:0
    v_mfma_f32_32x32x16_bf16 v[0:15], v[120:123], v[112:115], v[0:15]
    ds_read_b128 v[80:83], v157 offset:25600
    s_add_u32 m0, s25, 50176
    s_nop 0
    buffer_load_dwordx4 v146, s[12:15], s27 offen lds
    v_mfma_f32_32x32x16_bf16 v[16:31], v[120:123], v[116:119], v[16:31]
    ds_read_b64_tr_b16 v[88:89], v161 offset:43008
    ds_read_b64_tr_b16 v[90:91], v161 offset:43520
    v_mfma_f32_16x16x32_bf16 v[32:35], v[124:127], v[112:115], v[32:35]
    ds_read_b128 v[84:87], v157 offset:29696
    ds_read_b128 v[92:95], v155 offset:32
    s_add_u32 m0, s24, 49152
    s_nop 0
    buffer_load_dwordx4 v144, s[8:11], s26 offen offset:0 lds
    v_mfma_f32_16x16x32_bf16 v[48:51], v[124:127], v[116:119], v[48:51]
    buffer_load_dwordx4 v144, s[8:11], s26 offen offset:1024 lds
    s_waitcnt lgkmcnt(7)
    v_mfma_f32_32x32x16_bf16 v[0:15], v[72:75], v[64:67], v[0:15]
    ds_read_b128 v[96:99], v157 offset:26624
    s_waitcnt lgkmcnt(7)
    v_mfma_f32_32x32x16_bf16 v[16:31], v[72:75], v[68:71], v[16:31]
    ds_read_b64_tr_b16 v[104:105], v161 offset:45056
    ds_read_b64_tr_b16 v[106:107], v161 offset:45568
    s_waitcnt lgkmcnt(8)
    v_mfma_f32_16x16x32_bf16 v[32:35], v[76:79], v[64:67], v[32:35]
    ds_read_b128 v[100:103], v157 offset:30720
    ds_read_b128 v[108:111], v155 offset:64
    v_mfma_f32_16x16x32_bf16 v[48:51], v[76:79], v[68:71], v[48:51]
    ds_read_b128 v[112:115], v157 offset:27648
    s_waitcnt lgkmcnt(8)
    v_mfma_f32_32x32x16_bf16 v[0:15], v[88:91], v[80:83], v[0:15]
    ds_read_b64_tr_b16 v[120:121], v161 offset:47104
    ds_read_b64_tr_b16 v[122:123], v161 offset:47616
    s_add_u32 m0, s24, 49152
    s_nop 0
    buffer_load_dwordx4 v144, s[8:11], s26 offen offset:2048 lds
    s_waitcnt lgkmcnt(9)
    v_mfma_f32_32x32x16_bf16 v[16:31], v[88:91], v[84:87], v[16:31]
    ds_read_b128 v[116:119], v157 offset:31744
    ds_read_b128 v[124:127], v155 offset:96
    v_add_u32 v155, 128, v155
    s_waitcnt lgkmcnt(10)
    v_mfma_f32_16x16x32_bf16 v[32:35], v[92:95], v[80:83], v[32:35]
    v_mfma_f32_16x16x32_bf16 v[48:51], v[92:95], v[84:87], v[48:51]
    buffer_load_dwordx4 v144, s[8:11], s26 offen offset:3072 lds
    s_add_u32 s26, s26, 4096
    s_add_u32 s27, s27, 131072
    s_waitcnt lgkmcnt(7)
    v_mfma_f32_32x32x16_bf16 v[0:15], v[104:107], v[96:99], v[0:15]
    s_waitcnt lgkmcnt(6)
    v_mfma_f32_32x32x16_bf16 v[16:31], v[104:107], v[100:103], v[16:31]
    s_waitcnt vmcnt(24) lgkmcnt(0)
    s_barrier
    ds_read_b128 v[64:67], v158 offset:0
    v_mfma_f32_16x16x32_bf16 v[32:35], v[108:111], v[96:99], v[32:35]
    ds_read_b64_tr_b16 v[72:73], v162 offset:16384
    ds_read_b64_tr_b16 v[74:75], v162 offset:16896
    s_add_u32 m0, s25, 73728
    s_nop 0
    buffer_load_dwordx4 v145, s[12:15], s27 offen lds
    v_mfma_f32_16x16x32_bf16 v[48:51], v[108:111], v[100:103], v[48:51]
    ds_read_b128 v[68:71], v158 offset:4096
    ds_read_b128 v[76:79], v155 offset:0
    v_mfma_f32_32x32x16_bf16 v[0:15], v[120:123], v[112:115], v[0:15]
    ds_read_b128 v[80:83], v158 offset:1024
    s_add_u32 m0, s25, 74752
    s_nop 0
    buffer_load_dwordx4 v146, s[12:15], s27 offen lds
    v_mfma_f32_32x32x16_bf16 v[16:31], v[120:123], v[116:119], v[16:31]
    ds_read_b64_tr_b16 v[88:89], v162 offset:18432
    ds_read_b64_tr_b16 v[90:91], v162 offset:18944
    v_mfma_f32_16x16x32_bf16 v[32:35], v[124:127], v[112:115], v[32:35]
    ds_read_b128 v[84:87], v158 offset:5120
    ds_read_b128 v[92:95], v155 offset:32
    s_add_u32 m0, s24, 73728
    s_nop 0
    buffer_load_dwordx4 v144, s[8:11], s26 offen offset:0 lds
    v_mfma_f32_16x16x32_bf16 v[48:51], v[124:127], v[116:119], v[48:51]
    buffer_load_dwordx4 v144, s[8:11], s26 offen offset:1024 lds
    s_waitcnt lgkmcnt(7)
    v_mfma_f32_32x32x16_bf16 v[0:15], v[72:75], v[64:67], v[0:15]
    ds_read_b128 v[96:99], v158 offset:2048
    s_waitcnt lgkmcnt(7)
    v_mfma_f32_32x32x16_bf16 v[16:31], v[72:75], v[68:71], v[16:31]
    ds_read_b64_tr_b16 v[104:105], v162 offset:20480
    ds_read_b64_tr_b16 v[106:107], v162 offset:20992
    s_waitcnt lgkmcnt(8)
    v_mfma_f32_16x16x32_bf16 v[32:35], v[76:79], v[64:67], v[32:35]
    ds_read_b128 v[100:103], v158 offset:6144
    ds_read_b128 v[108:111], v155 offset:64
    v_mfma_f32_16x16x32_bf16 v[48:51], v[76:79], v[68:71], v[48:51]
    ds_read_b128 v[112:115], v158 offset:3072
    s_waitcnt lgkmcnt(8)
    v_mfma_f32_32x32x16_bf16 v[0:15], v[88:91], v[80:83], v[0:15]
    ds_read_b64_tr_b16 v[120:121], v162 offset:22528
    ds_read_b64_tr_b16 v[122:123], v162 offset:23040
    s_add_u32 m0, s24, 73728
    s_nop 0
    buffer_load_dwordx4 v144, s[8:11], s26 offen offset:2048 lds
    s_waitcnt lgkmcnt(9)
    v_mfma_f32_32x32x16_bf16 v[16:31], v[88:91], v[84:87], v[16:31]
    ds_read_b128 v[116:119], v158 offset:7168
    ds_read_b128 v[124:127], v155 offset:96
    v_add_u32 v155, 128, v155
    s_waitcnt lgkmcnt(10)
    v_mfma_f32_16x16x32_bf16 v[32:35], v[92:95], v[80:83], v[32:35]
    v_mfma_f32_16x16x32_bf16 v[48:51], v[92:95], v[84:87], v[48:51]
    buffer_load_dwordx4 v144, s[8:11], s26 offen offset:3072 lds
    s_add_u32 s26, s26, 4096
    s_add_u32 s27, s27, 131072
    s_waitcnt lgkmcnt(7)
    v_mfma_f32_32x32x16_bf16 v[0:15], v[104:107], v[96:99], v[0:15]
    s_waitcnt lgkmcnt(6)
    v_mfma_f32_32x32x16_bf16 v[16:31], v[104:107], v[100:103], v[16:31]
    s_waitcnt vmcnt(24) lgkmcnt(0)
    s_barrier
    ds_read_b128 v[64:67], v158 offset:24576
    v_mfma_f32_16x16x32_bf16 v[32:35], v[108:111], v[96:99], v[32:35]
    ds_read_b64_tr_b16 v[72:73], v162 offset:40960
    ds_read_b64_tr_b16 v[74:75], v162 offset:41472
    s_add_u32 m0, s25, 98304
    s_nop 0
    buffer_load_dwordx4 v145, s[12:15], s27 offen lds
    v_mfma_f32_16x16x32_bf16 v[48:51], v[108:111], v[100:103], v[48:51]
    ds_read_b128 v[68:71], v158 offset:28672
    ds_read_b128 v[76:79], v155 offset:0
    v_mfma_f32_32x32x16_bf16 v[0:15], v[120:123], v[112:115], v[0:15]
    ds_read_b128 v[80:83], v158 offset:25600
    s_add_u32 m0, s25, 99328
    s_nop 0
    buffer_load_dwordx4 v146, s[12:15], s27 offen lds
    v_mfma_f32_32x32x16_bf16 v[16:31], v[120:123], v[116:119], v[16:31]
    ds_read_b64_tr_b16 v[88:89], v162 offset:43008
    ds_read_b64_tr_b16 v[90:91], v162 offset:43520
    v_mfma_f32_16x16x32_bf16 v[32:35], v[124:127], v[112:115], v[32:35]
    ds_read_b128 v[84:87], v158 offset:29696
    ds_read_b128 v[92:95], v155 offset:32
    s_add_u32 m0, s24, 98304
    s_nop 0
    buffer_load_dwordx4 v144, s[8:11], s26 offen offset:0 lds
    v_mfma_f32_16x16x32_bf16 v[48:51], v[124:127], v[116:119], v[48:51]
    buffer_load_dwordx4 v144, s[8:11], s26 offen offset:1024 lds
    s_waitcnt lgkmcnt(7)
    v_mfma_f32_32x32x16_bf16 v[0:15], v[72:75], v[64:67], v[0:15]
    ds_read_b128 v[96:99], v158 offset:26624
    s_waitcnt lgkmcnt(7)
    v_mfma_f32_32x32x16_bf16 v[16:31], v[72:75], v[68:71], v[16:31]
    ds_read_b64_tr_b16 v[104:105], v162 offset:45056
    ds_read_b64_tr_b16 v[106:107], v162 offset:45568
    s_waitcnt lgkmcnt(8)
    v_mfma_f32_16x16x32_bf16 v[32:35], v[76:79], v[64:67], v[32:35]
    ds_read_b128 v[100:103], v158 offset:30720
    ds_read_b128 v[108:111], v155 offset:64
    v_mfma_f32_16x16x32_bf16 v[48:51], v[76:79], v[68:71], v[48:51]
    ds_read_b128 v[112:115], v158 offset:27648
    s_waitcnt lgkmcnt(8)
    v_mfma_f32_32x32x16_bf16 v[0:15], v[88:91], v[80:83], v[0:15]
    ds_read_b64_tr_b16 v[120:121], v162 offset:47104
    ds_read_b64_tr_b16 v[122:123], v162 offset:47616
    s_add_u32 m0, s24, 98304
    s_nop 0
    buffer_load_dwordx4 v144, s[8:11], s26 offen offset:2048 lds
    s_waitcnt lgkmcnt(9)
    v_mfma_f32_32x32x16_bf16 v[16:31], v[88:91], v[84:87], v[16:31]
    ds_read_b128 v[116:119], v158 offset:31744
    ds_read_b128 v[124:127], v155 offset:96
    v_add_u32 v155, 128, v155
    s_waitcnt lgkmcnt(10)
    v_mfma_f32_16x16x32_bf16 v[32:35], v[92:95], v[80:83], v[32:35]
    v_mfma_f32_16x16x32_bf16 v[48:51], v[92:95], v[84:87], v[48:51]
    buffer_load_dwordx4 v144, s[8:11], s26 offen offset:3072 lds
    s_add_u32 s26, s26, 4096
    s_add_u32 s27, s27, 131072
    s_waitcnt lgkmcnt(7)
    v_mfma_f32_32x32x16_bf16 v[0:15], v[104:107], v[96:99], v[0:15]
    s_waitcnt lgkmcnt(6)
    v_mfma_f32_32x32x16_bf16 v[16:31], v[104:107], v[100:103], v[16:31]
    s_waitcnt vmcnt(24) lgkmcnt(0)
    s_barrier
    ds_read_b128 v[64:67], v156 offset:0
    v_mfma_f32_16x16x32_bf16 v[32:35], v[108:111], v[96:99], v[32:35]
    ds_read_b64_tr_b16 v[72:73], v160 offset:16384
    ds_read_b64_tr_b16 v[74:75], v160 offset:16896
    s_add_u32 m0, s25, 122880
    s_nop 0
    buffer_load_dwordx4 v145, s[12:15], s27 offen lds
    v_mfma_f32_16x16x32_bf16 v[48:51], v[108:111], v[100:103], v[48:51]
    ds_read_b128 v[68:71], v156 offset:4096
    ds_read_b128 v[76:79], v155 offset:0
    v_mfma_f32_32x32x16_bf16 v[0:15], v[120:123], v[112:115], v[0:15]
    ds_read_b128 v[80:83], v156 offset:1024
    s_add_u32 m0, s25, 123904
    s_nop 0
    buffer_load_dwordx4 v146, s[12:15], s27 offen lds
    v_mfma_f32_32x32x16_bf16 v[16:31], v[120:123], v[116:119], v[16:31]
    ds_read_b64_tr_b16 v[88:89], v160 offset:18432
    ds_read_b64_tr_b16 v[90:91], v160 offset:18944
    v_mfma_f32_16x16x32_bf16 v[32:35], v[124:127], v[112:115], v[32:35]
    ds_read_b128 v[84:87], v156 offset:5120
    ds_read_b128 v[92:95], v155 offset:32
    s_add_u32 m0, s24, 122880
    s_nop 0
    buffer_load_dwordx4 v144, s[8:11], s26 offen offset:0 lds
    v_mfma_f32_16x16x32_bf16 v[48:51], v[124:127], v[116:119], v[48:51]
    buffer_load_dwordx4 v144, s[8:11], s26 offen offset:1024 lds
    s_waitcnt lgkmcnt(7)
    v_mfma_f32_32x32x16_bf16 v[0:15], v[72:75], v[64:67], v[0:15]
    ds_read_b128 v[96:99], v156 offset:2048
    s_waitcnt lgkmcnt(7)
    v_mfma_f32_32x32x16_bf16 v[16:31], v[72:75], v[68:71], v[16:31]
    ds_read_b64_tr_b16 v[104:105], v160 offset:20480
    ds_read_b64_tr_b16 v[106:107], v160 offset:20992
    s_waitcnt lgkmcnt(8)
    v_mfma_f32_16x16x32_bf16 v[32:35], v[76:79], v[64:67], v[32:35]
    ds_read_b128 v[100:103], v156 offset:6144
    ds_read_b128 v[108:111], v155 offset:64
    v_mfma_f32_16x16x32_bf16 v[48:51], v[76:79], v[68:71], v[48:51]
    ds_read_b128 v[112:115], v156 offset:3072
    s_waitcnt lgkmcnt(8)
    v_mfma_f32_32x32x16_bf16 v[0:15], v[88:91], v[80:83], v[0:15]
    ds_read_b64_tr_b16 v[120:121], v160 offset:22528
    ds_read_b64_tr_b16 v[122:123], v160 offset:23040
    s_add_u32 m0, s24, 122880
    s_nop 0
    buffer_load_dwordx4 v144, s[8:11], s26 offen offset:2048 lds
    s_waitcnt lgkmcnt(9)
    v_mfma_f32_32x32x16_bf16 v[16:31], v[88:91], v[84:87], v[16:31]
    ds_read_b128 v[116:119], v156 offset:7168
    ds_read_b128 v[124:127], v155 offset:96
    v_add_u32 v155, 128, v155
    s_waitcnt lgkmcnt(10)
    v_mfma_f32_16x16x32_bf16 v[32:35], v[92:95], v[80:83], v[32:35]
    v_mfma_f32_16x16x32_bf16 v[48:51], v[92:95], v[84:87], v[48:51]
    buffer_load_dwordx4 v144, s[8:11], s26 offen offset:3072 lds
    s_add_u32 s26, s26, 4096
    s_add_u32 s27, s27, 131072
    s_waitcnt lgkmcnt(7)
    v_mfma_f32_32x32x16_bf16 v[0:15], v[104:107], v[96:99], v[0:15]
    s_waitcnt lgkmcnt(6)
    v_mfma_f32_32x32x16_bf16 v[16:31], v[104:107], v[100:103], v[16:31]
    s_waitcnt vmcnt(24) lgkmcnt(0)
    s_barrier
    ds_read_b128 v[64:67], v156 offset:24576
    v_mfma_f32_16x16x32_bf16 v[32:35], v[108:111], v[96:99], v[32:35]
    ds_read_b64_tr_b16 v[72:73], v160 offset:40960
    ds_read_b64_tr_b16 v[74:75], v160 offset:41472
    s_add_u32 m0, s25, 0
    s_nop 0
    buffer_load_dwordx4 v145, s[12:15], s27 offen lds
    v_mfma_f32_16x16x32_bf16 v[48:51], v[108:111], v[100:103], v[48:51]
    ds_read_b128 v[68:71], v156 offset:28672
    ds_read_b128 v[76:79], v155 offset:0
    v_mfma_f32_32x32x16_bf16 v[0:15], v[120:123], v[112:115], v[0:15]
    ds_read_b128 v[80:83], v156 offset:25600
    s_add_u32 m0, s25, 1024
    s_nop 0
    buffer_load_dwordx4 v146, s[12:15], s27 offen lds
    v_mfma_f32_32x32x16_bf16 v[16:31], v[120:123], v[116:119], v[16:31]
    ds_read_b64_tr_b16 v[88:89], v160 offset:43008
    ds_read_b64_tr_b16 v[90:91], v160 offset:43520
    v_mfma_f32_16x16x32_bf16 v[32:35], v[124:127], v[112:115], v[32:35]
    ds_read_b128 v[84:87], v156 offset:29696
    ds_read_b128 v[92:95], v155 offset:32
    s_add_u32 m0, s24, 0
    s_nop 0
    buffer_load_dwordx4 v144, s[8:11], s26 offen offset:0 lds
    v_mfma_f32_16x16x32_bf16 v[48:51], v[124:127], v[116:119], v[48:51]
    buffer_load_dwordx4 v144, s[8:11], s26 offen offset:1024 lds
    s_waitcnt lgkmcnt(7)
    v_mfma_f32_32x32x16_bf16 v[0:15], v[72:75], v[64:67], v[0:15]
    ds_read_b128 v[96:99], v156 offset:26624
    s_waitcnt lgkmcnt(7)
    v_mfma_f32_32x32x16_bf16 v[16:31], v[72:75], v[68:71], v[16:31]
    ds_read_b64_tr_b16 v[104:105], v160 offset:45056
    ds_read_b64_tr_b16 v[106:107], v160 offset:45568
    s_waitcnt lgkmcnt(8)
    v_mfma_f32_16x16x32_bf16 v[32:35], v[76:79], v[64:67], v[32:35]
    ds_read_b128 v[100:103], v156 offset:30720
    ds_read_b128 v[108:111], v155 offset:64
    v_mfma_f32_16x16x32_bf16 v[48:51], v[76:79], v[68:71], v[48:51]
    ds_read_b128 v[112:115], v156 offset:27648
    s_waitcnt lgkmcnt(8)
    v_mfma_f32_32x32x16_bf16 v[0:15], v[88:91], v[80:83], v[0:15]
    ds_read_b64_tr_b16 v[120:121], v160 offset:47104
    ds_read_b64_tr_b16 v[122:123], v160 offset:47616
    s_add_u32 m0, s24, 0
    s_nop 0
    buffer_load_dwordx4 v144, s[8:11], s26 offen offset:2048 lds
    s_waitcnt lgkmcnt(9)
    v_mfma_f32_32x32x16_bf16 v[16:31], v[88:91], v[84:87], v[16:31]
    ds_read_b128 v[116:119], v156 offset:31744
    ds_read_b128 v[124:127], v155 offset:96
    v_add_u32 v155, 128, v155
    s_waitcnt lgkmcnt(10)
    v_mfma_f32_16x16x32_bf16 v[32:35], v[92:95], v[80:83], v[32:35]
    v_mfma_f32_16x16x32_bf16 v[48:51], v[92:95], v[84:87], v[48:51]
    buffer_load_dwordx4 v144, s[8:11], s26 offen offset:3072 lds
    s_add_u32 s26, s26, 4096
    s_add_u32 s27, s27, 131072
    s_waitcnt lgkmcnt(7)
    v_mfma_f32_32x32x16_bf16 v[0:15], v[104:107], v[96:99], v[0:15]
    s_waitcnt lgkmcnt(6)
    v_mfma_f32_32x32x16_bf16 v[16:31], v[104:107], v[100:103], v[16:31]
    s_waitcnt vmcnt(24) lgkmcnt(0)
    s_barrier
    ds_read_b128 v[64:67], v157 offset:0
    v_mfma_f32_16x16x32_bf16 v[32:35], v[108:111], v[96:99], v[32:35]
    ds_read_b64_tr_b16 v[72:73], v161 offset:16384
    ds_read_b64_tr_b16 v[74:75], v161 offset:16896
    s_add_u32 m0, s25, 24576
    s_nop 0
    buffer_load_dwordx4 v145, s[12:15], s27 offen lds
    v_mfma_f32_16x16x32_bf16 v[48:51], v[108:111], v[100:103], v[48:51]
    ds_read_b128 v[68:71], v157 offset:4096
    ds_read_b128 v[76:79], v155 offset:0
    v_mfma_f32_32x32x16_bf16 v[0:15], v[120:123], v[112:115], v[0:15]
    ds_read_b128 v[80:83], v157 offset:1024
    s_add_u32 m0, s25, 25600
    s_nop 0
    buffer_load_dwordx4 v146, s[12:15], s27 offen lds
    v_mfma_f32_32x32x16_bf16 v[16:31], v[120:123], v[116:119], v[16:31]
    ds_read_b64_tr_b16 v[88:89], v161 offset:18432
    ds_read_b64_tr_b16 v[90:91], v161 offset:18944
    v_mfma_f32_16x16x32_bf16 v[32:35], v[124:127], v[112:115], v[32:35]
    ds_read_b128 v[84:87], v157 offset:5120
    ds_read_b128 v[92:95], v155 offset:32
    s_add_u32 m0, s24, 24576
    s_nop 0
    buffer_load_dwordx4 v144, s[8:11], s26 offen offset:0 lds
    v_mfma_f32_16x16x32_bf16 v[48:51], v[124:127], v[116:119], v[48:51]
    buffer_load_dwordx4 v144, s[8:11], s26 offen offset:1024 lds
    s_waitcnt lgkmcnt(7)
    v_mfma_f32_32x32x16_bf16 v[0:15], v[72:75], v[64:67], v[0:15]
    ds_read_b128 v[96:99], v157 offset:2048
    s_waitcnt lgkmcnt(7)
    v_mfma_f32_32x32x16_bf16 v[16:31], v[72:75], v[68:71], v[16:31]
    ds_read_b64_tr_b16 v[104:105], v161 offset:20480
    ds_read_b64_tr_b16 v[106:107], v161 offset:20992
    s_waitcnt lgkmcnt(8)
    v_mfma_f32_16x16x32_bf16 v[32:35], v[76:79], v[64:67], v[32:35]
    ds_read_b128 v[100:103], v157 offset:6144
    ds_read_b128 v[108:111], v155 offset:64
    v_mfma_f32_16x16x32_bf16 v[48:51], v[76:79], v[68:71], v[48:51]
    ds_read_b128 v[112:115], v157 offset:3072
    s_waitcnt lgkmcnt(8)
    v_mfma_f32_32x32x16_bf16 v[0:15], v[88:91], v[80:83], v[0:15]
    ds_read_b64_tr_b16 v[120:121], v161 offset:22528
    ds_read_b64_tr_b16 v[122:123], v161 offset:23040
    s_add_u32 m0, s24, 24576
    s_nop 0
    buffer_load_dwordx4 v144, s[8:11], s26 offen offset:2048 lds
    s_waitcnt lgkmcnt(9)
    v_mfma_f32_32x32x16_bf16 v[16:31], v[88:91], v[84:87], v[16:31]
    ds_read_b128 v[116:119], v157 offset:7168
    ds_read_b128 v[124:127], v155 offset:96
    v_add_u32 v155, 128, v155
    s_waitcnt lgkmcnt(10)
    v_mfma_f32_16x16x32_bf16 v[32:35], v[92:95], v[80:83], v[32:35]
    v_mfma_f32_16x16x32_bf16 v[48:51], v[92:95], v[84:87], v[48:51]
    buffer_load_dwordx4 v144, s[8:11], s26 offen offset:3072 lds
    s_add_u32 s26, s26, 4096
    s_add_u32 s27, s27, 131072
    s_waitcnt lgkmcnt(7)
    v_mfma_f32_32x32x16_bf16 v[0:15], v[104:107], v[96:99], v[0:15]
    s_waitcnt lgkmcnt(6)
    v_mfma_f32_32x32x16_bf16 v[16:31], v[104:107], v[100:103], v[16:31]
    s_waitcnt vmcnt(24) lgkmcnt(0)
    s_barrier
    ds_read_b128 v[64:67], v157 offset:24576
    v_mfma_f32_16x16x32_bf16 v[32:35], v[108:111], v[96:99], v[32:35]
    ds_read_b64_tr_b16 v[72:73], v161 offset:40960
    ds_read_b64_tr_b16 v[74:75], v161 offset:41472
    s_add_u32 m0, s25, 49152
    s_nop 0
    buffer_load_dwordx4 v145, s[12:15], s27 offen lds
    v_mfma_f32_16x16x32_bf16 v[48:51], v[108:111], v[100:103], v[48:51]
    ds_read_b128 v[68:71], v157 offset:28672
    ds_read_b128 v[76:79], v155 offset:0
    v_mfma_f32_32x32x16_bf16 v[0:15], v[120:123], v[112:115], v[0:15]
    ds_read_b128 v[80:83], v157 offset:25600
    s_add_u32 m0, s25, 50176
    s_nop 0
    buffer_load_dwordx4 v146, s[12:15], s27 offen lds
    v_mfma_f32_32x32x16_bf16 v[16:31], v[120:123], v[116:119], v[16:31]
    ds_read_b64_tr_b16 v[88:89], v161 offset:43008
    ds_read_b64_tr_b16 v[90:91], v161 offset:43520
    v_mfma_f32_16x16x32_bf16 v[32:35], v[124:127], v[112:115], v[32:35]
    ds_read_b128 v[84:87], v157 offset:29696
    ds_read_b128 v[92:95], v155 offset:32
    s_add_u32 m0, s24, 49152
    s_nop 0
    buffer_load_dwordx4 v144, s[8:11], s26 offen offset:0 lds
    v_mfma_f32_16x16x32_bf16 v[48:51], v[124:127], v[116:119], v[48:51]
    buffer_load_dwordx4 v144, s[8:11], s26 offen offset:1024 lds
    s_waitcnt lgkmcnt(7)
    v_mfma_f32_32x32x16_bf16 v[0:15], v[72:75], v[64:67], v[0:15]
    ds_read_b128 v[96:99], v157 offset:26624
    s_waitcnt lgkmcnt(7)
    v_mfma_f32_32x32x16_bf16 v[16:31], v[72:75], v[68:71], v[16:31]
    ds_read_b64_tr_b16 v[104:105], v161 offset:45056
    ds_read_b64_tr_b16 v[106:107], v161 offset:45568
    s_waitcnt lgkmcnt(8)
    v_mfma_f32_16x16x32_bf16 v[32:35], v[76:79], v[64:67], v[32:35]
    ds_read_b128 v[100:103], v157 offset:30720
    ds_read_b128 v[108:111], v155 offset:64
    v_mfma_f32_16x16x32_bf16 v[48:51], v[76:79], v[68:71], v[48:51]
    ds_read_b128 v[112:115], v157 offset:27648
    s_waitcnt lgkmcnt(8)
    v_mfma_f32_32x32x16_bf16 v[0:15], v[88:91], v[80:83], v[0:15]
    ds_read_b64_tr_b16 v[120:121], v161 offset:47104
    ds_read_b64_tr_b16 v[122:123], v161 offset:47616
    s_add_u32 m0, s24, 49152
    s_nop 0
    buffer_load_dwordx4 v144, s[8:11], s26 offen offset:2048 lds
    s_waitcnt lgkmcnt(9)
    v_mfma_f32_32x32x16_bf16 v[16:31], v[88:91], v[84:87], v[16:31]
    ds_read_b128 v[116:119], v157 offset:31744
    ds_read_b128 v[124:127], v155 offset:96
    v_add_u32 v155, 128, v155
    s_waitcnt lgkmcnt(10)
    v_mfma_f32_16x16x32_bf16 v[32:35], v[92:95], v[80:83], v[32:35]
    v_mfma_f32_16x16x32_bf16 v[48:51], v[92:95], v[84:87], v[48:51]
    buffer_load_dwordx4 v144, s[8:11], s26 offen offset:3072 lds
    s_add_u32 s26, s26, 4096
    s_add_u32 s27, s27, 131072
    s_waitcnt lgkmcnt(7)
    v_mfma_f32_32x32x16_bf16 v[0:15], v[104:107], v[96:99], v[0:15]
    s_waitcnt lgkmcnt(6)
    v_mfma_f32_32x32x16_bf16 v[16:31], v[104:107], v[100:103], v[16:31]
    s_waitcnt vmcnt(24) lgkmcnt(0)
    s_barrier
    ds_read_b128 v[64:67], v158 offset:0
    v_mfma_f32_16x16x32_bf16 v[32:35], v[108:111], v[96:99], v[32:35]
    ds_read_b64_tr_b16 v[72:73], v162 offset:16384
    ds_read_b64_tr_b16 v[74:75], v162 offset:16896
    s_add_u32 m0, s25, 73728
    s_nop 0
    buffer_load_dwordx4 v145, s[12:15], s27 offen lds
    v_mfma_f32_16x16x32_bf16 v[48:51], v[108:111], v[100:103], v[48:51]
    ds_read_b128 v[68:71], v158 offset:4096
    ds_read_b128 v[76:79], v155 offset:0
    v_mfma_f32_32x32x16_bf16 v[0:15], v[120:123], v[112:115], v[0:15]
    ds_read_b128 v[80:83], v158 offset:1024
    s_add_u32 m0, s25, 74752
    s_nop 0
    buffer_load_dwordx4 v146, s[12:15], s27 offen lds
    v_mfma_f32_32x32x16_bf16 v[16:31], v[120:123], v[116:119], v[16:31]
    ds_read_b64_tr_b16 v[88:89], v162 offset:18432
    ds_read_b64_tr_b16 v[90:91], v162 offset:18944
    v_mfma_f32_16x16x32_bf16 v[32:35], v[124:127], v[112:115], v[32:35]
    ds_read_b128 v[84:87], v158 offset:5120
    ds_read_b128 v[92:95], v155 offset:32
    s_add_u32 m0, s24, 73728
    s_nop 0
    buffer_load_dwordx4 v144, s[8:11], s26 offen offset:0 lds
    v_mfma_f32_16x16x32_bf16 v[48:51], v[124:127], v[116:119], v[48:51]
    buffer_load_dwordx4 v144, s[8:11], s26 offen offset:1024 lds
    s_waitcnt lgkmcnt(7)
    v_mfma_f32_32x32x16_bf16 v[0:15], v[72:75], v[64:67], v[0:15]
    ds_read_b128 v[96:99], v158 offset:2048
    s_waitcnt lgkmcnt(7)
    v_mfma_f32_32x32x16_bf16 v[16:31], v[72:75], v[68:71], v[16:31]
    ds_read_b64_tr_b16 v[104:105], v162 offset:20480
    ds_read_b64_tr_b16 v[106:107], v162 offset:20992
    s_waitcnt lgkmcnt(8)
    v_mfma_f32_16x16x32_bf16 v[32:35], v[76:79], v[64:67], v[32:35]
    ds_read_b128 v[100:103], v158 offset:6144
    ds_read_b128 v[108:111], v155 offset:64
    v_mfma_f32_16x16x32_bf16 v[48:51], v[76:79], v[68:71], v[48:51]
    ds_read_b128 v[112:115], v158 offset:3072
    s_waitcnt lgkmcnt(8)
    v_mfma_f32_32x32x16_bf16 v[0:15], v[88:91], v[80:83], v[0:15]
    ds_read_b64_tr_b16 v[120:121], v162 offset:22528
    ds_read_b64_tr_b16 v[122:123], v162 offset:23040
    s_add_u32 m0, s24, 73728
    s_nop 0
    buffer_load_dwordx4 v144, s[8:11], s26 offen offset:2048 lds
    s_waitcnt lgkmcnt(9)
    v_mfma_f32_32x32x16_bf16 v[16:31], v[88:91], v[84:87], v[16:31]
    ds_read_b128 v[116:119], v158 offset:7168
    ds_read_b128 v[124:127], v155 offset:96
    v_add_u32 v155, 128, v155
    s_waitcnt lgkmcnt(10)
    v_mfma_f32_16x16x32_bf16 v[32:35], v[92:95], v[80:83], v[32:35]
    v_mfma_f32_16x16x32_bf16 v[48:51], v[92:95], v[84:87], v[48:51]
    buffer_load_dwordx4 v144, s[8:11], s26 offen offset:3072 lds
    s_add_u32 s26, s26, 4096
    s_add_u32 s27, s27, 131072
    s_waitcnt lgkmcnt(7)
    v_mfma_f32_32x32x16_bf16 v[0:15], v[104:107], v[96:99], v[0:15]
    s_waitcnt lgkmcnt(6)
    v_mfma_f32_32x32x16_bf16 v[16:31], v[104:107], v[100:103], v[16:31]
    s_waitcnt vmcnt(24) lgkmcnt(0)
    s_barrier
    ds_read_b128 v[64:67], v158 offset:24576
    v_mfma_f32_16x16x32_bf16 v[32:35], v[108:111], v[96:99], v[32:35]
    ds_read_b64_tr_b16 v[72:73], v162 offset:40960
    ds_read_b64_tr_b16 v[74:75], v162 offset:41472
    v_mfma_f32_16x16x32_bf16 v[48:51], v[108:111], v[100:103], v[48:51]
    ds_read_b128 v[68:71], v158 offset:28672
    ds_read_b128 v[76:79], v155 offset:0
    v_mfma_f32_32x32x16_bf16 v[0:15], v[120:123], v[112:115], v[0:15]
    ds_read_b128 v[80:83], v158 offset:25600
    v_mfma_f32_32x32x16_bf16 v[16:31], v[120:123], v[116:119], v[16:31]
    ds_read_b64_tr_b16 v[88:89], v162 offset:43008
    ds_read_b64_tr_b16 v[90:91], v162 offset:43520
    v_mfma_f32_16x16x32_bf16 v[32:35], v[124:127], v[112:115], v[32:35]
    ds_read_b128 v[84:87], v158 offset:29696
    ds_read_b128 v[92:95], v155 offset:32
    v_mfma_f32_16x16x32_bf16 v[48:51], v[124:127], v[116:119], v[48:51]
    s_waitcnt lgkmcnt(7)
    v_mfma_f32_32x32x16_bf16 v[0:15], v[72:75], v[64:67], v[0:15]
    ds_read_b128 v[96:99], v158 offset:26624
    s_waitcnt lgkmcnt(7)
    v_mfma_f32_32x32x16_bf16 v[16:31], v[72:75], v[68:71], v[16:31]
    ds_read_b64_tr_b16 v[104:105], v162 offset:45056
    ds_read_b64_tr_b16 v[106:107], v162 offset:45568
    s_waitcnt lgkmcnt(8)
    v_mfma_f32_16x16x32_bf16 v[32:35], v[76:79], v[64:67], v[32:35]
    ds_read_b128 v[100:103], v158 offset:30720
    ds_read_b128 v[108:111], v155 offset:64
    buffer_load_dwordx4 v[128:131], v148, s[44:47], 0 offen offset:0
    v_mfma_f32_16x16x32_bf16 v[48:51], v[76:79], v[68:71], v[48:51]
    ds_read_b128 v[112:115], v158 offset:27648
    buffer_load_dwordx4 v[132:135], v148, s[44:47], 0 offen offset:32
    s_waitcnt lgkmcnt(8)
    v_mfma_f32_32x32x16_bf16 v[0:15], v[88:91], v[80:83], v[0:15]
    ds_read_b64_tr_b16 v[120:121], v162 offset:47104
    ds_read_b64_tr_b16 v[122:123], v162 offset:47616
    buffer_load_dwordx4 v[136:139], v149, s[44:47], 0 offen offset:0
    s_waitcnt lgkmcnt(9)
    v_mfma_f32_32x32x16_bf16 v[16:31], v[88:91], v[84:87], v[16:31]
    ds_read_b128 v[116:119], v158 offset:31744
    ds_read_b128 v[124:127], v155 offset:96
    v_add_u32 v155, 128, v155
    buffer_load_dwordx4 v[140:143], v149, s[44:47], 0 offen offset:32
    s_waitcnt lgkmcnt(10)
    v_mfma_f32_16x16x32_bf16 v[32:35], v[92:95], v[80:83], v[32:35]
    buffer_load_dword v152, v154, s[48:51], s31 offen offset:0
    v_mfma_f32_16x16x32_bf16 v[48:51], v[92:95], v[84:87], v[48:51]
    buffer_load_dword v153, v154, s[48:51], s31 offen offset:128
    s_waitcnt lgkmcnt(7)
    v_mfma_f32_32x32x16_bf16 v[0:15], v[104:107], v[96:99], v[0:15]
    s_waitcnt lgkmcnt(6)
    v_mfma_f32_32x32x16_bf16 v[16:31], v[104:107], v[100:103], v[16:31]
    s_waitcnt vmcnt(24) lgkmcnt(0)
    s_barrier
    ds_read_b128 v[64:67], v156 offset:0
    v_mfma_f32_16x16x32_bf16 v[32:35], v[108:111], v[96:99], v[32:35]
    ds_read_b64_tr_b16 v[72:73], v160 offset:16384
    ds_read_b64_tr_b16 v[74:75], v160 offset:16896
    v_mfma_f32_16x16x32_bf16 v[48:51], v[108:111], v[100:103], v[48:51]
    ds_read_b128 v[68:71], v156 offset:4096
    ds_read_b128 v[76:79], v155 offset:0
    v_mfma_f32_32x32x16_bf16 v[0:15], v[120:123], v[112:115], v[0:15]
    ds_read_b128 v[80:83], v156 offset:1024
    v_mfma_f32_32x32x16_bf16 v[16:31], v[120:123], v[116:119], v[16:31]
    ds_read_b64_tr_b16 v[88:89], v160 offset:18432
    ds_read_b64_tr_b16 v[90:91], v160 offset:18944
    v_mfma_f32_16x16x32_bf16 v[32:35], v[124:127], v[112:115], v[32:35]
    ds_read_b128 v[84:87], v156 offset:5120
    ds_read_b128 v[92:95], v155 offset:32
    v_mfma_f32_16x16x32_bf16 v[48:51], v[124:127], v[116:119], v[48:51]
    s_waitcnt lgkmcnt(7)
    v_mfma_f32_32x32x16_bf16 v[0:15], v[72:75], v[64:67], v[0:15]
    ds_read_b128 v[96:99], v156 offset:2048
    s_waitcnt lgkmcnt(7)
    v_mfma_f32_32x32x16_bf16 v[16:31], v[72:75], v[68:71], v[16:31]
    ds_read_b64_tr_b16 v[104:105], v160 offset:20480
    ds_read_b64_tr_b16 v[106:107], v160 offset:20992
    s_waitcnt lgkmcnt(8)
    v_mfma_f32_16x16x32_bf16 v[32:35], v[76:79], v[64:67], v[32:35]
    ds_read_b128 v[100:103], v156 offset:6144
    ds_read_b128 v[108:111], v155 offset:64
    v_mfma_f32_16x16x32_bf16 v[48:51], v[76:79], v[68:71], v[48:51]
    ds_read_b128 v[112:115], v156 offset:3072
    s_waitcnt lgkmcnt(8)
    v_mfma_f32_32x32x16_bf16 v[0:15], v[88:91], v[80:83], v[0:15]
    ds_read_b64_tr_b16 v[120:121], v160 offset:22528
    ds_read_b64_tr_b16 v[122:123], v160 offset:23040
    s_waitcnt lgkmcnt(9)
    v_mfma_f32_32x32x16_bf16 v[16:31], v[88:91], v[84:87], v[16:31]
    ds_read_b128 v[116:119], v156 offset:7168
    ds_read_b128 v[124:127], v155 offset:96
    v_add_u32 v155, 128, v155
    s_waitcnt lgkmcnt(10)
    v_mfma_f32_16x16x32_bf16 v[32:35], v[92:95], v[80:83], v[32:35]
    v_mfma_f32_16x16x32_bf16 v[48:51], v[92:95], v[84:87], v[48:51]
    s_waitcnt lgkmcnt(7)
    v_mfma_f32_32x32x16_bf16 v[0:15], v[104:107], v[96:99], v[0:15]
    s_waitcnt lgkmcnt(6)
    v_mfma_f32_32x32x16_bf16 v[16:31], v[104:107], v[100:103], v[16:31]
    s_waitcnt vmcnt(18) lgkmcnt(0)
    s_barrier
    ds_read_b128 v[64:67], v156 offset:24576
    v_mfma_f32_16x16x32_bf16 v[32:35], v[108:111], v[96:99], v[32:35]
    ds_read_b64_tr_b16 v[72:73], v160 offset:40960
    ds_read_b64_tr_b16 v[74:75], v160 offset:41472
    v_mfma_f32_16x16x32_bf16 v[48:51], v[108:111], v[100:103], v[48:51]
    ds_read_b128 v[68:71], v156 offset:28672
    ds_read_b128 v[76:79], v155 offset:0
    v_mfma_f32_32x32x16_bf16 v[0:15], v[120:123], v[112:115], v[0:15]
    ds_read_b128 v[80:83], v156 offset:25600
    v_mfma_f32_32x32x16_bf16 v[16:31], v[120:123], v[116:119], v[16:31]
    ds_read_b64_tr_b16 v[88:89], v160 offset:43008
    ds_read_b64_tr_b16 v[90:91], v160 offset:43520
    v_mfma_f32_16x16x32_bf16 v[32:35], v[124:127], v[112:115], v[32:35]
    ds_read_b128 v[84:87], v156 offset:29696
    ds_read_b128 v[92:95], v155 offset:32
    v_mfma_f32_16x16x32_bf16 v[48:51], v[124:127], v[116:119], v[48:51]
    s_waitcnt lgkmcnt(7)
    v_mfma_f32_32x32x16_bf16 v[0:15], v[72:75], v[64:67], v[0:15]
    ds_read_b128 v[96:99], v156 offset:26624
    s_waitcnt lgkmcnt(7)
    v_mfma_f32_32x32x16_bf16 v[16:31], v[72:75], v[68:71], v[16:31]
    ds_read_b64_tr_b16 v[104:105], v160 offset:45056
    ds_read_b64_tr_b16 v[106:107], v160 offset:45568
    s_waitcnt lgkmcnt(8)
    v_mfma_f32_16x16x32_bf16 v[32:35], v[76:79], v[64:67], v[32:35]
    ds_read_b128 v[100:103], v156 offset:30720
    ds_read_b128 v[108:111], v155 offset:64
    v_mfma_f32_16x16x32_bf16 v[48:51], v[76:79], v[68:71], v[48:51]
    ds_read_b128 v[112:115], v156 offset:27648
    s_waitcnt lgkmcnt(8)
    v_mfma_f32_32x32x16_bf16 v[0:15], v[88:91], v[80:83], v[0:15]
    ds_read_b64_tr_b16 v[120:121], v160 offset:47104
    ds_read_b64_tr_b16 v[122:123], v160 offset:47616
    s_waitcnt lgkmcnt(9)
    v_mfma_f32_32x32x16_bf16 v[16:31], v[88:91], v[84:87], v[16:31]
    ds_read_b128 v[116:119], v156 offset:31744
    ds_read_b128 v[124:127], v155 offset:96
    v_add_u32 v155, 128, v155
    s_waitcnt lgkmcnt(10)
    v_mfma_f32_16x16x32_bf16 v[32:35], v[92:95], v[80:83], v[32:35]
    v_mfma_f32_16x16x32_bf16 v[48:51], v[92:95], v[84:87], v[48:51]
    s_waitcnt lgkmcnt(7)
    v_mfma_f32_32x32x16_bf16 v[0:15], v[104:107], v[96:99], v[0:15]
    s_waitcnt lgkmcnt(6)
    v_mfma_f32_32x32x16_bf16 v[16:31], v[104:107], v[100:103], v[16:31]
    s_waitcnt vmcnt(12) lgkmcnt(0)
    s_barrier
    ds_read_b128 v[64:67], v157 offset:0
    v_mfma_f32_16x16x32_bf16 v[32:35], v[108:111], v[96:99], v[32:35]
    ds_read_b64_tr_b16 v[72:73], v161 offset:16384
    ds_read_b64_tr_b16 v[74:75], v161 offset:16896
    v_mfma_f32_16x16x32_bf16 v[48:51], v[108:111], v[100:103], v[48:51]
    ds_read_b128 v[68:71], v157 offset:4096
    ds_read_b128 v[76:79], v155 offset:0
    v_mfma_f32_32x32x16_bf16 v[0:15], v[120:123], v[112:115], v[0:15]
    ds_read_b128 v[80:83], v157 offset:1024
    v_mfma_f32_32x32x16_bf16 v[16:31], v[120:123], v[116:119], v[16:31]
    ds_read_b64_tr_b16 v[88:89], v161 offset:18432
    ds_read_b64_tr_b16 v[90:91], v161 offset:18944
    v_mfma_f32_16x16x32_bf16 v[32:35], v[124:127], v[112:115], v[32:35]
    ds_read_b128 v[84:87], v157 offset:5120
    ds_read_b128 v[92:95], v155 offset:32
    v_mfma_f32_16x16x32_bf16 v[48:51], v[124:127], v[116:119], v[48:51]
    s_waitcnt lgkmcnt(7)
    v_mfma_f32_32x32x16_bf16 v[0:15], v[72:75], v[64:67], v[0:15]
    ds_read_b128 v[96:99], v157 offset:2048
    s_waitcnt lgkmcnt(7)
    v_mfma_f32_32x32x16_bf16 v[16:31], v[72:75], v[68:71], v[16:31]
    ds_read_b64_tr_b16 v[104:105], v161 offset:20480
    ds_read_b64_tr_b16 v[106:107], v161 offset:20992
    s_waitcnt lgkmcnt(8)
    v_mfma_f32_16x16x32_bf16 v[32:35], v[76:79], v[64:67], v[32:35]
    ds_read_b128 v[100:103], v157 offset:6144
    ds_read_b128 v[108:111], v155 offset:64
    v_mfma_f32_16x16x32_bf16 v[48:51], v[76:79], v[68:71], v[48:51]
    ds_read_b128 v[112:115], v157 offset:3072
    s_waitcnt lgkmcnt(8)
    v_mfma_f32_32x32x16_bf16 v[0:15], v[88:91], v[80:83], v[0:15]
    ds_read_b64_tr_b16 v[120:121], v161 offset:22528
    ds_read_b64_tr_b16 v[122:123], v161 offset:23040
    s_waitcnt lgkmcnt(9)
    v_mfma_f32_32x32x16_bf16 v[16:31], v[88:91], v[84:87], v[16:31]
    ds_read_b128 v[116:119], v157 offset:7168
    ds_read_b128 v[124:127], v155 offset:96
    v_add_u32 v155, 128, v155
    s_waitcnt lgkmcnt(10)
    v_mfma_f32_16x16x32_bf16 v[32:35], v[92:95], v[80:83], v[32:35]
    v_mfma_f32_16x16x32_bf16 v[48:51], v[92:95], v[84:87], v[48:51]
    s_waitcnt lgkmcnt(7)
    v_mfma_f32_32x32x16_bf16 v[0:15], v[104:107], v[96:99], v[0:15]
    s_waitcnt lgkmcnt(6)
    v_mfma_f32_32x32x16_bf16 v[16:31], v[104:107], v[100:103], v[16:31]
    s_waitcnt vmcnt(6) lgkmcnt(0)
    s_barrier
    ds_read_b128 v[64:67], v157 offset:24576
    v_mfma_f32_16x16x32_bf16 v[32:35], v[108:111], v[96:99], v[32:35]
    ds_read_b64_tr_b16 v[72:73], v161 offset:40960
    ds_read_b64_tr_b16 v[74:75], v161 offset:41472
    v_mfma_f32_16x16x32_bf16 v[48:51], v[108:111], v[100:103], v[48:51]
    ds_read_b128 v[68:71], v157 offset:28672
    ds_read_b128 v[76:79], v155 offset:0
    v_mfma_f32_32x32x16_bf16 v[0:15], v[120:123], v[112:115], v[0:15]
    ds_read_b128 v[80:83], v157 offset:25600
    v_mfma_f32_32x32x16_bf16 v[16:31], v[120:123], v[116:119], v[16:31]
    ds_read_b64_tr_b16 v[88:89], v161 offset:43008
    ds_read_b64_tr_b16 v[90:91], v161 offset:43520
    v_mfma_f32_16x16x32_bf16 v[32:35], v[124:127], v[112:115], v[32:35]
    ds_read_b128 v[84:87], v157 offset:29696
    ds_read_b128 v[92:95], v155 offset:32
    v_mfma_f32_16x16x32_bf16 v[48:51], v[124:127], v[116:119], v[48:51]
    s_waitcnt lgkmcnt(7)
    v_mfma_f32_32x32x16_bf16 v[0:15], v[72:75], v[64:67], v[0:15]
    ds_read_b128 v[96:99], v157 offset:26624
    s_waitcnt lgkmcnt(7)
    v_mfma_f32_32x32x16_bf16 v[16:31], v[72:75], v[68:71], v[16:31]
    ds_read_b64_tr_b16 v[104:105], v161 offset:45056
    ds_read_b64_tr_b16 v[106:107], v161 offset:45568
    s_waitcnt lgkmcnt(8)
    v_mfma_f32_16x16x32_bf16 v[32:35], v[76:79], v[64:67], v[32:35]
    ds_read_b128 v[100:103], v157 offset:30720
    ds_read_b128 v[108:111], v155 offset:64
    v_mfma_f32_16x16x32_bf16 v[48:51], v[76:79], v[68:71], v[48:51]
    ds_read_b128 v[112:115], v157 offset:27648
    s_waitcnt lgkmcnt(8)
    v_mfma_f32_32x32x16_bf16 v[0:15], v[88:91], v[80:83], v[0:15]
    ds_read_b64_tr_b16 v[120:121], v161 offset:47104
    ds_read_b64_tr_b16 v[122:123], v161 offset:47616
    s_waitcnt lgkmcnt(9)
    v_mfma_f32_32x32x16_bf16 v[16:31], v[88:91], v[84:87], v[16:31]
    ds_read_b128 v[116:119], v157 offset:31744
    ds_read_b128 v[124:127], v155 offset:96
    v_add_u32 v155, 128, v155
    s_waitcnt lgkmcnt(10)
    v_mfma_f32_16x16x32_bf16 v[32:35], v[92:95], v[80:83], v[32:35]
    v_mfma_f32_16x16x32_bf16 v[48:51], v[92:95], v[84:87], v[48:51]
    s_waitcnt lgkmcnt(7)
    v_mfma_f32_32x32x16_bf16 v[0:15], v[104:107], v[96:99], v[0:15]
    s_waitcnt lgkmcnt(6)
    v_mfma_f32_32x32x16_bf16 v[16:31], v[104:107], v[100:103], v[16:31]
    s_waitcnt lgkmcnt(5)
    v_mfma_f32_16x16x32_bf16 v[32:35], v[108:111], v[96:99], v[32:35]
    v_mfma_f32_16x16x32_bf16 v[48:51], v[108:111], v[100:103], v[48:51]
    s_waitcnt lgkmcnt(2)
    v_mfma_f32_32x32x16_bf16 v[0:15], v[120:123], v[112:115], v[0:15]
    s_waitcnt lgkmcnt(1)
    v_mfma_f32_32x32x16_bf16 v[16:31], v[120:123], v[116:119], v[16:31]
    s_waitcnt lgkmcnt(0)
    v_mfma_f32_16x16x32_bf16 v[32:35], v[124:127], v[112:115], v[32:35]
    v_mfma_f32_16x16x32_bf16 v[48:51], v[124:127], v[116:119], v[48:51]
    s_waitcnt vmcnt(0) lgkmcnt(0)
    s_nop 14
    v_lshlrev_b32 v172, 16, v128
    v_and_b32 v173, 0xffff0000, v128
    v_pk_add_f32 v[0:1], v[0:1], v[172:173]
    v_lshlrev_b32 v172, 16, v129
    v_and_b32 v173, 0xffff0000, v129
    v_pk_add_f32 v[2:3], v[2:3], v[172:173]
    v_lshlrev_b32 v172, 16, v130
    v_and_b32 v173, 0xffff0000, v130
    v_pk_add_f32 v[4:5], v[4:5], v[172:173]
    v_lshlrev_b32 v172, 16, v131
    v_and_b32 v173, 0xffff0000, v131
    v_pk_add_f32 v[6:7], v[6:7], v[172:173]
    v_lshlrev_b32 v172, 16, v132
    v_and_b32 v173, 0xffff0000, v132
    v_pk_add_f32 v[8:9], v[8:9], v[172:173]
    v_lshlrev_b32 v172, 16, v133
    v_and_b32 v173, 0xffff0000, v133
    v_pk_add_f32 v[10:11], v[10:11], v[172:173]
    v_lshlrev_b32 v172, 16, v134
    v_and_b32 v173, 0xffff0000, v134
    v_pk_add_f32 v[12:13], v[12:13], v[172:173]
    v_lshlrev_b32 v172, 16, v135
    v_and_b32 v173, 0xffff0000, v135
    v_pk_add_f32 v[14:15], v[14:15], v[172:173]
    v_lshlrev_b32 v172, 16, v136
    v_and_b32 v173, 0xffff0000, v136
    v_pk_add_f32 v[16:17], v[16:17], v[172:173]
    v_lshlrev_b32 v172, 16, v137
    v_and_b32 v173, 0xffff0000, v137
    v_pk_add_f32 v[18:19], v[18:19], v[172:173]
    v_lshlrev_b32 v172, 16, v138
    v_and_b32 v173, 0xffff0000, v138
    v_pk_add_f32 v[20:21], v[20:21], v[172:173]
    v_lshlrev_b32 v172, 16, v139
    v_and_b32 v173, 0xffff0000, v139
    v_pk_add_f32 v[22:23], v[22:23], v[172:173]
    v_lshlrev_b32 v172, 16, v140
    v_and_b32 v173, 0xffff0000, v140
    v_pk_add_f32 v[24:25], v[24:25], v[172:173]
    v_lshlrev_b32 v172, 16, v141
    v_and_b32 v173, 0xffff0000, v141
    v_pk_add_f32 v[26:27], v[26:27], v[172:173]
    v_lshlrev_b32 v172, 16, v142
    v_and_b32 v173, 0xffff0000, v142
    v_pk_add_f32 v[28:29], v[28:29], v[172:173]
    v_lshlrev_b32 v172, 16, v143
    v_and_b32 v173, 0xffff0000, v143
    v_pk_add_f32 v[30:31], v[30:31], v[172:173]
    v_add_f32 v32, v32, v152
    v_add_f32 v48, v48, v153
    s_add_u32 s31, s31, 8192
    s_cmp_lg_u32 s23, 0
    s_cbranch_scc1 nomu_mlp_kernel_2
    buffer_store_dword v32, v154, s[48:51], s31 offen offset:0 sc1
    buffer_store_dword v48, v154, s[48:51], s31 offen offset:128 sc1
nomu_mlp_kernel_2:
    v_pk_add_f32 v[0:1], v[0:1], v[32:33] op_sel_hi:[1,0] neg_lo:[0,1] neg_hi:[0,1]
    v_pk_add_f32 v[2:3], v[2:3], v[32:33] op_sel_hi:[1,0] neg_lo:[0,1] neg_hi:[0,1]
    v_pk_add_f32 v[4:5], v[4:5], v[32:33] op_sel_hi:[1,0] neg_lo:[0,1] neg_hi:[0,1]
    v_pk_add_f32 v[6:7], v[6:7], v[32:33] op_sel_hi:[1,0] neg_lo:[0,1] neg_hi:[0,1]
    v_pk_add_f32 v[8:9], v[8:9], v[32:33] op_sel_hi:[1,0] neg_lo:[0,1] neg_hi:[0,1]
    v_pk_add_f32 v[10:11], v[10:11], v[32:33] op_sel_hi:[1,0] neg_lo:[0,1] neg_hi:[0,1]
    v_pk_add_f32 v[12:13], v[12:13], v[32:33] op_sel_hi:[1,0] neg_lo:[0,1] neg_hi:[0,1]
    v_pk_add_f32 v[14:15], v[14:15], v[32:33] op_sel_hi:[1,0] neg_lo:[0,1] neg_hi:[0,1]
    v_cvt_pk_bf16_f32 v64, v0, v1
    v_cvt_pk_bf16_f32 v65, v2, v3
    v_cvt_pk_bf16_f32 v66, v4, v5
    v_cvt_pk_bf16_f32 v67, v6, v7
    v_cvt_pk_bf16_f32 v68, v8, v9
    v_cvt_pk_bf16_f32 v69, v10, v11
    v_cvt_pk_bf16_f32 v70, v12, v13
    v_cvt_pk_bf16_f32 v71, v14, v15
    buffer_store_dwordx4 v[64:67], v150, s[40:43], 0 offen offset:0 sc1
    buffer_store_dwordx4 v[68:71], v150, s[40:43], 0 offen offset:1024 sc1
    v_pk_add_f32 v[16:17], v[16:17], v[48:49] op_sel_hi:[1,0] neg_lo:[0,1] neg_hi:[0,1]
    v_pk_add_f32 v[18:19], v[18:19], v[48:49] op_sel_hi:[1,0] neg_lo:[0,1] neg_hi:[0,1]
    v_pk_add_f32 v[20:21], v[20:21], v[48:49] op_sel_hi:[1,0] neg_lo:[0,1] neg_hi:[0,1]
    v_pk_add_f32 v[22:23], v[22:23], v[48:49] op_sel_hi:[1,0] neg_lo:[0,1] neg_hi:[0,1]
    v_pk_add_f32 v[24:25], v[24:25], v[48:49] op_sel_hi:[1,0] neg_lo:[0,1] neg_hi:[0,1]
    v_pk_add_f32 v[26:27], v[26:27], v[48:49] op_sel_hi:[1,0] neg_lo:[0,1] neg_hi:[0,1]
    v_pk_add_f32 v[28:29], v[28:29], v[48:49] op_sel_hi:[1,0] neg_lo:[0,1] neg_hi:[0,1]
    v_pk_add_f32 v[30:31], v[30:31], v[48:49] op_sel_hi:[1,0] neg_lo:[0,1] neg_hi:[0,1]
    v_cvt_pk_bf16_f32 v72, v16, v17
    v_cvt_pk_bf16_f32 v73, v18, v19
    v_cvt_pk_bf16_f32 v74, v20, v21
    v_cvt_pk_bf16_f32 v75, v22, v23
    v_cvt_pk_bf16_f32 v76, v24, v25
    v_cvt_pk_bf16_f32 v77, v26, v27
    v_cvt_pk_bf16_f32 v78, v28, v29
    v_cvt_pk_bf16_f32 v79, v30, v31
    buffer_store_dwordx4 v[72:75], v151, s[40:43], 0 offen offset:0 sc1
    buffer_store_dwordx4 v[76:79], v151, s[40:43], 0 offen offset:1024 sc1
    v_pk_mul_f32 v[32:33], v[0:1], v[0:1]
    v_pk_mul_f32 v[34:35], v[16:17], v[16:17]
    v_pk_fma_f32 v[32:33], v[2:3], v[2:3], v[32:33]
    v_pk_fma_f32 v[34:35], v[18:19], v[18:19], v[34:35]
    v_pk_fma_f32 v[32:33], v[4:5], v[4:5], v[32:33]
    v_pk_fma_f32 v[34:35], v[20:21], v[20:21], v[34:35]
    v_pk_fma_f32 v[32:33], v[6:7], v[6:7], v[32:33]
    v_pk_fma_f32 v[34:35], v[22:23], v[22:23], v[34:35]
    v_pk_fma_f32 v[32:33], v[8:9], v[8:9], v[32:33]
    v_pk_fma_f32 v[34:35], v[24:25], v[24:25], v[34:35]
    v_pk_fma_f32 v[32:33], v[10:11], v[10:11], v[32:33]
    v_pk_fma_f32 v[34:35], v[26:27], v[26:27], v[34:35]
    v_pk_fma_f32 v[32:33], v[12:13], v[12:13], v[32:33]
    v_pk_fma_f32 v[34:35], v[28:29], v[28:29], v[34:35]
    v_pk_fma_f32 v[32:33], v[14:15], v[14:15], v[32:33]
    v_pk_fma_f32 v[34:35], v[30:31], v[30:31], v[34:35]
    v_add_f32 v32, v32, v33
    v_add_f32 v33, v34, v35
    v_mov_b32 v34, v32
    s_nop 1
    v_permlane32_swap_b32 v34, v32
    s_nop 1
    v_add_f32 v32, v32, v34
    v_mov_b32 v34, v33
    s_nop 1
    v_permlane32_swap_b32 v34, v33
    s_nop 1
    v_add_f32 v33, v33, v34
    v_lshlrev_b32 v154, 2, v154
    s_lshr_b32 s22, s23, 2
    s_lshl_b32 s22, s22, 9
    s_and_b32 s23, s23, 3
    s_lshl_b32 s23, s23, 2
    s_add_u32 s23, s23, s22
    s_lshl_b32 s22, s30, 12
    s_add_u32 s22, s22, s23
    s_add_u32 s22, s22, 65536
    s_add_u32 s23, s22, 4096
    s_mov_b32 exec_hi, 0
    buffer_store_dword v32, v154, s[48:51], s22 offen sc1
    buffer_store_dword v33, v154, s[48:51], s23 offen sc1
    s_mov_b32 exec_hi, -1
    s_lshl_b32 s51, s17, 12
    s_lshl_b32 s22, s18, 2
    s_add_u32 s51, s51, s22
    s_add_u32 s51, s51, 65536
    s_and_b32 s17, s2, 1
    s_lshl_b32 s17, s17, 2
    s_bfe_u32 s18, s2, 0x20003
    s_add_u32 s17, s17, s18
    s_bfe_u32 s18, s2, 0x20001
    s_lshl_b32 s18, s18, 3
    s_lshr_b32 s19, s2, 5
    s_add_u32 s18, s18, s19
    s_cmp_lt_u32 s16, 2
    s_cbranch_scc1 w_mlp_kernel_3
    s_sub_u32 s22, s16, 2
    s_lshl_b32 s24, s22, 13
    s_lshl_b32 s22, s22, 2
    s_lshl_b32 s23, s17, 3
    s_add_u32 s22, s22, s23
    s_lshl_b32 s22, s22, 16
    v_lshlrev_b32 v240, 4, v224
    v_add_u32 v240, s22, v240
    v_add_u32 v225, 0, v240
    v_add_u32 v226, 1024, v240
    v_add_u32 v227, 65536, v240
    v_add_u32 v228, 66560, v240
    v_add_u32 v229, 131072, v240
    v_add_u32 v230, 132096, v240
    v_add_u32 v231, 196608, v240
    v_add_u32 v232, 197632, v240
    s_mov_b32 s27, 2048
    s_add_u32 s25, s24, 7168
    s_mov_b32 s30, 30976
    s_waitcnt lgkmcnt(0)
    s_add_u32 s8, s4, 25165824
    s_addc_u32 s9, s5, 0
    s_and_b32 s9, s9, 0xffff
    s_mov_b32 s10, 4194304
    s_mov_b32 s11, 0x00020000
    s_branch e_mlp_kernel_4
w_mlp_kernel_3:
    s_mul_i32 s24, s16, 7296
    s_add_u32 s24, s24, 16384
    s_mul_i32 s22, s18, 224
    v_add_u32 v240, 0, v224
    v_mul_u32_u24 v241, 4682, v240
    v_lshrrev_b32 v241, 16, v241
    v_mul_u32_u24 v241, 6944, v241
    v_lshl_add_u32 v241, v240, 4, v241
    v_add_u32 v225, s22, v241
    v_add_u32 v240, 64, v224
    v_mul_u32_u24 v241, 4682, v240
    v_lshrrev_b32 v241, 16, v241
    v_mul_u32_u24 v241, 6944, v241
    v_lshl_add_u32 v241, v240, 4, v241
    v_add_u32 v226, s22, v241
    v_add_u32 v240, 128, v224
    v_mul_u32_u24 v241, 4682, v240
    v_lshrrev_b32 v241, 16, v241
    v_mul_u32_u24 v241, 6944, v241
    v_lshl_add_u32 v241, v240, 4, v241
    v_add_u32 v227, s22, v241
    v_add_u32 v240, 192, v224
    v_mul_u32_u24 v241, 4682, v240
    v_lshrrev_b32 v241, 16, v241
    v_mul_u32_u24 v241, 6944, v241
    v_lshl_add_u32 v241, v240, 4, v241
    v_add_u32 v228, s22, v241
    v_add_u32 v240, 256, v224
    v_mul_u32_u24 v241, 4682, v240
    v_lshrrev_b32 v241, 16, v241
    v_mul_u32_u24 v241, 6944, v241
    v_lshl_add_u32 v241, v240, 4, v241
    v_add_u32 v229, s22, v241
    v_add_u32 v240, 320, v224
    v_mul_u32_u24 v241, 4682, v240
    v_lshrrev_b32 v241, 16, v241
    v_mul_u32_u24 v241, 6944, v241
    v_lshl_add_u32 v241, v240, 4, v241
    v_add_u32 v230, s22, v241
    v_add_u32 v240, 384, v224
    v_mul_u32_u24 v241, 4682, v240
    v_lshrrev_b32 v241, 16, v241
    v_mul_u32_u24 v241, 6944, v241
    v_lshl_add_u32 v241, v240, 4, v241
    v_add_u32 v231, s22, v241
    v_mov_b32 v232, 0x7f000000
    s_mov_b32 s27, 229376
    s_mov_b32 s25, 123904
    s_mov_b32 s30, 0
    s_waitcnt lgkmcnt(0)
    s_cmp_eq_u32 s16, 0
    s_cselect_b32 s8, s36, s38
    s_cselect_b32 s9, s37, s39
    s_and_b32 s9, s9, 0xffff
    s_mov_b32 s10, 7340032
    s_mov_b32 s11, 0x00020000
e_mlp_kernel_4:
    s_mov_b32 s26, 0
    s_mov_b32 s31, s25
    s_add_u32 s52, s4, 48234496
    s_addc_u32 s53, s5, 0
    s_and_b32 s53, s53, 0xffff
    s_mov_b32 s54, 262144
    s_mov_b32 s55, 0x00020000
    v_lshlrev_b32 v0, 7, v224
    v_lshlrev_b32 v249, 2, v224
    v_mov_b32 v2, 1
    s_lshl_b32 s22, s17, 1
    s_add_u32 s22, s22, s16
    s_add_u32 s22, s22, 14
    s_lshl_b32 s22, s22, 5
    s_add_u32 s22, s22, s18
    s_lshl_b32 s6, s22, 7
    s_waitcnt vmcnt(0)
    s_barrier
    s_cmp_lg_u32 s16, 0
    s_cbranch_scc1 nf_mlp_kernel_5
    s_mov_b32 exec_hi, 0
    buffer_store_dword v2, v0, s[52:55], s51 offen sc1
    s_mov_b32 exec_hi, -1
nf_mlp_kernel_5:
    s_load_dwordx4 s[36:39], s[0:1], 48
    s_add_u32 s32, s31, s30
    s_add_u32 s33, s32, s30
    s_add_u32 s34, s33, s30
    s_add_u32 s40, s4, 46202880
    s_addc_u32 s41, s5, 0
    s_and_b32 s41, s41, 0xffff
    s_mov_b32 s42, 262144
    s_mov_b32 s43, 0x00020000
    v_and_b32 v237, 31, v224
    v_lshlrev_b32 v237, 4, v237
    v_lshrrev_b32 v241, 5, v224
    v_lshl_add_u32 v237, v241, 11, v237
    s_lshl_b32 s44, s17, 2
    s_add_u32 s44, s44, s16
    s_lshl_b32 s44, s44, 13
    s_add_u32 s45, s44, 4096
    s_lshl_b32 s22, s16, 12
    v_lshlrev_b32 v240, 4, v224
    v_add_u32 v240, s22, v240
    v_add_u32 v233, 0, v240
    v_add_u32 v234, 30976, v240
    v_add_u32 v235, 61952, v240
    v_add_u32 v236, 92928, v240
    v_lshrrev_b32 v240, 4, v224
    v_bfe_u32 v241, v224, 2, 2
    v_and_b32 v242, 1, v224
    v_lshlrev_b32 v242, 1, v242
    v_bfe_u32 v243, v224, 1, 1
    v_or_b32 v242, v242, v243
    v_and_b32 v243, 1, v240
    v_mul_u32_u24 v243, 7296, v243
    v_lshrrev_b32 v240, 1, v240
    v_lshl_add_u32 v240, v240, 3, v241
    v_mul_u32_u24 v240, 224, v240
    v_add_u32 v243, v243, v240
    v_lshl_add_u32 v243, v242, 3, v243
    v_add_u32 v244, 16384, v243
    v_add_u32 v245, 47360, v243
    v_add_u32 v246, 78336, v243
    v_add_u32 v247, 109312, v243
    s_waitcnt lgkmcnt(0)
    s_bfe_u32 s19, s2, 0x10002
    s_and_b32 s48, s2, 1
    s_lshl_b32 s48, s48, 3
    s_bfe_u32 s49, s2, 0x30003
    s_add_u32 s48, s48, s49
    s_bfe_u32 s49, s2, 0x10001
    s_lshl_b32 s49, s49, 2
    s_lshr_b32 s20, s2, 6
    s_add_u32 s49, s49, s20
    v_lshrrev_b32 v238, 3, v224
    v_and_b32 v239, 7, v224
    v_bfe_u32 v240, v224, 4, 1
    v_lshlrev_b32 v240, 2, v240
    v_xor_b32 v239, v239, v240
    v_lshlrev_b32 v238, 11, v238
    v_lshl_add_u32 v238, v239, 4, v238
    s_lshl_b32 s22, s16, 15
    s_lshl_b32 s23, s49, 8
    s_add_u32 s22, s22, s23
    s_mul_i32 s23, s19, 3670016
    s_add_u32 s22, s22, s23
    v_add_u32 v252, s22, v238
    v_add_u32 v253, 0x4000, v252
    v_add_u32 v254, 128, v252
    v_add_u32 v255, 128, v253
    s_mov_b32 s12, s36
    s_and_b32 s13, s37, 0xffff
    s_mov_b32 s14, 7340032
    s_mov_b32 s15, 0x00020000
    s_lshl_b32 s46, s17, 2
    s_add_u32 s46, s46, s16
    s_lshl_b32 s46, s46, 1
    s_lshr_b32 s47, s18, 4
    s_add_u32 s46, s46, s47
    s_lshl_b32 s46, s46, 10
    s_and_b32 s47, s18, 15
    s_lshl_b32 s47, s47, 2
    s_add_u32 s46, s46, s47
    s_and_b32 s20, s16, 1
    s_lshr_b32 s21, s16, 1
    s_lshl_b32 s47, s48, 1
    s_add_u32 s47, s47, s21
    s_lshl_b32 s47, s47, 1
    s_add_u32 s47, s47, s19
    s_lshl_b32 s47, s47, 3
    s_add_u32 s47, s47, s49
    s_lshl_b32 s47, s47, 7
    s_lshl_b32 s35, s48, 2
    s_add_u32 s35, s35, s16
    s_mul_i32 s22, s35, 229376
    s_mul_i32 s23, s19, 114688
    s_add_u32 s22, s22, s23
    v_lshlrev_b32 v248, 4, v224
    v_add_u32 v238, s22, v248
    v_accvgpr_write_b32 a104, v238
    s_lshl_b32 s22, s21, 13
    v_add_u32 v238, s22, v248
    v_accvgpr_write_b32 a105, v238
    v_lshrrev_b32 v238, 4, v224
    v_bfe_u32 v239, v224, 2, 2
    v_and_b32 v240, 1, v224
    v_lshlrev_b32 v240, 1, v240
    v_bfe_u32 v241, v224, 1, 1
    v_or_b32 v240, v240, v241
    v_and_b32 v241, 1, v238
    v_lshlrev_b32 v241, 1, v241
    s_lshl_b32 s22, s19, 2
    v_add_u32 v241, s22, v241
    v_lshrrev_b32 v242, 1, v240
    v_add_u32 v241, v241, v242
    v_lshrrev_b32 v242, 1, v239
    v_lshlrev_b32 v242, 2, v242
    v_xor_b32 v241, v241, v242
    v_lshlrev_b32 v241, 4, v241
    v_and_b32 v242, 1, v240
    v_lshl_add_u32 v241, v242, 3, v241
    v_lshl_add_u32 v241, v239, 7, v241
    v_lshrrev_b32 v242, 1, v238
    v_lshl_add_u32 v241, v242, 10, v241
    s_lshl_b32 s22, s20, 13
    v_add_u32 v241, s22, v241
    v_accvgpr_write_b32 a106, v241
    s_lshl_b32 s35, s48, 2
    s_lshl_b32 s22, s21, 1
    s_add_u32 s35, s35, s22
    s_lshl_b32 s22, s35, 16
    s_lshl_b32 s23, s49, 1
    s_add_u32 s23, s23, s20
    s_lshl_b32 s23, s23, 1
    s_add_u32 s23, s23, s19
    s_lshl_b32 s29, s23, 6
    s_add_u32 s29, s29, s22
    v_and_b32 v238, 31, v224
    v_lshlrev_b32 v238, 11, v238
    v_lshrrev_b32 v239, 5, v224
    v_lshl_add_u32 v238, v239, 4, v238
    v_add_u32 v238, s29, v238
    v_accvgpr_write_b32 a107, v238
    s_lshl_b32 s29, s23, 11
    s_add_u32 s58, s29, s22
    s_add_u32 s59, s58, 0x10000
    s_lshl_b32 s56, s2, 2
    s_add_u32 s56, s56, s16
    s_lshl_b32 s56, s56, 12
    s_xor_b32 s57, s56, 65536
    s_cmp_lt_u32 s16, 2
    s_cbranch_scc1 np_mlp_kernel_6
    s_mov_b64 exec, 0xffff
    s_mov_b32 s50, 0x40000
poll_mlp_kernel_7:
    buffer_load_dword v251, v249, s[52:55], s6 offen sc1
    s_waitcnt vmcnt(0)
    v_cmp_eq_u32 vcc, 0, v251
    s_and_b64 exec, exec, vcc
    s_cbranch_scc0 rdy_mlp_kernel_8
    s_sub_u32 s50, s50, 1
    s_cmp_lg_u32 s50, 0
    s_cbranch_scc1 poll_mlp_kernel_7
rdy_mlp_kernel_8:
    s_mov_b64 exec, -1
np_mlp_kernel_6:
    s_add_u32 m0, s24, 0
    s_nop 0
    buffer_load_dwordx4 v225, s[8:11], s26 offen lds
    s_add_u32 m0, s24, 1024
    s_nop 0
    buffer_load_dwordx4 v226, s[8:11], s26 offen lds
    s_add_u32 m0, s24, 2048
    s_nop 0
    buffer_load_dwordx4 v227, s[8:11], s26 offen lds
    s_add_u32 m0, s24, 3072
    s_nop 0
    buffer_load_dwordx4 v228, s[8:11], s26 offen lds
    s_add_u32 m0, s24, 4096
    s_nop 0
    buffer_load_dwordx4 v229, s[8:11], s26 offen lds
    s_add_u32 m0, s24, 5120
    s_nop 0
    buffer_load_dwordx4 v230, s[8:11], s26 offen lds
    s_add_u32 m0, s24, 6144
    s_nop 0
    buffer_load_dwordx4 v231, s[8:11], s26 offen lds
    s_mov_b32 m0, s31
    s_nop 0
    buffer_load_dwordx4 v232, s[8:11], s26 offen lds
    s_add_u32 s26, s26, s27
    s_add_u32 m0, s24, 30976
    s_nop 0
    buffer_load_dwordx4 v225, s[8:11], s26 offen lds
    s_add_u32 m0, s24, 32000
    s_nop 0
    buffer_load_dwordx4 v226, s[8:11], s26 offen lds
    s_add_u32 m0, s24, 33024
    s_nop 0
    buffer_load_dwordx4 v227, s[8:11], s26 offen lds
    s_add_u32 m0, s24, 34048
    s_nop 0
    buffer_load_dwordx4 v228, s[8:11], s26 offen lds
    s_add_u32 m0, s24, 35072
    s_nop 0
    buffer_load_dwordx4 v229, s[8:11], s26 offen lds
    s_add_u32 m0, s24, 36096
    s_nop 0
    buffer_load_dwordx4 v230, s[8:11], s26 offen lds
    s_add_u32 m0, s24, 37120
    s_nop 0
    buffer_load_dwordx4 v231, s[8:11], s26 offen lds
    s_mov_b32 m0, s32
    s_nop 0
    buffer_load_dwordx4 v232, s[8:11], s26 offen lds
    s_add_u32 s26, s26, s27
    s_add_u32 m0, s24, 61952
    s_nop 0
    buffer_load_dwordx4 v225, s[8:11], s26 offen lds
    s_add_u32 m0, s24, 62976
    s_nop 0
    buffer_load_dwordx4 v226, s[8:11], s26 offen lds
    s_add_u32 m0, s24, 64000
    s_nop 0
    buffer_load_dwordx4 v227, s[8:11], s26 offen lds
    s_add_u32 m0, s24, 65024
    s_nop 0
    buffer_load_dwordx4 v228, s[8:11], s26 offen lds
    s_add_u32 m0, s24, 66048
    s_nop 0
    buffer_load_dwordx4 v229, s[8:11], s26 offen lds
    s_add_u32 m0, s24, 67072
    s_nop 0
    buffer_load_dwordx4 v230, s[8:11], s26 offen lds
    s_add_u32 m0, s24, 68096
    s_nop 0
    buffer_load_dwordx4 v231, s[8:11], s26 offen lds
    s_mov_b32 m0, s33
    s_nop 0
    buffer_load_dwordx4 v232, s[8:11], s26 offen lds
    s_add_u32 s26, s26, s27
    s_add_u32 m0, s24, 92928
    s_nop 0
    buffer_load_dwordx4 v225, s[8:11], s26 offen lds
    s_add_u32 m0, s24, 93952
    s_nop 0
    buffer_load_dwordx4 v226, s[8:11], s26 offen lds
    s_add_u32 m0, s24, 94976
    s_nop 0
    buffer_load_dwordx4 v227, s[8:11], s26 offen lds
    s_add_u32 m0, s24, 96000
    s_nop 0
    buffer_load_dwordx4 v228, s[8:11], s26 offen lds
    s_waitcnt vmcnt(20)
    s_barrier
    ds_read_b128 a[0:3], v233 offset:0
    ds_read_b64_tr_b16 a[8:9], v244 offset:0
    ds_read_b64_tr_b16 a[10:11], v244 offset:896
    ds_read_b128 a[4:7], v233 offset:2048
    ds_read_b64_tr_b16 a[12:13], v244 offset:32
    ds_read_b64_tr_b16 a[14:15], v244 offset:928
    ds_read_b64_tr_b16 a[16:17], v244 offset:64
    ds_read_b64_tr_b16 a[18:19], v244 offset:960
    ds_read_b64_tr_b16 a[20:21], v244 offset:96
    ds_read_b64_tr_b16 a[22:23], v244 offset:992
    ds_read_b64_tr_b16 a[24:25], v244 offset:128
    ds_read_b64_tr_b16 a[26:27], v244 offset:1024
    ds_read_b64_tr_b16 a[28:29], v244 offset:160
    ds_read_b64_tr_b16 a[30:31], v244 offset:1056
    ds_read_b64_tr_b16 a[32:33], v244 offset:192
    ds_read_b64_tr_b16 a[34:35], v244 offset:1088
    s_waitcnt lgkmcnt(13)
    v_mfma_f32_32x32x16_bf16 v[0:15], a[8:11], a[0:3], 0
    ds_read_b128 a[36:39], v233 offset:1024
    ds_read_b64_tr_b16 a[44:45], v244 offset:3584
    s_waitcnt lgkmcnt(14)
    v_mfma_f32_32x32x16_bf16 v[16:31], a[8:11], a[4:7], 0
    ds_read_b64_tr_b16 a[46:47], v244 offset:4480
    ds_read_b128 a[40:43], v233 offset:3072
    s_waitcnt lgkmcnt(14)
    v_mfma_f32_32x32x16_bf16 v[32:47], a[12:15], a[0:3], 0
    ds_read_b64_tr_b16 a[48:49], v244 offset:3616
    ds_read_b64_tr_b16 a[50:51], v244 offset:4512
    v_mfma_f32_32x32x16_bf16 v[48:63], a[12:15], a[4:7], 0
    ds_read_b64_tr_b16 a[52:53], v244 offset:3648
    ds_read_b64_tr_b16 a[54:55], v244 offset:4544
    s_add_u32 m0, s24, 97024
    s_nop 0
    buffer_load_dwordx4 v229, s[8:11], s26 offen lds
    s_waitcnt lgkmcnt(14)
    v_mfma_f32_32x32x16_bf16 v[64:79], a[16:19], a[0:3], 0
    ds_read_b64_tr_b16 a[56:57], v244 offset:3680
    ds_read_b64_tr_b16 a[58:59], v244 offset:4576
    v_mfma_f32_32x32x16_bf16 v[80:95], a[16:19], a[4:7], 0
    ds_read_b64_tr_b16 a[60:61], v244 offset:3712
    ds_read_b64_tr_b16 a[62:63], v244 offset:4608
    v_mfma_f32_32x32x16_bf16 v[96:111], a[20:23], a[0:3], 0
    ds_read_b64_tr_b16 a[64:65], v244 offset:3744
    ds_read_b64_tr_b16 a[66:67], v244 offset:4640
    s_add_u32 m0, s24, 98048
    s_nop 0
    buffer_load_dwordx4 v230, s[8:11], s26 offen lds
    v_mfma_f32_32x32x16_bf16 v[112:127], a[20:23], a[4:7], 0
    ds_read_b64_tr_b16 a[68:69], v244 offset:3776
    ds_read_b64_tr_b16 a[70:71], v244 offset:4672
    s_waitcnt lgkmcnt(14)
    v_mfma_f32_32x32x16_bf16 v[128:143], a[24:27], a[0:3], 0
    v_mfma_f32_32x32x16_bf16 v[144:159], a[24:27], a[4:7], 0
    v_mfma_f32_32x32x16_bf16 v[160:175], a[28:31], a[0:3], 0
    s_add_u32 m0, s24, 99072
    s_nop 0
    buffer_load_dwordx4 v231, s[8:11], s26 offen lds
    v_mfma_f32_32x32x16_bf16 v[176:191], a[28:31], a[4:7], 0
    v_mfma_f32_32x32x16_bf16 v[192:207], a[32:35], a[0:3], 0
    v_mfma_f32_32x32x16_bf16 v[208:223], a[32:35], a[4:7], 0
    s_mov_b32 m0, s34
    s_nop 0
    buffer_load_dwordx4 v232, s[8:11], s26 offen lds
    s_add_u32 s26, s26, s27
    s_waitcnt lgkmcnt(13)
    v_mfma_f32_32x32x16_bf16 v[0:15], a[44:47], a[36:39], v[0:15]
    s_waitcnt lgkmcnt(12)
    v_mfma_f32_32x32x16_bf16 v[16:31], a[44:47], a[40:43], v[16:31]
    s_waitcnt lgkmcnt(10)
    v_mfma_f32_32x32x16_bf16 v[32:47], a[48:51], a[36:39], v[32:47]
    s_waitcnt vmcnt(16) lgkmcnt(0)
    s_barrier
    ds_read_b128 a[0:3], v234 offset:0
    ds_read_b64_tr_b16 a[8:9], v245 offset:0
    v_mfma_f32_32x32x16_bf16 v[48:63], a[48:51], a[40:43], v[48:63]
    ds_read_b64_tr_b16 a[10:11], v245 offset:896
    ds_read_b128 a[4:7], v234 offset:2048
    v_mfma_f32_32x32x16_bf16 v[64:79], a[52:55], a[36:39], v[64:79]
    ds_read_b64_tr_b16 a[12:13], v245 offset:32
    ds_read_b64_tr_b16 a[14:15], v245 offset:928
    s_add_u32 m0, s24, 0
    s_nop 0
    buffer_load_dwordx4 v225, s[8:11], s26 offen lds
    v_mfma_f32_32x32x16_bf16 v[80:95], a[52:55], a[40:43], v[80:95]
    ds_read_b64_tr_b16 a[16:17], v245 offset:64
    ds_read_b64_tr_b16 a[18:19], v245 offset:960
    v_mfma_f32_32x32x16_bf16 v[96:111], a[56:59], a[36:39], v[96:111]
    ds_read_b64_tr_b16 a[20:21], v245 offset:96
    ds_read_b64_tr_b16 a[22:23], v245 offset:992
    v_mfma_f32_32x32x16_bf16 v[112:127], a[56:59], a[40:43], v[112:127]
    ds_read_b64_tr_b16 a[24:25], v245 offset:128
    ds_read_b64_tr_b16 a[26:27], v245 offset:1024
    s_add_u32 m0, s24, 1024
    s_nop 0
    buffer_load_dwordx4 v226, s[8:11], s26 offen lds
    v_mfma_f32_32x32x16_bf16 v[128:143], a[60:63], a[36:39], v[128:143]
    ds_read_b64_tr_b16 a[28:29], v245 offset:160
    ds_read_b64_tr_b16 a[30:31], v245 offset:1056
    v_mfma_f32_32x32x16_bf16 v[144:159], a[60:63], a[40:43], v[144:159]
    ds_read_b64_tr_b16 a[32:33], v245 offset:192
    ds_read_b64_tr_b16 a[34:35], v245 offset:1088
    v_mfma_f32_32x32x16_bf16 v[160:175], a[64:67], a[36:39], v[160:175]
    s_add_u32 m0, s24, 2048
    s_nop 0
    buffer_load_dwordx4 v227, s[8:11], s26 offen lds
    v_mfma_f32_32x32x16_bf16 v[176:191], a[64:67], a[40:43], v[176:191]
    v_mfma_f32_32x32x16_bf16 v[192:207], a[68:71], a[36:39], v[192:207]
    v_mfma_f32_32x32x16_bf16 v[208:223], a[68:71], a[40:43], v[208:223]
    s_add_u32 m0, s24, 3072
    s_nop 0
    buffer_load_dwordx4 v228, s[8:11], s26 offen lds
    s_waitcnt lgkmcnt(13)
    v_mfma_f32_32x32x16_bf16 v[0:15], a[8:11], a[0:3], v[0:15]
    ds_read_b128 a[36:39], v234 offset:1024
    ds_read_b64_tr_b16 a[44:45], v245 offset:3584
    s_waitcnt lgkmcnt(14)
    v_mfma_f32_32x32x16_bf16 v[16:31], a[8:11], a[4:7], v[16:31]
    ds_read_b64_tr_b16 a[46:47], v245 offset:4480
    ds_read_b128 a[40:43], v234 offset:3072
    s_waitcnt lgkmcnt(14)
    v_mfma_f32_32x32x16_bf16 v[32:47], a[12:15], a[0:3], v[32:47]
    ds_read_b64_tr_b16 a[48:49], v245 offset:3616
    ds_read_b64_tr_b16 a[50:51], v245 offset:4512
    v_mfma_f32_32x32x16_bf16 v[48:63], a[12:15], a[4:7], v[48:63]
    ds_read_b64_tr_b16 a[52:53], v245 offset:3648
    ds_read_b64_tr_b16 a[54:55], v245 offset:4544
    s_add_u32 m0, s24, 4096
    s_nop 0
    buffer_load_dwordx4 v229, s[8:11], s26 offen lds
    s_waitcnt lgkmcnt(14)
    v_mfma_f32_32x32x16_bf16 v[64:79], a[16:19], a[0:3], v[64:79]
    ds_read_b64_tr_b16 a[56:57], v245 offset:3680
    ds_read_b64_tr_b16 a[58:59], v245 offset:4576
    v_mfma_f32_32x32x16_bf16 v[80:95], a[16:19], a[4:7], v[80:95]
    ds_read_b64_tr_b16 a[60:61], v245 offset:3712
    ds_read_b64_tr_b16 a[62:63], v245 offset:4608
    v_mfma_f32_32x32x16_bf16 v[96:111], a[20:23], a[0:3], v[96:111]
    ds_read_b64_tr_b16 a[64:65], v245 offset:3744
    ds_read_b64_tr_b16 a[66:67], v245 offset:4640
    s_add_u32 m0, s24, 5120
    s_nop 0
    buffer_load_dwordx4 v230, s[8:11], s26 offen lds
    v_mfma_f32_32x32x16_bf16 v[112:127], a[20:23], a[4:7], v[112:127]
    ds_read_b64_tr_b16 a[68:69], v245 offset:3776
    ds_read_b64_tr_b16 a[70:71], v245 offset:4672
    s_waitcnt lgkmcnt(14)
    v_mfma_f32_32x32x16_bf16 v[128:143], a[24:27], a[0:3], v[128:143]
    v_mfma_f32_32x32x16_bf16 v[144:159], a[24:27], a[4:7], v[144:159]
    v_mfma_f32_32x32x16_bf16 v[160:175], a[28:31], a[0:3], v[160:175]
    s_add_u32 m0, s24, 6144
    s_nop 0
    buffer_load_dwordx4 v231, s[8:11], s26 offen lds
    v_mfma_f32_32x32x16_bf16 v[176:191], a[28:31], a[4:7], v[176:191]
    v_mfma_f32_32x32x16_bf16 v[192:207], a[32:35], a[0:3], v[192:207]
    v_mfma_f32_32x32x16_bf16 v[208:223], a[32:35], a[4:7], v[208:223]
    s_mov_b32 m0, s31
    s_nop 0
    buffer_load_dwordx4 v232, s[8:11], s26 offen lds
    s_add_u32 s26, s26, s27
    s_waitcnt lgkmcnt(13)
    v_mfma_f32_32x32x16_bf16 v[0:15], a[44:47], a[36:39], v[0:15]
    s_waitcnt lgkmcnt(12)
    v_mfma_f32_32x32x16_bf16 v[16:31], a[44:47], a[40:43], v[16:31]
    s_waitcnt lgkmcnt(10)
    v_mfma_f32_32x32x16_bf16 v[32:47], a[48:51], a[36:39], v[32:47]
    s_waitcnt vmcnt(16) lgkmcnt(0)
    s_barrier
    ds_read_b128 a[0:3], v235 offset:0
    ds_read_b64_tr_b16 a[8:9], v246 offset:0
    v_mfma_f32_32x32x16_bf16 v[48:63], a[48:51], a[40:43], v[48:63]
    ds_read_b64_tr_b16 a[10:11], v246 offset:896
    ds_read_b128 a[4:7], v235 offset:2048
    v_mfma_f32_32x32x16_bf16 v[64:79], a[52:55], a[36:39], v[64:79]
    ds_read_b64_tr_b16 a[12:13], v246 offset:32
    ds_read_b64_tr_b16 a[14:15], v246 offset:928
    s_add_u32 m0, s24, 30976
    s_nop 0
    buffer_load_dwordx4 v225, s[8:11], s26 offen lds
    v_mfma_f32_32x32x16_bf16 v[80:95], a[52:55], a[40:43], v[80:95]
    ds_read_b64_tr_b16 a[16:17], v246 offset:64
    ds_read_b64_tr_b16 a[18:19], v246 offset:960
    v_mfma_f32_32x32x16_bf16 v[96:111], a[56:59], a[36:39], v[96:111]
    ds_read_b64_tr_b16 a[20:21], v246 offset:96
    ds_read_b64_tr_b16 a[22:23], v246 offset:992
    v_mfma_f32_32x32x16_bf16 v[112:127], a[56:59], a[40:43], v[112:127]
    ds_read_b64_tr_b16 a[24:25], v246 offset:128
    ds_read_b64_tr_b16 a[26:27], v246 offset:1024
    s_add_u32 m0, s24, 32000
    s_nop 0
    buffer_load_dwordx4 v226, s[8:11], s26 offen lds
    v_mfma_f32_32x32x16_bf16 v[128:143], a[60:63], a[36:39], v[128:143]
    ds_read_b64_tr_b16 a[28:29], v246 offset:160
    ds_read_b64_tr_b16 a[30:31], v246 offset:1056
    v_mfma_f32_32x32x16_bf16 v[144:159], a[60:63], a[40:43], v[144:159]
    ds_read_b64_tr_b16 a[32:33], v246 offset:192
    ds_read_b64_tr_b16 a[34:35], v246 offset:1088
    v_mfma_f32_32x32x16_bf16 v[160:175], a[64:67], a[36:39], v[160:175]
    s_add_u32 m0, s24, 33024
    s_nop 0
    buffer_load_dwordx4 v227, s[8:11], s26 offen lds
    v_mfma_f32_32x32x16_bf16 v[176:191], a[64:67], a[40:43], v[176:191]
    v_mfma_f32_32x32x16_bf16 v[192:207], a[68:71], a[36:39], v[192:207]
    v_mfma_f32_32x32x16_bf16 v[208:223], a[68:71], a[40:43], v[208:223]
    s_add_u32 m0, s24, 34048
    s_nop 0
    buffer_load_dwordx4 v228, s[8:11], s26 offen lds
    s_waitcnt lgkmcnt(13)
    v_mfma_f32_32x32x16_bf16 v[0:15], a[8:11], a[0:3], v[0:15]
    ds_read_b128 a[36:39], v235 offset:1024
    ds_read_b64_tr_b16 a[44:45], v246 offset:3584
    s_waitcnt lgkmcnt(14)
    v_mfma_f32_32x32x16_bf16 v[16:31], a[8:11], a[4:7], v[16:31]
    ds_read_b64_tr_b16 a[46:47], v246 offset:4480
    ds_read_b128 a[40:43], v235 offset:3072
    s_waitcnt lgkmcnt(14)
    v_mfma_f32_32x32x16_bf16 v[32:47], a[12:15], a[0:3], v[32:47]
    ds_read_b64_tr_b16 a[48:49], v246 offset:3616
    ds_read_b64_tr_b16 a[50:51], v246 offset:4512
    v_mfma_f32_32x32x16_bf16 v[48:63], a[12:15], a[4:7], v[48:63]
    ds_read_b64_tr_b16 a[52:53], v246 offset:3648
    ds_read_b64_tr_b16 a[54:55], v246 offset:4544
    s_add_u32 m0, s24, 35072
    s_nop 0
    buffer_load_dwordx4 v229, s[8:11], s26 offen lds
    s_waitcnt lgkmcnt(14)
    v_mfma_f32_32x32x16_bf16 v[64:79], a[16:19], a[0:3], v[64:79]
    ds_read_b64_tr_b16 a[56:57], v246 offset:3680
    ds_read_b64_tr_b16 a[58:59], v246 offset:4576
    v_mfma_f32_32x32x16_bf16 v[80:95], a[16:19], a[4:7], v[80:95]
    ds_read_b64_tr_b16 a[60:61], v246 offset:3712
    ds_read_b64_tr_b16 a[62:63], v246 offset:4608
    v_mfma_f32_32x32x16_bf16 v[96:111], a[20:23], a[0:3], v[96:111]
    ds_read_b64_tr_b16 a[64:65], v246 offset:3744
    ds_read_b64_tr_b16 a[66:67], v246 offset:4640
    s_add_u32 m0, s24, 36096
    s_nop 0
    buffer_load_dwordx4 v230, s[8:11], s26 offen lds
    buffer_load_dwordx4 a[72:75], v237, s[40:43], s44 offen offset:0
    v_mfma_f32_32x32x16_bf16 v[112:127], a[20:23], a[4:7], v[112:127]
    ds_read_b64_tr_b16 a[68:69], v246 offset:3776
    ds_read_b64_tr_b16 a[70:71], v246 offset:4672
    s_waitcnt lgkmcnt(14)
    v_mfma_f32_32x32x16_bf16 v[128:143], a[24:27], a[0:3], v[128:143]
    v_mfma_f32_32x32x16_bf16 v[144:159], a[24:27], a[4:7], v[144:159]
    v_mfma_f32_32x32x16_bf16 v[160:175], a[28:31], a[0:3], v[160:175]
    s_add_u32 m0, s24, 37120
    s_nop 0
    buffer_load_dwordx4 v231, s[8:11], s26 offen lds
    v_mfma_f32_32x32x16_bf16 v[176:191], a[28:31], a[4:7], v[176:191]
    v_mfma_f32_32x32x16_bf16 v[192:207], a[32:35], a[0:3], v[192:207]
    v_mfma_f32_32x32x16_bf16 v[208:223], a[32:35], a[4:7], v[208:223]
    s_mov_b32 m0, s32
    s_nop 0
    buffer_load_dwordx4 v232, s[8:11], s26 offen lds
    s_add_u32 s26, s26, s27
    buffer_load_dwordx4 a[76:79], v237, s[40:43], s44 offen offset:512
    s_waitcnt lgkmcnt(13)
    v_mfma_f32_32x32x16_bf16 v[0:15], a[44:47], a[36:39], v[0:15]
    s_waitcnt lgkmcnt(12)
    v_mfma_f32_32x32x16_bf16 v[16:31], a[44:47], a[40:43], v[16:31]
    s_waitcnt lgkmcnt(10)
    v_mfma_f32_32x32x16_bf16 v[32:47], a[48:51], a[36:39], v[32:47]
    s_waitcnt vmcnt(16) lgkmcnt(0)
    s_barrier
    ds_read_b128 a[0:3], v236 offset:0
    ds_read_b64_tr_b16 a[8:9], v247 offset:0
    v_mfma_f32_32x32x16_bf16 v[48:63], a[48:51], a[40:43], v[48:63]
    ds_read_b64_tr_b16 a[10:11], v247 offset:896
    ds_read_b128 a[4:7], v236 offset:2048
    v_mfma_f32_32x32x16_bf16 v[64:79], a[52:55], a[36:39], v[64:79]
    ds_read_b64_tr_b16 a[12:13], v247 offset:32
    ds_read_b64_tr_b16 a[14:15], v247 offset:928
    s_add_u32 m0, s24, 61952
    s_nop 0
    buffer_load_dwordx4 v225, s[8:11], s26 offen lds
    v_mfma_f32_32x32x16_bf16 v[80:95], a[52:55], a[40:43], v[80:95]
    ds_read_b64_tr_b16 a[16:17], v247 offset:64
    ds_read_b64_tr_b16 a[18:19], v247 offset:960
    v_mfma_f32_32x32x16_bf16 v[96:111], a[56:59], a[36:39], v[96:111]
    ds_read_b64_tr_b16 a[20:21], v247 offset:96
    ds_read_b64_tr_b16 a[22:23], v247 offset:992
    buffer_load_dwordx4 a[80:83], v237, s[40:43], s44 offen offset:1024
    v_mfma_f32_32x32x16_bf16 v[112:127], a[56:59], a[40:43], v[112:127]
    ds_read_b64_tr_b16 a[24:25], v247 offset:128
    ds_read_b64_tr_b16 a[26:27], v247 offset:1024
    s_add_u32 m0, s24, 62976
    s_nop 0
    buffer_load_dwordx4 v226, s[8:11], s26 offen lds
    v_mfma_f32_32x32x16_bf16 v[128:143], a[60:63], a[36:39], v[128:143]
    ds_read_b64_tr_b16 a[28:29], v247 offset:160
    ds_read_b64_tr_b16 a[30:31], v247 offset:1056
    v_mfma_f32_32x32x16_bf16 v[144:159], a[60:63], a[40:43], v[144:159]
    ds_read_b64_tr_b16 a[32:33], v247 offset:192
    ds_read_b64_tr_b16 a[34:35], v247 offset:1088
    v_mfma_f32_32x32x16_bf16 v[160:175], a[64:67], a[36:39], v[160:175]
    s_add_u32 m0, s24, 64000
    s_nop 0
    buffer_load_dwordx4 v227, s[8:11], s26 offen lds
    v_mfma_f32_32x32x16_bf16 v[176:191], a[64:67], a[40:43], v[176:191]
    v_mfma_f32_32x32x16_bf16 v[192:207], a[68:71], a[36:39], v[192:207]
    v_mfma_f32_32x32x16_bf16 v[208:223], a[68:71], a[40:43], v[208:223]
    s_add_u32 m0, s24, 65024
    s_nop 0
    buffer_load_dwordx4 v228, s[8:11], s26 offen lds
    buffer_load_dwordx4 a[84:87], v237, s[40:43], s44 offen offset:1536
    s_waitcnt lgkmcnt(13)
    v_mfma_f32_32x32x16_bf16 v[0:15], a[8:11], a[0:3], v[0:15]
    ds_read_b128 a[36:39], v236 offset:1024
    ds_read_b64_tr_b16 a[44:45], v247 offset:3584
    s_waitcnt lgkmcnt(14)
    v_mfma_f32_32x32x16_bf16 v[16:31], a[8:11], a[4:7], v[16:31]
    ds_read_b64_tr_b16 a[46:47], v247 offset:4480
    ds_read_b128 a[40:43], v236 offset:3072
    s_waitcnt lgkmcnt(14)
    v_mfma_f32_32x32x16_bf16 v[32:47], a[12:15], a[0:3], v[32:47]
    ds_read_b64_tr_b16 a[48:49], v247 offset:3616
    ds_read_b64_tr_b16 a[50:51], v247 offset:4512
    v_mfma_f32_32x32x16_bf16 v[48:63], a[12:15], a[4:7], v[48:63]
    ds_read_b64_tr_b16 a[52:53], v247 offset:3648
    ds_read_b64_tr_b16 a[54:55], v247 offset:4544
    s_add_u32 m0, s24, 66048
    s_nop 0
    buffer_load_dwordx4 v229, s[8:11], s26 offen lds
    s_waitcnt lgkmcnt(14)
    v_mfma_f32_32x32x16_bf16 v[64:79], a[16:19], a[0:3], v[64:79]
    ds_read_b64_tr_b16 a[56:57], v247 offset:3680
    ds_read_b64_tr_b16 a[58:59], v247 offset:4576
    v_mfma_f32_32x32x16_bf16 v[80:95], a[16:19], a[4:7], v[80:95]
    ds_read_b64_tr_b16 a[60:61], v247 offset:3712
    ds_read_b64_tr_b16 a[62:63], v247 offset:4608
    v_mfma_f32_32x32x16_bf16 v[96:111], a[20:23], a[0:3], v[96:111]
    ds_read_b64_tr_b16 a[64:65], v247 offset:3744
    ds_read_b64_tr_b16 a[66:67], v247 offset:4640
    s_add_u32 m0, s24, 67072
    s_nop 0
    buffer_load_dwordx4 v230, s[8:11], s26 offen lds
    buffer_load_dwordx4 a[88:91], v237, s[40:43], s45 offen offset:0
    v_mfma_f32_32x32x16_bf16 v[112:127], a[20:23], a[4:7], v[112:127]
    ds_read_b64_tr_b16 a[68:69], v247 offset:3776
    ds_read_b64_tr_b16 a[70:71], v247 offset:4672
    s_waitcnt lgkmcnt(14)
    v_mfma_f32_32x32x16_bf16 v[128:143], a[24:27], a[0:3], v[128:143]
    v_mfma_f32_32x32x16_bf16 v[144:159], a[24:27], a[4:7], v[144:159]
    v_mfma_f32_32x32x16_bf16 v[160:175], a[28:31], a[0:3], v[160:175]
    s_add_u32 m0, s24, 68096
    s_nop 0
    buffer_load_dwordx4 v231, s[8:11], s26 offen lds
    v_mfma_f32_32x32x16_bf16 v[176:191], a[28:31], a[4:7], v[176:191]
    v_mfma_f32_32x32x16_bf16 v[192:207], a[32:35], a[0:3], v[192:207]
    v_mfma_f32_32x32x16_bf16 v[208:223], a[32:35], a[4:7], v[208:223]
    s_mov_b32 m0, s33
    s_nop 0
    buffer_load_dwordx4 v232, s[8:11], s26 offen lds
    s_add_u32 s26, s26, s27
    buffer_load_dwordx4 a[92:95], v237, s[40:43], s45 offen offset:512
    s_waitcnt lgkmcnt(13)
    v_mfma_f32_32x32x16_bf16 v[0:15], a[44:47], a[36:39], v[0:15]
    s_waitcnt lgkmcnt(12)
    v_mfma_f32_32x32x16_bf16 v[16:31], a[44:47], a[40:43], v[16:31]
    s_waitcnt lgkmcnt(10)
    v_mfma_f32_32x32x16_bf16 v[32:47], a[48:51], a[36:39], v[32:47]
    s_waitcnt vmcnt(16) lgkmcnt(0)
    s_barrier
    ds_read_b128 a[0:3], v233 offset:0
    ds_read_b64_tr_b16 a[8:9], v244 offset:0
    v_mfma_f32_32x32x16_bf16 v[48:63], a[48:51], a[40:43], v[48:63]
    ds_read_b64_tr_b16 a[10:11], v244 offset:896
    ds_read_b128 a[4:7], v233 offset:2048
    v_mfma_f32_32x32x16_bf16 v[64:79], a[52:55], a[36:39], v[64:79]
    ds_read_b64_tr_b16 a[12:13], v244 offset:32
    ds_read_b64_tr_b16 a[14:15], v244 offset:928
    s_add_u32 m0, s24, 92928
    s_nop 0
    buffer_load_dwordx4 v225, s[8:11], s26 offen lds
    v_mfma_f32_32x32x16_bf16 v[80:95], a[52:55], a[40:43], v[80:95]
    ds_read_b64_tr_b16 a[16:17], v244 offset:64
    ds_read_b64_tr_b16 a[18:19], v244 offset:960
    v_mfma_f32_32x32x16_bf16 v[96:111], a[56:59], a[36:39], v[96:111]
    ds_read_b64_tr_b16 a[20:21], v244 offset:96
    ds_read_b64_tr_b16 a[22:23], v244 offset:992
    buffer_load_dwordx4 a[96:99], v237, s[40:43], s45 offen offset:1024
    v_mfma_f32_32x32x16_bf16 v[112:127], a[56:59], a[40:43], v[112:127]
    ds_read_b64_tr_b16 a[24:25], v244 offset:128
    ds_read_b64_tr_b16 a[26:27], v244 offset:1024
    s_add_u32 m0, s24, 93952
    s_nop 0
    buffer_load_dwordx4 v226, s[8:11], s26 offen lds
    v_mfma_f32_32x32x16_bf16 v[128:143], a[60:63], a[36:39], v[128:143]
    ds_read_b64_tr_b16 a[28:29], v244 offset:160
    ds_read_b64_tr_b16 a[30:31], v244 offset:1056
    v_mfma_f32_32x32x16_bf16 v[144:159], a[60:63], a[40:43], v[144:159]
    ds_read_b64_tr_b16 a[32:33], v244 offset:192
    ds_read_b64_tr_b16 a[34:35], v244 offset:1088
    v_mfma_f32_32x32x16_bf16 v[160:175], a[64:67], a[36:39], v[160:175]
    s_add_u32 m0, s24, 94976
    s_nop 0
    buffer_load_dwordx4 v227, s[8:11], s26 offen lds
    v_mfma_f32_32x32x16_bf16 v[176:191], a[64:67], a[40:43], v[176:191]
    v_mfma_f32_32x32x16_bf16 v[192:207], a[68:71], a[36:39], v[192:207]
    v_mfma_f32_32x32x16_bf16 v[208:223], a[68:71], a[40:43], v[208:223]
    s_add_u32 m0, s24, 96000
    s_nop 0
    buffer_load_dwordx4 v228, s[8:11], s26 offen lds
    buffer_load_dwordx4 a[100:103], v237, s[40:43], s45 offen offset:1536
    s_mov_b32 s28, 6
loop_mlp_kernel_9:
    s_waitcnt lgkmcnt(13)
    v_mfma_f32_32x32x16_bf16 v[0:15], a[8:11], a[0:3], v[0:15]
    ds_read_b128 a[36:39], v233 offset:1024
    ds_read_b64_tr_b16 a[44:45], v244 offset:3584
    s_waitcnt lgkmcnt(14)
    v_mfma_f32_32x32x16_bf16 v[16:31], a[8:11], a[4:7], v[16:31]
    ds_read_b64_tr_b16 a[46:47], v244 offset:4480
    ds_read_b128 a[40:43], v233 offset:3072
    s_waitcnt lgkmcnt(14)
    v_mfma_f32_32x32x16_bf16 v[32:47], a[12:15], a[0:3], v[32:47]
    ds_read_b64_tr_b16 a[48:49], v244 offset:3616
    ds_read_b64_tr_b16 a[50:51], v244 offset:4512
    v_mfma_f32_32x32x16_bf16 v[48:63], a[12:15], a[4:7], v[48:63]
    ds_read_b64_tr_b16 a[52:53], v244 offset:3648
    ds_read_b64_tr_b16 a[54:55], v244 offset:4544
    s_add_u32 m0, s24, 97024
    s_nop 0
    buffer_load_dwordx4 v229, s[8:11], s26 offen lds
    s_waitcnt lgkmcnt(14)
    v_mfma_f32_32x32x16_bf16 v[64:79], a[16:19], a[0:3], v[64:79]
    ds_read_b64_tr_b16 a[56:57], v244 offset:3680
    ds_read_b64_tr_b16 a[58:59], v244 offset:4576
    v_mfma_f32_32x32x16_bf16 v[80:95], a[16:19], a[4:7], v[80:95]
    ds_read_b64_tr_b16 a[60:61], v244 offset:3712
    ds_read_b64_tr_b16 a[62:63], v244 offset:4608
    v_mfma_f32_32x32x16_bf16 v[96:111], a[20:23], a[0:3], v[96:111]
    ds_read_b64_tr_b16 a[64:65], v244 offset:3744
    ds_read_b64_tr_b16 a[66:67], v244 offset:4640
    s_add_u32 m0, s24, 98048
    s_nop 0
    buffer_load_dwordx4 v230, s[8:11], s26 offen lds
    v_mfma_f32_32x32x16_bf16 v[112:127], a[20:23], a[4:7], v[112:127]
    ds_read_b64_tr_b16 a[68:69], v244 offset:3776
    ds_read_b64_tr_b16 a[70:71], v244 offset:4672
    s_waitcnt lgkmcnt(14)
    v_mfma_f32_32x32x16_bf16 v[128:143], a[24:27], a[0:3], v[128:143]
    v_mfma_f32_32x32x16_bf16 v[144:159], a[24:27], a[4:7], v[144:159]
    v_mfma_f32_32x32x16_bf16 v[160:175], a[28:31], a[0:3], v[160:175]
    s_add_u32 m0, s24, 99072
    s_nop 0
    buffer_load_dwordx4 v231, s[8:11], s26 offen lds
    v_mfma_f32_32x32x16_bf16 v[176:191], a[28:31], a[4:7], v[176:191]
    v_mfma_f32_32x32x16_bf16 v[192:207], a[32:35], a[0:3], v[192:207]
    v_mfma_f32_32x32x16_bf16 v[208:223], a[32:35], a[4:7], v[208:223]
    s_mov_b32 m0, s34
    s_nop 0
    buffer_load_dwordx4 v232, s[8:11], s26 offen lds
    s_add_u32 s26, s26, s27
    s_waitcnt lgkmcnt(13)
    v_mfma_f32_32x32x16_bf16 v[0:15], a[44:47], a[36:39], v[0:15]
    s_waitcnt lgkmcnt(12)
    v_mfma_f32_32x32x16_bf16 v[16:31], a[44:47], a[40:43], v[16:31]
    s_waitcnt lgkmcnt(10)
    v_mfma_f32_32x32x16_bf16 v[32:47], a[48:51], a[36:39], v[32:47]
    s_waitcnt vmcnt(16) lgkmcnt(0)
    s_barrier
    ds_read_b128 a[0:3], v234 offset:0
    ds_read_b64_tr_b16 a[8:9], v245 offset:0
    v_mfma_f32_32x32x16_bf16 v[48:63], a[48:51], a[40:43], v[48:63]
    ds_read_b64_tr_b16 a[10:11], v245 offset:896
    ds_read_b128 a[4:7], v234 offset:2048
    v_mfma_f32_32x32x16_bf16 v[64:79], a[52:55], a[36:39], v[64:79]
    ds_read_b64_tr_b16 a[12:13], v245 offset:32
    ds_read_b64_tr_b16 a[14:15], v245 offset:928
    s_add_u32 m0, s24, 0
    s_nop 0
    buffer_load_dwordx4 v225, s[8:11], s26 offen lds
    v_mfma_f32_32x32x16_bf16 v[80:95], a[52:55], a[40:43], v[80:95]
    ds_read_b64_tr_b16 a[16:17], v245 offset:64
    ds_read_b64_tr_b16 a[18:19], v245 offset:960
    v_mfma_f32_32x32x16_bf16 v[96:111], a[56:59], a[36:39], v[96:111]
    ds_read_b64_tr_b16 a[20:21], v245 offset:96
    ds_read_b64_tr_b16 a[22:23], v245 offset:992
    v_mfma_f32_32x32x16_bf16 v[112:127], a[56:59], a[40:43], v[112:127]
    ds_read_b64_tr_b16 a[24:25], v245 offset:128
    ds_read_b64_tr_b16 a[26:27], v245 offset:1024
    s_add_u32 m0, s24, 1024
    s_nop 0
    buffer_load_dwordx4 v226, s[8:11], s26 offen lds
    v_mfma_f32_32x32x16_bf16 v[128:143], a[60:63], a[36:39], v[128:143]
    ds_read_b64_tr_b16 a[28:29], v245 offset:160
    ds_read_b64_tr_b16 a[30:31], v245 offset:1056
    v_mfma_f32_32x32x16_bf16 v[144:159], a[60:63], a[40:43], v[144:159]
    ds_read_b64_tr_b16 a[32:33], v245 offset:192
    ds_read_b64_tr_b16 a[34:35], v245 offset:1088
    v_mfma_f32_32x32x16_bf16 v[160:175], a[64:67], a[36:39], v[160:175]
    s_add_u32 m0, s24, 2048
    s_nop 0
    buffer_load_dwordx4 v227, s[8:11], s26 offen lds
    v_mfma_f32_32x32x16_bf16 v[176:191], a[64:67], a[40:43], v[176:191]
    v_mfma_f32_32x32x16_bf16 v[192:207], a[68:71], a[36:39], v[192:207]
    v_mfma_f32_32x32x16_bf16 v[208:223], a[68:71], a[40:43], v[208:223]
    s_add_u32 m0, s24, 3072
    s_nop 0
    buffer_load_dwordx4 v228, s[8:11], s26 offen lds
    s_waitcnt lgkmcnt(13)
    v_mfma_f32_32x32x16_bf16 v[0:15], a[8:11], a[0:3], v[0:15]
    ds_read_b128 a[36:39], v234 offset:1024
    ds_read_b64_tr_b16 a[44:45], v245 offset:3584
    s_waitcnt lgkmcnt(14)
    v_mfma_f32_32x32x16_bf16 v[16:31], a[8:11], a[4:7], v[16:31]
    ds_read_b64_tr_b16 a[46:47], v245 offset:4480
    ds_read_b128 a[40:43], v234 offset:3072
    s_waitcnt lgkmcnt(14)
    v_mfma_f32_32x32x16_bf16 v[32:47], a[12:15], a[0:3], v[32:47]
    ds_read_b64_tr_b16 a[48:49], v245 offset:3616
    ds_read_b64_tr_b16 a[50:51], v245 offset:4512
    v_mfma_f32_32x32x16_bf16 v[48:63], a[12:15], a[4:7], v[48:63]
    ds_read_b64_tr_b16 a[52:53], v245 offset:3648
    ds_read_b64_tr_b16 a[54:55], v245 offset:4544
    s_add_u32 m0, s24, 4096
    s_nop 0
    buffer_load_dwordx4 v229, s[8:11], s26 offen lds
    s_waitcnt lgkmcnt(14)
    v_mfma_f32_32x32x16_bf16 v[64:79], a[16:19], a[0:3], v[64:79]
    ds_read_b64_tr_b16 a[56:57], v245 offset:3680
    ds_read_b64_tr_b16 a[58:59], v245 offset:4576
    v_mfma_f32_32x32x16_bf16 v[80:95], a[16:19], a[4:7], v[80:95]
    ds_read_b64_tr_b16 a[60:61], v245 offset:3712
    ds_read_b64_tr_b16 a[62:63], v245 offset:4608
    v_mfma_f32_32x32x16_bf16 v[96:111], a[20:23], a[0:3], v[96:111]
    ds_read_b64_tr_b16 a[64:65], v245 offset:3744
    ds_read_b64_tr_b16 a[66:67], v245 offset:4640
    s_add_u32 m0, s24, 5120
    s_nop 0
    buffer_load_dwordx4 v230, s[8:11], s26 offen lds
    v_mfma_f32_32x32x16_bf16 v[112:127], a[20:23], a[4:7], v[112:127]
    ds_read_b64_tr_b16 a[68:69], v245 offset:3776
    ds_read_b64_tr_b16 a[70:71], v245 offset:4672
    s_waitcnt lgkmcnt(14)
    v_mfma_f32_32x32x16_bf16 v[128:143], a[24:27], a[0:3], v[128:143]
    v_mfma_f32_32x32x16_bf16 v[144:159], a[24:27], a[4:7], v[144:159]
    v_mfma_f32_32x32x16_bf16 v[160:175], a[28:31], a[0:3], v[160:175]
    s_add_u32 m0, s24, 6144
    s_nop 0
    buffer_load_dwordx4 v231, s[8:11], s26 offen lds
    v_mfma_f32_32x32x16_bf16 v[176:191], a[28:31], a[4:7], v[176:191]
    v_mfma_f32_32x32x16_bf16 v[192:207], a[32:35], a[0:3], v[192:207]
    v_mfma_f32_32x32x16_bf16 v[208:223], a[32:35], a[4:7], v[208:223]
    s_mov_b32 m0, s31
    s_nop 0
    buffer_load_dwordx4 v232, s[8:11], s26 offen lds
    s_add_u32 s26, s26, s27
    s_waitcnt lgkmcnt(13)
    v_mfma_f32_32x32x16_bf16 v[0:15], a[44:47], a[36:39], v[0:15]
    s_waitcnt lgkmcnt(12)
    v_mfma_f32_32x32x16_bf16 v[16:31], a[44:47], a[40:43], v[16:31]
    s_waitcnt lgkmcnt(10)
    v_mfma_f32_32x32x16_bf16 v[32:47], a[48:51], a[36:39], v[32:47]
    s_waitcnt vmcnt(16) lgkmcnt(0)
    s_barrier
    ds_read_b128 a[0:3], v235 offset:0
    ds_read_b64_tr_b16 a[8:9], v246 offset:0
    v_mfma_f32_32x32x16_bf16 v[48:63], a[48:51], a[40:43], v[48:63]
    ds_read_b64_tr_b16 a[10:11], v246 offset:896
    ds_read_b128 a[4:7], v235 offset:2048
    v_mfma_f32_32x32x16_bf16 v[64:79], a[52:55], a[36:39], v[64:79]
    ds_read_b64_tr_b16 a[12:13], v246 offset:32
    ds_read_b64_tr_b16 a[14:15], v246 offset:928
    s_add_u32 m0, s24, 30976
    s_nop 0
    buffer_load_dwordx4 v225, s[8:11], s26 offen lds
    v_mfma_f32_32x32x16_bf16 v[80:95], a[52:55], a[40:43], v[80:95]
    ds_read_b64_tr_b16 a[16:17], v246 offset:64
    ds_read_b64_tr_b16 a[18:19], v246 offset:960
    v_mfma_f32_32x32x16_bf16 v[96:111], a[56:59], a[36:39], v[96:111]
    ds_read_b64_tr_b16 a[20:21], v246 offset:96
    ds_read_b64_tr_b16 a[22:23], v246 offset:992
    v_mfma_f32_32x32x16_bf16 v[112:127], a[56:59], a[40:43], v[112:127]
    ds_read_b64_tr_b16 a[24:25], v246 offset:128
    ds_read_b64_tr_b16 a[26:27], v246 offset:1024
    s_add_u32 m0, s24, 32000
    s_nop 0
    buffer_load_dwordx4 v226, s[8:11], s26 offen lds
    v_mfma_f32_32x32x16_bf16 v[128:143], a[60:63], a[36:39], v[128:143]
    ds_read_b64_tr_b16 a[28:29], v246 offset:160
    ds_read_b64_tr_b16 a[30:31], v246 offset:1056
    v_mfma_f32_32x32x16_bf16 v[144:159], a[60:63], a[40:43], v[144:159]
    ds_read_b64_tr_b16 a[32:33], v246 offset:192
    ds_read_b64_tr_b16 a[34:35], v246 offset:1088
    v_mfma_f32_32x32x16_bf16 v[160:175], a[64:67], a[36:39], v[160:175]
    s_add_u32 m0, s24, 33024
    s_nop 0
    buffer_load_dwordx4 v227, s[8:11], s26 offen lds
    v_mfma_f32_32x32x16_bf16 v[176:191], a[64:67], a[40:43], v[176:191]
    v_mfma_f32_32x32x16_bf16 v[192:207], a[68:71], a[36:39], v[192:207]
    v_mfma_f32_32x32x16_bf16 v[208:223], a[68:71], a[40:43], v[208:223]
    s_add_u32 m0, s24, 34048
    s_nop 0
    buffer_load_dwordx4 v228, s[8:11], s26 offen lds
    s_waitcnt lgkmcnt(13)
    v_mfma_f32_32x32x16_bf16 v[0:15], a[8:11], a[0:3], v[0:15]
    ds_read_b128 a[36:39], v235 offset:1024
    ds_read_b64_tr_b16 a[44:45], v246 offset:3584
    s_waitcnt lgkmcnt(14)
    v_mfma_f32_32x32x16_bf16 v[16:31], a[8:11], a[4:7], v[16:31]
    ds_read_b64_tr_b16 a[46:47], v246 offset:4480
    ds_read_b128 a[40:43], v235 offset:3072
    s_waitcnt lgkmcnt(14)
    v_mfma_f32_32x32x16_bf16 v[32:47], a[12:15], a[0:3], v[32:47]
    ds_read_b64_tr_b16 a[48:49], v246 offset:3616
    ds_read_b64_tr_b16 a[50:51], v246 offset:4512
    v_mfma_f32_32x32x16_bf16 v[48:63], a[12:15], a[4:7], v[48:63]
    ds_read_b64_tr_b16 a[52:53], v246 offset:3648
    ds_read_b64_tr_b16 a[54:55], v246 offset:4544
    s_add_u32 m0, s24, 35072
    s_nop 0
    buffer_load_dwordx4 v229, s[8:11], s26 offen lds
    s_waitcnt lgkmcnt(14)
    v_mfma_f32_32x32x16_bf16 v[64:79], a[16:19], a[0:3], v[64:79]
    ds_read_b64_tr_b16 a[56:57], v246 offset:3680
    ds_read_b64_tr_b16 a[58:59], v246 offset:4576
    v_mfma_f32_32x32x16_bf16 v[80:95], a[16:19], a[4:7], v[80:95]
    ds_read_b64_tr_b16 a[60:61], v246 offset:3712
    ds_read_b64_tr_b16 a[62:63], v246 offset:4608
    v_mfma_f32_32x32x16_bf16 v[96:111], a[20:23], a[0:3], v[96:111]
    ds_read_b64_tr_b16 a[64:65], v246 offset:3744
    ds_read_b64_tr_b16 a[66:67], v246 offset:4640
    s_add_u32 m0, s24, 36096
    s_nop 0
    buffer_load_dwordx4 v230, s[8:11], s26 offen lds
    v_mfma_f32_32x32x16_bf16 v[112:127], a[20:23], a[4:7], v[112:127]
    ds_read_b64_tr_b16 a[68:69], v246 offset:3776
    ds_read_b64_tr_b16 a[70:71], v246 offset:4672
    s_waitcnt lgkmcnt(14)
    v_mfma_f32_32x32x16_bf16 v[128:143], a[24:27], a[0:3], v[128:143]
    v_mfma_f32_32x32x16_bf16 v[144:159], a[24:27], a[4:7], v[144:159]
    v_mfma_f32_32x32x16_bf16 v[160:175], a[28:31], a[0:3], v[160:175]
    s_add_u32 m0, s24, 37120
    s_nop 0
    buffer_load_dwordx4 v231, s[8:11], s26 offen lds
    v_mfma_f32_32x32x16_bf16 v[176:191], a[28:31], a[4:7], v[176:191]
    v_mfma_f32_32x32x16_bf16 v[192:207], a[32:35], a[0:3], v[192:207]
    v_mfma_f32_32x32x16_bf16 v[208:223], a[32:35], a[4:7], v[208:223]
    s_mov_b32 m0, s32
    s_nop 0
    buffer_load_dwordx4 v232, s[8:11], s26 offen lds
    s_add_u32 s26, s26, s27
    s_waitcnt lgkmcnt(13)
    v_mfma_f32_32x32x16_bf16 v[0:15], a[44:47], a[36:39], v[0:15]
    s_waitcnt lgkmcnt(12)
    v_mfma_f32_32x32x16_bf16 v[16:31], a[44:47], a[40:43], v[16:31]
    s_waitcnt lgkmcnt(10)
    v_mfma_f32_32x32x16_bf16 v[32:47], a[48:51], a[36:39], v[32:47]
    s_waitcnt vmcnt(16) lgkmcnt(0)
    s_barrier
    ds_read_b128 a[0:3], v236 offset:0
    ds_read_b64_tr_b16 a[8:9], v247 offset:0
    v_mfma_f32_32x32x16_bf16 v[48:63], a[48:51], a[40:43], v[48:63]
    ds_read_b64_tr_b16 a[10:11], v247 offset:896
    ds_read_b128 a[4:7], v236 offset:2048
    v_mfma_f32_32x32x16_bf16 v[64:79], a[52:55], a[36:39], v[64:79]
    ds_read_b64_tr_b16 a[12:13], v247 offset:32
    ds_read_b64_tr_b16 a[14:15], v247 offset:928
    s_add_u32 m0, s24, 61952
    s_nop 0
    buffer_load_dwordx4 v225, s[8:11], s26 offen lds
    v_mfma_f32_32x32x16_bf16 v[80:95], a[52:55], a[40:43], v[80:95]
    ds_read_b64_tr_b16 a[16:17], v247 offset:64
    ds_read_b64_tr_b16 a[18:19], v247 offset:960
    v_mfma_f32_32x32x16_bf16 v[96:111], a[56:59], a[36:39], v[96:111]
    ds_read_b64_tr_b16 a[20:21], v247 offset:96
    ds_read_b64_tr_b16 a[22:23], v247 offset:992
    v_mfma_f32_32x32x16_bf16 v[112:127], a[56:59], a[40:43], v[112:127]
    ds_read_b64_tr_b16 a[24:25], v247 offset:128
    ds_read_b64_tr_b16 a[26:27], v247 offset:1024
    s_add_u32 m0, s24, 62976
    s_nop 0
    buffer_load_dwordx4 v226, s[8:11], s26 offen lds
    v_mfma_f32_32x32x16_bf16 v[128:143], a[60:63], a[36:39], v[128:143]
    ds_read_b64_tr_b16 a[28:29], v247 offset:160
    ds_read_b64_tr_b16 a[30:31], v247 offset:1056
    v_mfma_f32_32x32x16_bf16 v[144:159], a[60:63], a[40:43], v[144:159]
    ds_read_b64_tr_b16 a[32:33], v247 offset:192
    ds_read_b64_tr_b16 a[34:35], v247 offset:1088
    v_mfma_f32_32x32x16_bf16 v[160:175], a[64:67], a[36:39], v[160:175]
    s_add_u32 m0, s24, 64000
    s_nop 0
    buffer_load_dwordx4 v227, s[8:11], s26 offen lds
    v_mfma_f32_32x32x16_bf16 v[176:191], a[64:67], a[40:43], v[176:191]
    v_mfma_f32_32x32x16_bf16 v[192:207], a[68:71], a[36:39], v[192:207]
    v_mfma_f32_32x32x16_bf16 v[208:223], a[68:71], a[40:43], v[208:223]
    s_add_u32 m0, s24, 65024
    s_nop 0
    buffer_load_dwordx4 v228, s[8:11], s26 offen lds
    s_waitcnt lgkmcnt(13)
    v_mfma_f32_32x32x16_bf16 v[0:15], a[8:11], a[0:3], v[0:15]
    ds_read_b128 a[36:39], v236 offset:1024
    ds_read_b64_tr_b16 a[44:45], v247 offset:3584
    s_waitcnt lgkmcnt(14)
    v_mfma_f32_32x32x16_bf16 v[16:31], a[8:11], a[4:7], v[16:31]
    ds_read_b64_tr_b16 a[46:47], v247 offset:4480
    ds_read_b128 a[40:43], v236 offset:3072
    s_waitcnt lgkmcnt(14)
    v_mfma_f32_32x32x16_bf16 v[32:47], a[12:15], a[0:3], v[32:47]
    ds_read_b64_tr_b16 a[48:49], v247 offset:3616
    ds_read_b64_tr_b16 a[50:51], v247 offset:4512
    v_mfma_f32_32x32x16_bf16 v[48:63], a[12:15], a[4:7], v[48:63]
    ds_read_b64_tr_b16 a[52:53], v247 offset:3648
    ds_read_b64_tr_b16 a[54:55], v247 offset:4544
    s_add_u32 m0, s24, 66048
    s_nop 0
    buffer_load_dwordx4 v229, s[8:11], s26 offen lds
    s_waitcnt lgkmcnt(14)
    v_mfma_f32_32x32x16_bf16 v[64:79], a[16:19], a[0:3], v[64:79]
    ds_read_b64_tr_b16 a[56:57], v247 offset:3680
    ds_read_b64_tr_b16 a[58:59], v247 offset:4576
    v_mfma_f32_32x32x16_bf16 v[80:95], a[16:19], a[4:7], v[80:95]
    ds_read_b64_tr_b16 a[60:61], v247 offset:3712
    ds_read_b64_tr_b16 a[62:63], v247 offset:4608
    v_mfma_f32_32x32x16_bf16 v[96:111], a[20:23], a[0:3], v[96:111]
    ds_read_b64_tr_b16 a[64:65], v247 offset:3744
    ds_read_b64_tr_b16 a[66:67], v247 offset:4640
    s_add_u32 m0, s24, 67072
    s_nop 0
    buffer_load_dwordx4 v230, s[8:11], s26 offen lds
    v_mfma_f32_32x32x16_bf16 v[112:127], a[20:23], a[4:7], v[112:127]
    ds_read_b64_tr_b16 a[68:69], v247 offset:3776
    ds_read_b64_tr_b16 a[70:71], v247 offset:4672
    s_waitcnt lgkmcnt(14)
    v_mfma_f32_32x32x16_bf16 v[128:143], a[24:27], a[0:3], v[128:143]
    v_mfma_f32_32x32x16_bf16 v[144:159], a[24:27], a[4:7], v[144:159]
    v_mfma_f32_32x32x16_bf16 v[160:175], a[28:31], a[0:3], v[160:175]
    s_add_u32 m0, s24, 68096
    s_nop 0
    buffer_load_dwordx4 v231, s[8:11], s26 offen lds
    v_mfma_f32_32x32x16_bf16 v[176:191], a[28:31], a[4:7], v[176:191]
    v_mfma_f32_32x32x16_bf16 v[192:207], a[32:35], a[0:3], v[192:207]
    v_mfma_f32_32x32x16_bf16 v[208:223], a[32:35], a[4:7], v[208:223]
    s_mov_b32 m0, s33
    s_nop 0
    buffer_load_dwordx4 v232, s[8:11], s26 offen lds
    s_add_u32 s26, s26, s27
    s_waitcnt lgkmcnt(13)
    v_mfma_f32_32x32x16_bf16 v[0:15], a[44:47], a[36:39], v[0:15]
    s_waitcnt lgkmcnt(12)
    v_mfma_f32_32x32x16_bf16 v[16:31], a[44:47], a[40:43], v[16:31]
    s_waitcnt lgkmcnt(10)
    v_mfma_f32_32x32x16_bf16 v[32:47], a[48:51], a[36:39], v[32:47]
    s_waitcnt vmcnt(16) lgkmcnt(0)
    s_barrier
    ds_read_b128 a[0:3], v233 offset:0
    ds_read_b64_tr_b16 a[8:9], v244 offset:0
    v_mfma_f32_32x32x16_bf16 v[48:63], a[48:51], a[40:43], v[48:63]
    ds_read_b64_tr_b16 a[10:11], v244 offset:896
    ds_read_b128 a[4:7], v233 offset:2048
    v_mfma_f32_32x32x16_bf16 v[64:79], a[52:55], a[36:39], v[64:79]
    ds_read_b64_tr_b16 a[12:13], v244 offset:32
    ds_read_b64_tr_b16 a[14:15], v244 offset:928
    s_add_u32 m0, s24, 92928
    s_nop 0
    buffer_load_dwordx4 v225, s[8:11], s26 offen lds
    v_mfma_f32_32x32x16_bf16 v[80:95], a[52:55], a[40:43], v[80:95]
    ds_read_b64_tr_b16 a[16:17], v244 offset:64
    ds_read_b64_tr_b16 a[18:19], v244 offset:960
    v_mfma_f32_32x32x16_bf16 v[96:111], a[56:59], a[36:39], v[96:111]
    ds_read_b64_tr_b16 a[20:21], v244 offset:96
    ds_read_b64_tr_b16 a[22:23], v244 offset:992
    v_mfma_f32_32x32x16_bf16 v[112:127], a[56:59], a[40:43], v[112:127]
    ds_read_b64_tr_b16 a[24:25], v244 offset:128
    ds_read_b64_tr_b16 a[26:27], v244 offset:1024
    s_add_u32 m0, s24, 93952
    s_nop 0
    buffer_load_dwordx4 v226, s[8:11], s26 offen lds
    v_mfma_f32_32x32x16_bf16 v[128:143], a[60:63], a[36:39], v[128:143]
    ds_read_b64_tr_b16 a[28:29], v244 offset:160
    ds_read_b64_tr_b16 a[30:31], v244 offset:1056
    v_mfma_f32_32x32x16_bf16 v[144:159], a[60:63], a[40:43], v[144:159]
    ds_read_b64_tr_b16 a[32:33], v244 offset:192
    ds_read_b64_tr_b16 a[34:35], v244 offset:1088
    v_mfma_f32_32x32x16_bf16 v[160:175], a[64:67], a[36:39], v[160:175]
    s_add_u32 m0, s24, 94976
    s_nop 0
    buffer_load_dwordx4 v227, s[8:11], s26 offen lds
    v_mfma_f32_32x32x16_bf16 v[176:191], a[64:67], a[40:43], v[176:191]
    v_mfma_f32_32x32x16_bf16 v[192:207], a[68:71], a[36:39], v[192:207]
    v_mfma_f32_32x32x16_bf16 v[208:223], a[68:71], a[40:43], v[208:223]
    s_add_u32 m0, s24, 96000
    s_nop 0
    buffer_load_dwordx4 v228, s[8:11], s26 offen lds
    s_sub_u32 s28, s28, 1
    s_cmp_lg_u32 s28, 0
    s_cbranch_scc1 loop_mlp_kernel_9
    s_waitcnt lgkmcnt(13)
    v_mfma_f32_32x32x16_bf16 v[0:15], a[8:11], a[0:3], v[0:15]
    ds_read_b128 a[36:39], v233 offset:1024
    ds_read_b64_tr_b16 a[44:45], v244 offset:3584
    s_waitcnt lgkmcnt(14)
    v_mfma_f32_32x32x16_bf16 v[16:31], a[8:11], a[4:7], v[16:31]
    ds_read_b64_tr_b16 a[46:47], v244 offset:4480
    ds_read_b128 a[40:43], v233 offset:3072
    s_waitcnt lgkmcnt(14)
    v_mfma_f32_32x32x16_bf16 v[32:47], a[12:15], a[0:3], v[32:47]
    ds_read_b64_tr_b16 a[48:49], v244 offset:3616
    ds_read_b64_tr_b16 a[50:51], v244 offset:4512
    v_mfma_f32_32x32x16_bf16 v[48:63], a[12:15], a[4:7], v[48:63]
    ds_read_b64_tr_b16 a[52:53], v244 offset:3648
    ds_read_b64_tr_b16 a[54:55], v244 offset:4544
    s_add_u32 m0, s24, 97024
    s_nop 0
    buffer_load_dwordx4 v229, s[8:11], s26 offen lds
    s_waitcnt lgkmcnt(14)
    v_mfma_f32_32x32x16_bf16 v[64:79], a[16:19], a[0:3], v[64:79]
    ds_read_b64_tr_b16 a[56:57], v244 offset:3680
    ds_read_b64_tr_b16 a[58:59], v244 offset:4576
    v_mfma_f32_32x32x16_bf16 v[80:95], a[16:19], a[4:7], v[80:95]
    ds_read_b64_tr_b16 a[60:61], v244 offset:3712
    ds_read_b64_tr_b16 a[62:63], v244 offset:4608
    v_mfma_f32_32x32x16_bf16 v[96:111], a[20:23], a[0:3], v[96:111]
    ds_read_b64_tr_b16 a[64:65], v244 offset:3744
    ds_read_b64_tr_b16 a[66:67], v244 offset:4640
    s_add_u32 m0, s24, 98048
    s_nop 0
    buffer_load_dwordx4 v230, s[8:11], s26 offen lds
    v_mfma_f32_32x32x16_bf16 v[112:127], a[20:23], a[4:7], v[112:127]
    ds_read_b64_tr_b16 a[68:69], v244 offset:3776
    ds_read_b64_tr_b16 a[70:71], v244 offset:4672
    s_waitcnt lgkmcnt(14)
    v_mfma_f32_32x32x16_bf16 v[128:143], a[24:27], a[0:3], v[128:143]
    v_mfma_f32_32x32x16_bf16 v[144:159], a[24:27], a[4:7], v[144:159]
    v_mfma_f32_32x32x16_bf16 v[160:175], a[28:31], a[0:3], v[160:175]
    s_add_u32 m0, s24, 99072
    s_nop 0
    buffer_load_dwordx4 v231, s[8:11], s26 offen lds
    v_mfma_f32_32x32x16_bf16 v[176:191], a[28:31], a[4:7], v[176:191]
    v_mfma_f32_32x32x16_bf16 v[192:207], a[32:35], a[0:3], v[192:207]
    v_mfma_f32_32x32x16_bf16 v[208:223], a[32:35], a[4:7], v[208:223]
    s_mov_b32 m0, s34
    s_nop 0
    buffer_load_dwordx4 v232, s[8:11], s26 offen lds
    s_add_u32 s26, s26, s27
    s_waitcnt lgkmcnt(13)
    v_mfma_f32_32x32x16_bf16 v[0:15], a[44:47], a[36:39], v[0:15]
    s_waitcnt lgkmcnt(12)
    v_mfma_f32_32x32x16_bf16 v[16:31], a[44:47], a[40:43], v[16:31]
    s_waitcnt lgkmcnt(10)
    v_mfma_f32_32x32x16_bf16 v[32:47], a[48:51], a[36:39], v[32:47]
    s_waitcnt vmcnt(16) lgkmcnt(0)
    s_barrier
    ds_read_b128 a[0:3], v234 offset:0
    ds_read_b64_tr_b16 a[8:9], v245 offset:0
    v_mfma_f32_32x32x16_bf16 v[48:63], a[48:51], a[40:43], v[48:63]
    ds_read_b64_tr_b16 a[10:11], v245 offset:896
    ds_read_b128 a[4:7], v234 offset:2048
    v_mfma_f32_32x32x16_bf16 v[64:79], a[52:55], a[36:39], v[64:79]
    ds_read_b64_tr_b16 a[12:13], v245 offset:32
    ds_read_b64_tr_b16 a[14:15], v245 offset:928
    v_mfma_f32_32x32x16_bf16 v[80:95], a[52:55], a[40:43], v[80:95]
    ds_read_b64_tr_b16 a[16:17], v245 offset:64
    ds_read_b64_tr_b16 a[18:19], v245 offset:960
    v_mfma_f32_32x32x16_bf16 v[96:111], a[56:59], a[36:39], v[96:111]
    ds_read_b64_tr_b16 a[20:21], v245 offset:96
    ds_read_b64_tr_b16 a[22:23], v245 offset:992
    v_mfma_f32_32x32x16_bf16 v[112:127], a[56:59], a[40:43], v[112:127]
    ds_read_b64_tr_b16 a[24:25], v245 offset:128
    ds_read_b64_tr_b16 a[26:27], v245 offset:1024
    v_mfma_f32_32x32x16_bf16 v[128:143], a[60:63], a[36:39], v[128:143]
    ds_read_b64_tr_b16 a[28:29], v245 offset:160
    ds_read_b64_tr_b16 a[30:31], v245 offset:1056
    v_mfma_f32_32x32x16_bf16 v[144:159], a[60:63], a[40:43], v[144:159]
    ds_read_b64_tr_b16 a[32:33], v245 offset:192
    ds_read_b64_tr_b16 a[34:35], v245 offset:1088
    v_mfma_f32_32x32x16_bf16 v[160:175], a[64:67], a[36:39], v[160:175]
    v_mfma_f32_32x32x16_bf16 v[176:191], a[64:67], a[40:43], v[176:191]
    v_mfma_f32_32x32x16_bf16 v[192:207], a[68:71], a[36:39], v[192:207]
    v_mfma_f32_32x32x16_bf16 v[208:223], a[68:71], a[40:43], v[208:223]
    s_waitcnt lgkmcnt(13)
    v_mfma_f32_32x32x16_bf16 v[0:15], a[8:11], a[0:3], v[0:15]
    ds_read_b128 a[36:39], v234 offset:1024
    ds_read_b64_tr_b16 a[44:45], v245 offset:3584
    v_accvgpr_read_b32 v225, a72
    s_waitcnt lgkmcnt(14)
    v_mfma_f32_32x32x16_bf16 v[16:31], a[8:11], a[4:7], v[16:31]
    ds_read_b64_tr_b16 a[46:47], v245 offset:4480
    ds_read_b128 a[40:43], v234 offset:3072
    v_accvgpr_read_b32 v226, a73
    v_accvgpr_read_b32 v227, a74
    s_waitcnt lgkmcnt(14)
    v_mfma_f32_32x32x16_bf16 v[32:47], a[12:15], a[0:3], v[32:47]
    ds_read_b64_tr_b16 a[48:49], v245 offset:3616
    ds_read_b64_tr_b16 a[50:51], v245 offset:4512
    v_accvgpr_read_b32 v228, a75
    v_mfma_f32_32x32x16_bf16 v[48:63], a[12:15], a[4:7], v[48:63]
    ds_read_b64_tr_b16 a[52:53], v245 offset:3648
    ds_read_b64_tr_b16 a[54:55], v245 offset:4544
    v_accvgpr_read_b32 v229, a76
    v_accvgpr_read_b32 v230, a77
    s_waitcnt lgkmcnt(14)
    v_mfma_f32_32x32x16_bf16 v[64:79], a[16:19], a[0:3], v[64:79]
    ds_read_b64_tr_b16 a[56:57], v245 offset:3680
    ds_read_b64_tr_b16 a[58:59], v245 offset:4576
    v_accvgpr_read_b32 v231, a78
    v_mfma_f32_32x32x16_bf16 v[80:95], a[16:19], a[4:7], v[80:95]
    ds_read_b64_tr_b16 a[60:61], v245 offset:3712
    ds_read_b64_tr_b16 a[62:63], v245 offset:4608
    v_accvgpr_read_b32 v232, a79
    v_accvgpr_read_b32 v242, a80
    v_mfma_f32_32x32x16_bf16 v[96:111], a[20:23], a[0:3], v[96:111]
    ds_read_b64_tr_b16 a[64:65], v245 offset:3744
    ds_read_b64_tr_b16 a[66:67], v245 offset:4640
    v_add_f32 v225, v225, v242
    v_mfma_f32_32x32x16_bf16 v[112:127], a[20:23], a[4:7], v[112:127]
    ds_read_b64_tr_b16 a[68:69], v245 offset:3776
    ds_read_b64_tr_b16 a[70:71], v245 offset:4672
    v_accvgpr_read_b32 v242, a81
    v_add_f32 v226, v226, v242
    s_waitcnt lgkmcnt(14)
    v_mfma_f32_32x32x16_bf16 v[128:143], a[24:27], a[0:3], v[128:143]
    v_accvgpr_read_b32 v242, a82
    v_mfma_f32_32x32x16_bf16 v[144:159], a[24:27], a[4:7], v[144:159]
    v_add_f32 v227, v227, v242
    v_accvgpr_read_b32 v242, a83
    v_mfma_f32_32x32x16_bf16 v[160:175], a[28:31], a[0:3], v[160:175]
    v_add_f32 v228, v228, v242
    v_mfma_f32_32x32x16_bf16 v[176:191], a[28:31], a[4:7], v[176:191]
    v_accvgpr_read_b32 v242, a84
    v_add_f32 v229, v229, v242
    v_mfma_f32_32x32x16_bf16 v[192:207], a[32:35], a[0:3], v[192:207]
    v_accvgpr_read_b32 v242, a85
    v_mfma_f32_32x32x16_bf16 v[208:223], a[32:35], a[4:7], v[208:223]
    v_add_f32 v230, v230, v242
    v_accvgpr_read_b32 v242, a86
    s_waitcnt lgkmcnt(13)
    v_mfma_f32_32x32x16_bf16 v[0:15], a[44:47], a[36:39], v[0:15]
    v_add_f32 v231, v231, v242
    s_waitcnt lgkmcnt(12)
    v_mfma_f32_32x32x16_bf16 v[16:31], a[44:47], a[40:43], v[16:31]
    v_accvgpr_read_b32 v242, a87
    v_add_f32 v232, v232, v242
    s_waitcnt lgkmcnt(10)
    v_mfma_f32_32x32x16_bf16 v[32:47], a[48:51], a[36:39], v[32:47]
    s_waitcnt vmcnt(8) lgkmcnt(0)
    s_barrier
    ds_read_b128 a[0:3], v235 offset:0
    ds_read_b64_tr_b16 a[8:9], v246 offset:0
    v_add_f32 v225, v225, v229
    v_mfma_f32_32x32x16_bf16 v[48:63], a[48:51], a[40:43], v[48:63]
    ds_read_b64_tr_b16 a[10:11], v246 offset:896
    ds_read_b128 a[4:7], v235 offset:2048
    v_add_f32 v226, v226, v230
    v_add_f32 v227, v227, v231
    v_mfma_f32_32x32x16_bf16 v[64:79], a[52:55], a[36:39], v[64:79]
    ds_read_b64_tr_b16 a[12:13], v246 offset:32
    ds_read_b64_tr_b16 a[14:15], v246 offset:928
    v_add_f32 v228, v228, v232
    v_mfma_f32_32x32x16_bf16 v[80:95], a[52:55], a[40:43], v[80:95]
    ds_read_b64_tr_b16 a[16:17], v246 offset:64
    ds_read_b64_tr_b16 a[18:19], v246 offset:960
    v_add_f32 v225, v225, v226
    v_add_f32 v227, v227, v228
    v_mfma_f32_32x32x16_bf16 v[96:111], a[56:59], a[36:39], v[96:111]
    ds_read_b64_tr_b16 a[20:21], v246 offset:96
    ds_read_b64_tr_b16 a[22:23], v246 offset:992
    v_add_f32 v225, v225, v227
    v_mfma_f32_32x32x16_bf16 v[112:127], a[56:59], a[40:43], v[112:127]
    ds_read_b64_tr_b16 a[24:25], v246 offset:128
    ds_read_b64_tr_b16 a[26:27], v246 offset:1024
    v_mov_b32 v226, v225
    s_nop 1
    v_mfma_f32_32x32x16_bf16 v[128:143], a[60:63], a[36:39], v[128:143]
    ds_read_b64_tr_b16 a[28:29], v246 offset:160
    ds_read_b64_tr_b16 a[30:31], v246 offset:1056
    v_permlane32_swap_b32 v226, v225
    v_mfma_f32_32x32x16_bf16 v[144:159], a[60:63], a[40:43], v[144:159]
    ds_read_b64_tr_b16 a[32:33], v246 offset:192
    ds_read_b64_tr_b16 a[34:35], v246 offset:1088
    s_nop 1
    v_add_f32 v225, v225, v226
    v_mfma_f32_32x32x16_bf16 v[160:175], a[64:67], a[36:39], v[160:175]
    v_mov_b32 v226, 0x3727c5ac
    v_mfma_f32_32x32x16_bf16 v[176:191], a[64:67], a[40:43], v[176:191]
    v_fmac_f32 v226, 0x3a800000, v225
    v_rsq_f32 v227, v226
    v_mfma_f32_32x32x16_bf16 v[192:207], a[68:71], a[36:39], v[192:207]
    v_sqrt_f32 v240, v226
    v_mfma_f32_32x32x16_bf16 v[208:223], a[68:71], a[40:43], v[208:223]
    s_nop 0
    v_mul_f32 v238, 0xbfb8aa3b, v227
    s_waitcnt lgkmcnt(13)
    v_mfma_f32_32x32x16_bf16 v[0:15], a[8:11], a[0:3], v[0:15]
    ds_read_b128 a[36:39], v235 offset:1024
    ds_read_b64_tr_b16 a[44:45], v246 offset:3584
    v_accvgpr_read_b32 v225, a88
    s_waitcnt lgkmcnt(14)
    v_mfma_f32_32x32x16_bf16 v[16:31], a[8:11], a[4:7], v[16:31]
    ds_read_b64_tr_b16 a[46:47], v246 offset:4480
    ds_read_b128 a[40:43], v235 offset:3072
    v_accvgpr_read_b32 v226, a89
    v_accvgpr_read_b32 v227, a90
    s_waitcnt lgkmcnt(14)
    v_mfma_f32_32x32x16_bf16 v[32:47], a[12:15], a[0:3], v[32:47]
    ds_read_b64_tr_b16 a[48:49], v246 offset:3616
    ds_read_b64_tr_b16 a[50:51], v246 offset:4512
    v_accvgpr_read_b32 v228, a91
    v_mfma_f32_32x32x16_bf16 v[48:63], a[12:15], a[4:7], v[48:63]
    ds_read_b64_tr_b16 a[52:53], v246 offset:3648
    ds_read_b64_tr_b16 a[54:55], v246 offset:4544
    v_accvgpr_read_b32 v229, a92
    v_accvgpr_read_b32 v230, a93
    s_waitcnt lgkmcnt(14)
    v_mfma_f32_32x32x16_bf16 v[64:79], a[16:19], a[0:3], v[64:79]
    ds_read_b64_tr_b16 a[56:57], v246 offset:3680
    ds_read_b64_tr_b16 a[58:59], v246 offset:4576
    v_accvgpr_read_b32 v231, a94
    v_mfma_f32_32x32x16_bf16 v[80:95], a[16:19], a[4:7], v[80:95]
    ds_read_b64_tr_b16 a[60:61], v246 offset:3712
    ds_read_b64_tr_b16 a[62:63], v246 offset:4608
    v_accvgpr_read_b32 v232, a95
    v_accvgpr_read_b32 v242, a96
    v_mfma_f32_32x32x16_bf16 v[96:111], a[20:23], a[0:3], v[96:111]
    ds_read_b64_tr_b16 a[64:65], v246 offset:3744
    ds_read_b64_tr_b16 a[66:67], v246 offset:4640
    v_add_f32 v225, v225, v242
    v_mfma_f32_32x32x16_bf16 v[112:127], a[20:23], a[4:7], v[112:127]
    ds_read_b64_tr_b16 a[68:69], v246 offset:3776
    ds_read_b64_tr_b16 a[70:71], v246 offset:4672
    v_accvgpr_read_b32 v242, a97
    v_add_f32 v226, v226, v242
    s_waitcnt lgkmcnt(14)
    v_mfma_f32_32x32x16_bf16 v[128:143], a[24:27], a[0:3], v[128:143]
    v_accvgpr_read_b32 v242, a98
    v_mfma_f32_32x32x16_bf16 v[144:159], a[24:27], a[4:7], v[144:159]
    v_add_f32 v227, v227, v242
    v_accvgpr_read_b32 v242, a99
    v_mfma_f32_32x32x16_bf16 v[160:175], a[28:31], a[0:3], v[160:175]
    v_add_f32 v228, v228, v242
    v_mfma_f32_32x32x16_bf16 v[176:191], a[28:31], a[4:7], v[176:191]
    v_accvgpr_read_b32 v242, a100
    v_add_f32 v229, v229, v242
    v_mfma_f32_32x32x16_bf16 v[192:207], a[32:35], a[0:3], v[192:207]
    v_accvgpr_read_b32 v242, a101
    v_mfma_f32_32x32x16_bf16 v[208:223], a[32:35], a[4:7], v[208:223]
    v_add_f32 v230, v230, v242
    v_accvgpr_read_b32 v242, a102
    s_waitcnt lgkmcnt(13)
    v_mfma_f32_32x32x16_bf16 v[0:15], a[44:47], a[36:39], v[0:15]
    v_add_f32 v231, v231, v242
    s_waitcnt lgkmcnt(12)
    v_mfma_f32_32x32x16_bf16 v[16:31], a[44:47], a[40:43], v[16:31]
    v_accvgpr_read_b32 v242, a103
    v_add_f32 v232, v232, v242
    s_waitcnt lgkmcnt(10)
    v_mfma_f32_32x32x16_bf16 v[32:47], a[48:51], a[36:39], v[32:47]
    s_waitcnt vmcnt(0) lgkmcnt(0)
    s_barrier
    ds_read_b128 a[0:3], v236 offset:0
    ds_read_b64_tr_b16 a[8:9], v247 offset:0
    v_add_f32 v225, v225, v229
    v_mfma_f32_32x32x16_bf16 v[48:63], a[48:51], a[40:43], v[48:63]
    ds_read_b64_tr_b16 a[10:11], v247 offset:896
    ds_read_b128 a[4:7], v236 offset:2048
    v_add_f32 v226, v226, v230
    v_add_f32 v227, v227, v231
    v_mfma_f32_32x32x16_bf16 v[64:79], a[52:55], a[36:39], v[64:79]
    ds_read_b64_tr_b16 a[12:13], v247 offset:32
    ds_read_b64_tr_b16 a[14:15], v247 offset:928
    v_add_f32 v228, v228, v232
    v_mfma_f32_32x32x16_bf16 v[80:95], a[52:55], a[40:43], v[80:95]
    ds_read_b64_tr_b16 a[16:17], v247 offset:64
    ds_read_b64_tr_b16 a[18:19], v247 offset:960
    v_add_f32 v225, v225, v226
    v_add_f32 v227, v227, v228
    v_mfma_f32_32x32x16_bf16 v[96:111], a[56:59], a[36:39], v[96:111]
    ds_read_b64_tr_b16 a[20:21], v247 offset:96
    ds_read_b64_tr_b16 a[22:23], v247 offset:992
    v_add_f32 v225, v225, v227
    v_mfma_f32_32x32x16_bf16 v[112:127], a[56:59], a[40:43], v[112:127]
    ds_read_b64_tr_b16 a[24:25], v247 offset:128
    ds_read_b64_tr_b16 a[26:27], v247 offset:1024
    v_mov_b32 v226, v225
    s_nop 1
    v_mfma_f32_32x32x16_bf16 v[128:143], a[60:63], a[36:39], v[128:143]
    ds_read_b64_tr_b16 a[28:29], v247 offset:160
    ds_read_b64_tr_b16 a[30:31], v247 offset:1056
    v_permlane32_swap_b32 v226, v225
    v_mfma_f32_32x32x16_bf16 v[144:159], a[60:63], a[40:43], v[144:159]
    ds_read_b64_tr_b16 a[32:33], v247 offset:192
    ds_read_b64_tr_b16 a[34:35], v247 offset:1088
    s_nop 1
    v_add_f32 v225, v225, v226
    v_mfma_f32_32x32x16_bf16 v[160:175], a[64:67], a[36:39], v[160:175]
    v_mov_b32 v226, 0x3727c5ac
    v_mfma_f32_32x32x16_bf16 v[176:191], a[64:67], a[40:43], v[176:191]
    v_fmac_f32 v226, 0x3a800000, v225
    v_rsq_f32 v227, v226
    v_mfma_f32_32x32x16_bf16 v[192:207], a[68:71], a[36:39], v[192:207]
    v_sqrt_f32 v250, v226
    v_mfma_f32_32x32x16_bf16 v[208:223], a[68:71], a[40:43], v[208:223]
    s_nop 0
    v_mul_f32 v248, 0xbfb8aa3b, v227
    s_waitcnt lgkmcnt(13)
    v_mfma_f32_32x32x16_bf16 v[0:15], a[8:11], a[0:3], v[0:15]
    ds_read_b128 a[36:39], v236 offset:1024
    ds_read_b64_tr_b16 a[44:45], v247 offset:3584
    s_waitcnt lgkmcnt(14)
    v_mfma_f32_32x32x16_bf16 v[16:31], a[8:11], a[4:7], v[16:31]
    ds_read_b64_tr_b16 a[46:47], v247 offset:4480
    ds_read_b128 a[40:43], v236 offset:3072
    s_waitcnt lgkmcnt(14)
    v_mfma_f32_32x32x16_bf16 v[32:47], a[12:15], a[0:3], v[32:47]
    ds_read_b64_tr_b16 a[48:49], v247 offset:3616
    ds_read_b64_tr_b16 a[50:51], v247 offset:4512
    v_mfma_f32_32x32x16_bf16 v[48:63], a[12:15], a[4:7], v[48:63]
    ds_read_b64_tr_b16 a[52:53], v247 offset:3648
    ds_read_b64_tr_b16 a[54:55], v247 offset:4544
    s_waitcnt lgkmcnt(14)
    v_mfma_f32_32x32x16_bf16 v[64:79], a[16:19], a[0:3], v[64:79]
    ds_read_b64_tr_b16 a[56:57], v247 offset:3680
    ds_read_b64_tr_b16 a[58:59], v247 offset:4576
    v_mfma_f32_32x32x16_bf16 v[80:95], a[16:19], a[4:7], v[80:95]
    ds_read_b64_tr_b16 a[60:61], v247 offset:3712
    ds_read_b64_tr_b16 a[62:63], v247 offset:4608
    v_mfma_f32_32x32x16_bf16 v[96:111], a[20:23], a[0:3], v[96:111]
    ds_read_b64_tr_b16 a[64:65], v247 offset:3744
    ds_read_b64_tr_b16 a[66:67], v247 offset:4640
    v_mfma_f32_32x32x16_bf16 v[112:127], a[20:23], a[4:7], v[112:127]
    ds_read_b64_tr_b16 a[68:69], v247 offset:3776
    ds_read_b64_tr_b16 a[70:71], v247 offset:4672
    s_waitcnt lgkmcnt(14)
    v_mfma_f32_32x32x16_bf16 v[128:143], a[24:27], a[0:3], v[128:143]
    v_mfma_f32_32x32x16_bf16 v[144:159], a[24:27], a[4:7], v[144:159]
    v_mfma_f32_32x32x16_bf16 v[160:175], a[28:31], a[0:3], v[160:175]
    v_mfma_f32_32x32x16_bf16 v[176:191], a[28:31], a[4:7], v[176:191]
    v_mfma_f32_32x32x16_bf16 v[192:207], a[32:35], a[0:3], v[192:207]
    v_mfma_f32_32x32x16_bf16 v[208:223], a[32:35], a[4:7], v[208:223]
    s_waitcnt lgkmcnt(13)
    v_mfma_f32_32x32x16_bf16 v[0:15], a[44:47], a[36:39], v[0:15]
    s_waitcnt lgkmcnt(12)
    v_mfma_f32_32x32x16_bf16 v[16:31], a[44:47], a[40:43], v[16:31]
    s_waitcnt lgkmcnt(10)
    v_mfma_f32_32x32x16_bf16 v[32:47], a[48:51], a[36:39], v[32:47]
    v_mfma_f32_32x32x16_bf16 v[48:63], a[48:51], a[40:43], v[48:63]
    s_waitcnt lgkmcnt(8)
    v_mfma_f32_32x32x16_bf16 v[64:79], a[52:55], a[36:39], v[64:79]
    v_mfma_f32_32x32x16_bf16 v[80:95], a[52:55], a[40:43], v[80:95]
    s_waitcnt lgkmcnt(6)
    v_mfma_f32_32x32x16_bf16 v[96:111], a[56:59], a[36:39], v[96:111]
    v_mfma_f32_32x32x16_bf16 v[112:127], a[56:59], a[40:43], v[112:127]
    s_waitcnt lgkmcnt(4)
    v_mfma_f32_32x32x16_bf16 v[128:143], a[60:63], a[36:39], v[128:143]
    v_mfma_f32_32x32x16_bf16 v[144:159], a[60:63], a[40:43], v[144:159]
    s_waitcnt lgkmcnt(2)
    v_mfma_f32_32x32x16_bf16 v[160:175], a[64:67], a[36:39], v[160:175]
    v_mfma_f32_32x32x16_bf16 v[176:191], a[64:67], a[40:43], v[176:191]
    s_waitcnt lgkmcnt(0)
    v_mfma_f32_32x32x16_bf16 v[192:207], a[68:71], a[36:39], v[192:207]
    v_mfma_f32_32x32x16_bf16 v[208:223], a[68:71], a[40:43], v[208:223]
    s_waitcnt vmcnt(0) lgkmcnt(0)
    s_nop 14
    s_lshl_b32 s25, s16, 11
    s_add_u32 s25, s25, 16384
    s_mov_b32 s27, 0
    s_mov_b32 s20, s25
    s_mov_b32 s21, 8192
    s_mov_b32 s29, 128
    s_barrier
    s_mov_b32 m0, s20
    s_nop 0
    buffer_load_dwordx4 v252, s[12:15], s27 offen lds
    s_add_u32 m0, s20, 1024
    s_add_u32 s20, s20, s21
    buffer_load_dwordx4 v253, s[12:15], s27 offen lds
    s_add_u32 s27, s27, s29
    s_xor_b32 s21, s21, 16384
    s_xor_b32 s29, s29, 130816
    s_add_u32 s8, s4, 29360128
    s_addc_u32 s9, s5, 0
    s_and_b32 s9, s9, 0xffff
    s_mov_b32 s10, 14680064
    s_mov_b32 s11, 0x00020000
    s_lshl_b32 s22, s17, 3
    s_lshl_b32 s23, s16, 1
    s_add_u32 s22, s22, s23
    s_mul_i32 s22, s22, 224
    s_mul_i32 s23, s18, 7
    s_add_u32 s22, s22, s23
    s_lshl_b32 s22, s22, 10
    s_add_u32 s23, s22, 229376
    v_lshlrev_b32 v225, 4, v224
    s_mov_b32 s28, 0
epi_mlp_kernel_10:
    s_set_gpr_idx_on s28, 0x1
    s_nop 0
    v_pk_mul_f32 v[226:227], v[0:1], v[238:239] op_sel_hi:[1,0]
    v_pk_mul_f32 v[228:229], v[2:3], v[238:239] op_sel_hi:[1,0]
    v_pk_mul_f32 v[230:231], v[4:5], v[238:239] op_sel_hi:[1,0]
    v_pk_mul_f32 v[232:233], v[6:7], v[238:239] op_sel_hi:[1,0]
    s_set_gpr_idx_off
    v_exp_f32 v226, v226
    v_exp_f32 v227, v227
    v_exp_f32 v228, v228
    v_exp_f32 v229, v229
    v_exp_f32 v230, v230
    v_exp_f32 v231, v231
    v_exp_f32 v232, v232
    v_exp_f32 v233, v233
    v_pk_fma_f32 v[226:227], v[226:227], v[240:241], v[240:241] op_sel_hi:[1,0,0]
    v_pk_fma_f32 v[228:229], v[228:229], v[240:241], v[240:241] op_sel_hi:[1,0,0]
    v_pk_fma_f32 v[230:231], v[230:231], v[240:241], v[240:241] op_sel_hi:[1,0,0]
    v_pk_fma_f32 v[232:233], v[232:233], v[240:241], v[240:241] op_sel_hi:[1,0,0]
    s_mov_b32 m0, s20
    s_nop 0
    buffer_load_dwordx4 v252, s[12:15], s27 offen lds
    v_rcp_f32 v226, v226
    v_rcp_f32 v227, v227
    v_rcp_f32 v228, v228
    v_rcp_f32 v229, v229
    v_rcp_f32 v230, v230
    v_rcp_f32 v231, v231
    v_rcp_f32 v232, v232
    v_rcp_f32 v233, v233
    s_set_gpr_idx_on s28, 0x1
    s_nop 0
    v_pk_mul_f32 v[226:227], v[8:9], v[226:227]
    v_pk_mul_f32 v[228:229], v[10:11], v[228:229]
    v_pk_mul_f32 v[230:231], v[12:13], v[230:231]
    v_pk_mul_f32 v[232:233], v[14:15], v[232:233]
    s_set_gpr_idx_off
    v_cvt_pk_bf16_f32 v234, v226, v227
    v_cvt_pk_bf16_f32 v235, v228, v229
    v_cvt_pk_bf16_f32 v236, v230, v231
    v_cvt_pk_bf16_f32 v237, v232, v233
    buffer_store_dwordx4 v[234:237], v225, s[8:11], s22 offen sc1
    s_add_u32 s22, s22, 1024
    s_set_gpr_idx_on s28, 0x1
    s_nop 0
    v_pk_mul_f32 v[226:227], v[16:17], v[248:249] op_sel_hi:[1,0]
    v_pk_mul_f32 v[228:229], v[18:19], v[248:249] op_sel_hi:[1,0]
    v_pk_mul_f32 v[230:231], v[20:21], v[248:249] op_sel_hi:[1,0]
    v_pk_mul_f32 v[232:233], v[22:23], v[248:249] op_sel_hi:[1,0]
    s_set_gpr_idx_off
    v_exp_f32 v226, v226
    v_exp_f32 v227, v227
    v_exp_f32 v228, v228
    v_exp_f32 v229, v229
    v_exp_f32 v230, v230
    v_exp_f32 v231, v231
    v_exp_f32 v232, v232
    v_exp_f32 v233, v233
    v_pk_fma_f32 v[226:227], v[226:227], v[250:251], v[250:251] op_sel_hi:[1,0,0]
    v_pk_fma_f32 v[228:229], v[228:229], v[250:251], v[250:251] op_sel_hi:[1,0,0]
    v_pk_fma_f32 v[230:231], v[230:231], v[250:251], v[250:251] op_sel_hi:[1,0,0]
    v_pk_fma_f32 v[232:233], v[232:233], v[250:251], v[250:251] op_sel_hi:[1,0,0]
    s_add_u32 m0, s20, 1024
    s_add_u32 s20, s20, s21
    buffer_load_dwordx4 v253, s[12:15], s27 offen lds
    s_add_u32 s27, s27, s29
    s_xor_b32 s21, s21, 16384
    s_xor_b32 s29, s29, 130816
    v_rcp_f32 v226, v226
    v_rcp_f32 v227, v227
    v_rcp_f32 v228, v228
    v_rcp_f32 v229, v229
    v_rcp_f32 v230, v230
    v_rcp_f32 v231, v231
    v_rcp_f32 v232, v232
    v_rcp_f32 v233, v233
    s_set_gpr_idx_on s28, 0x1
    s_nop 0
    v_pk_mul_f32 v[226:227], v[24:25], v[226:227]
    v_pk_mul_f32 v[228:229], v[26:27], v[228:229]
    v_pk_mul_f32 v[230:231], v[28:29], v[230:231]
    v_pk_mul_f32 v[232:233], v[30:31], v[232:233]
    s_set_gpr_idx_off
    v_cvt_pk_bf16_f32 v244, v226, v227
    v_cvt_pk_bf16_f32 v245, v228, v229
    v_cvt_pk_bf16_f32 v246, v230, v231
    v_cvt_pk_bf16_f32 v247, v232, v233
    buffer_store_dwordx4 v[244:247], v225, s[8:11], s23 offen sc1
    s_add_u32 s23, s23, 1024
    s_add_u32 s28, s28, 32
    s_cmp_lg_u32 s28, 224
    s_cbranch_scc1 epi_mlp_kernel_10
    v_lshlrev_b32 v187, 7, v224
    v_mov_b32 v250, 1
    v_accvgpr_read_b32 v176, a104
    v_accvgpr_read_b32 v190, a105
    v_accvgpr_read_b32 v194, a106
    v_accvgpr_read_b32 v181, a107
    s_lshl_b32 s24, s16, 12
    s_mov_b32 s26, 0
    v_xor_b32 v195, 64, v194
    v_add_u32 v182, 0x10000, v181
    v_add_u32 v191, 65536, v190
    v_add_u32 v196, 65536, v194
    v_add_u32 v197, 65536, v195
    v_add_u32 v192, 131072, v190
    v_add_u32 v198, 131072, v194
    v_add_u32 v199, 131072, v195
    s_add_u32 s40, s4, 25165824
    s_addc_u32 s41, s5, 0
    s_and_b32 s41, s41, 0xffff
    s_mov_b32 s42, 22020096
    s_mov_b32 s43, 0x00020000
    v_and_b32 v189, 31, v224
    v_lshlrev_b32 v189, 2, v189
    s_lshr_b32 s7, s58, 16
    s_lshl_b32 s7, s7, 7
    s_add_u32 s7, s7, 20979712
    s_waitcnt vmcnt(0)
    v_lshlrev_b32 v188, 2, v224
    s_mov_b64 exec, 0xff
    buffer_store_dword v250, v187, s[52:55], s46 offen sc1
    s_mov_b64 exec, 0xffff
    s_mov_b32 s50, 0x40000
poll_mlp_kernel_11:
    buffer_load_dword v251, v188, s[52:55], s47 offen sc1
    s_waitcnt vmcnt(0)
    v_cmp_eq_u32 vcc, 0, v251
    s_and_b64 exec, exec, vcc
    s_cbranch_scc0 rdy_mlp_kernel_12
    s_sub_u32 s50, s50, 1
    s_cmp_lg_u32 s50, 0
    s_cbranch_scc1 poll_mlp_kernel_11
rdy_mlp_kernel_12:
    s_mov_b64 exec, -1
    s_add_u32 m0, s24, 0
    s_nop 0
    buffer_load_dwordx4 v176, s[8:11], s26 offen offset:0 lds
    buffer_load_dwordx4 v176, s[8:11], s26 offen offset:1024 lds
    buffer_load_dwordx4 v176, s[8:11], s26 offen offset:2048 lds
    buffer_load_dwordx4 v176, s[8:11], s26 offen offset:3072 lds
    s_add_u32 s26, s26, 4096
    s_add_u32 m0, s24, 32768
    s_nop 0
    buffer_load_dwordx4 v176, s[8:11], s26 offen offset:0 lds
    buffer_load_dwordx4 v176, s[8:11], s26 offen offset:1024 lds
    buffer_load_dwordx4 v176, s[8:11], s26 offen offset:2048 lds
    buffer_load_dwordx4 v176, s[8:11], s26 offen offset:3072 lds
    s_add_u32 s26, s26, 4096
    s_add_u32 m0, s24, 65536
    s_nop 0
    buffer_load_dwordx4 v176, s[8:11], s26 offen offset:0 lds
    buffer_load_dwordx4 v176, s[8:11], s26 offen offset:1024 lds
    buffer_load_dwordx4 v176, s[8:11], s26 offen offset:2048 lds
    buffer_load_dwordx4 v176, s[8:11], s26 offen offset:3072 lds
    s_add_u32 s26, s26, 4096
    s_add_u32 m0, s24, 98304
    s_nop 0
    buffer_load_dwordx4 v176, s[8:11], s26 offen offset:0 lds
    buffer_load_dwordx4 v176, s[8:11], s26 offen offset:1024 lds
    buffer_load_dwordx4 v176, s[8:11], s26 offen offset:2048 lds
    buffer_load_dwordx4 v176, s[8:11], s26 offen offset:3072 lds
    s_add_u32 s26, s26, 4096
    s_add_u32 m0, s24, 131072
    s_nop 0
    buffer_load_dwordx4 v176, s[8:11], s26 offen offset:0 lds
    buffer_load_dwordx4 v176, s[8:11], s26 offen offset:1024 lds
    buffer_load_dwordx4 v176, s[8:11], s26 offen offset:2048 lds
    buffer_load_dwordx4 v176, s[8:11], s26 offen offset:3072 lds
    s_waitcnt vmcnt(16)
    s_barrier
    ds_read_b128 v[64:67], v190 offset:0
    ds_read_b64_tr_b16 v[72:73], v194 offset:16384
    ds_read_b64_tr_b16 v[74:75], v194 offset:16896
    ds_read_b128 v[68:71], v190 offset:4096
    ds_read_b64_tr_b16 v[76:77], v195 offset:16384
    ds_read_b64_tr_b16 v[78:79], v195 offset:16896
    ds_read_b128 v[80:83], v190 offset:1024
    ds_read_b64_tr_b16 v[88:89], v194 offset:18432
    ds_read_b64_tr_b16 v[90:91], v194 offset:18944
    ds_read_b128 v[84:87], v190 offset:5120
    ds_read_b64_tr_b16 v[92:93], v195 offset:18432
    ds_read_b64_tr_b16 v[94:95], v195 offset:18944
    s_waitcnt lgkmcnt(9)
    v_mfma_f32_32x32x16_bf16 v[0:15], v[72:75], v[64:67], 0
    ds_read_b128 v[96:99], v190 offset:2048
    ds_read_b64_tr_b16 v[104:105], v194 offset:20480
    s_waitcnt lgkmcnt(10)
    v_mfma_f32_32x32x16_bf16 v[16:31], v[72:75], v[68:71], 0
    ds_read_b64_tr_b16 v[106:107], v194 offset:20992
    ds_read_b128 v[100:103], v190 offset:6144
    s_waitcnt lgkmcnt(10)
    v_mfma_f32_32x32x16_bf16 v[32:47], v[76:79], v[64:67], 0
    ds_read_b64_tr_b16 v[108:109], v195 offset:20480
    ds_read_b64_tr_b16 v[110:111], v195 offset:20992
    s_add_u32 m0, s25, 131072
    s_nop 0
    buffer_load_dwordx4 v252, s[12:15], s27 offen lds
    v_mfma_f32_32x32x16_bf16 v[48:63], v[76:79], v[68:71], 0
    ds_read_b128 v[112:115], v190 offset:3072
    ds_read_b64_tr_b16 v[120:121], v194 offset:22528
    s_waitcnt lgkmcnt(11)
    v_mfma_f32_32x32x16_bf16 v[0:15], v[88:91], v[80:83], v[0:15]
    ds_read_b64_tr_b16 v[122:123], v194 offset:23040
    ds_read_b128 v[116:119], v190 offset:7168
    s_add_u32 m0, s25, 132096
    s_nop 0
    buffer_load_dwordx4 v253, s[12:15], s27 offen lds
    s_waitcnt lgkmcnt(12)
    v_mfma_f32_32x32x16_bf16 v[16:31], v[88:91], v[84:87], v[16:31]
    ds_read_b64_tr_b16 v[124:125], v195 offset:22528
    ds_read_b64_tr_b16 v[126:127], v195 offset:23040
    s_waitcnt lgkmcnt(12)
    v_mfma_f32_32x32x16_bf16 v[32:47], v[92:95], v[80:83], v[32:47]
    s_add_u32 m0, s25, 139264
    s_nop 0
    buffer_load_dwordx4 v254, s[12:15], s27 offen lds
    v_mfma_f32_32x32x16_bf16 v[48:63], v[92:95], v[84:87], v[48:63]
    s_add_u32 m0, s25, 140288
    s_nop 0
    buffer_load_dwordx4 v255, s[12:15], s27 offen lds
    s_add_u32 s26, s26, 4096
    s_add_u32 s27, s27, 131072
    s_waitcnt lgkmcnt(9)
    v_mfma_f32_32x32x16_bf16 v[0:15], v[104:107], v[96:99], v[0:15]
    s_waitcnt lgkmcnt(8)
    v_mfma_f32_32x32x16_bf16 v[16:31], v[104:107], v[100:103], v[16:31]
    s_waitcnt vmcnt(16) lgkmcnt(0)
    s_barrier
    ds_read_b128 v[64:67], v190 offset:32768
    ds_read_b64_tr_b16 v[72:73], v194 offset:49152
    v_mfma_f32_32x32x16_bf16 v[32:47], v[108:111], v[96:99], v[32:47]
    ds_read_b64_tr_b16 v[74:75], v194 offset:49664
    ds_read_b128 v[68:71], v190 offset:36864
    s_add_u32 m0, s24, 0
    s_nop 0
    buffer_load_dwordx4 v176, s[8:11], s26 offen offset:0 lds
    v_mfma_f32_32x32x16_bf16 v[48:63], v[108:111], v[100:103], v[48:63]
    ds_read_b64_tr_b16 v[76:77], v195 offset:49152
    ds_read_b64_tr_b16 v[78:79], v195 offset:49664
    v_mfma_f32_32x32x16_bf16 v[0:15], v[120:123], v[112:115], v[0:15]
    ds_read_b128 v[80:83], v190 offset:33792
    ds_read_b64_tr_b16 v[88:89], v194 offset:51200
    buffer_load_dwordx4 v176, s[8:11], s26 offen offset:1024 lds
    v_mfma_f32_32x32x16_bf16 v[16:31], v[120:123], v[116:119], v[16:31]
    ds_read_b64_tr_b16 v[90:91], v194 offset:51712
    ds_read_b128 v[84:87], v190 offset:37888
    v_mfma_f32_32x32x16_bf16 v[32:47], v[124:127], v[112:115], v[32:47]
    ds_read_b64_tr_b16 v[92:93], v195 offset:51200
    ds_read_b64_tr_b16 v[94:95], v195 offset:51712
    buffer_load_dwordx4 v176, s[8:11], s26 offen offset:2048 lds
    v_mfma_f32_32x32x16_bf16 v[48:63], v[124:127], v[116:119], v[48:63]
    buffer_load_dwordx4 v176, s[8:11], s26 offen offset:3072 lds
    s_waitcnt lgkmcnt(9)
    v_mfma_f32_32x32x16_bf16 v[0:15], v[72:75], v[64:67], v[0:15]
    ds_read_b128 v[96:99], v190 offset:34816
    ds_read_b64_tr_b16 v[104:105], v194 offset:53248
    s_waitcnt lgkmcnt(10)
    v_mfma_f32_32x32x16_bf16 v[16:31], v[72:75], v[68:71], v[16:31]
    ds_read_b64_tr_b16 v[106:107], v194 offset:53760
    ds_read_b128 v[100:103], v190 offset:38912
    s_waitcnt lgkmcnt(10)
    v_mfma_f32_32x32x16_bf16 v[32:47], v[76:79], v[64:67], v[32:47]
    ds_read_b64_tr_b16 v[108:109], v195 offset:53248
    ds_read_b64_tr_b16 v[110:111], v195 offset:53760
    s_add_u32 m0, s25, 0
    s_nop 0
    buffer_load_dwordx4 v252, s[12:15], s27 offen lds
    v_mfma_f32_32x32x16_bf16 v[48:63], v[76:79], v[68:71], v[48:63]
    ds_read_b128 v[112:115], v190 offset:35840
    ds_read_b64_tr_b16 v[120:121], v194 offset:55296
    s_waitcnt lgkmcnt(11)
    v_mfma_f32_32x32x16_bf16 v[0:15], v[88:91], v[80:83], v[0:15]
    ds_read_b64_tr_b16 v[122:123], v194 offset:55808
    ds_read_b128 v[116:119], v190 offset:39936
    s_add_u32 m0, s25, 1024
    s_nop 0
    buffer_load_dwordx4 v253, s[12:15], s27 offen lds
    s_waitcnt lgkmcnt(12)
    v_mfma_f32_32x32x16_bf16 v[16:31], v[88:91], v[84:87], v[16:31]
    ds_read_b64_tr_b16 v[124:125], v195 offset:55296
    ds_read_b64_tr_b16 v[126:127], v195 offset:55808
    s_waitcnt lgkmcnt(12)
    v_mfma_f32_32x32x16_bf16 v[32:47], v[92:95], v[80:83], v[32:47]
    s_add_u32 m0, s25, 8192
    s_nop 0
    buffer_load_dwordx4 v254, s[12:15], s27 offen lds
    v_mfma_f32_32x32x16_bf16 v[48:63], v[92:95], v[84:87], v[48:63]
    s_add_u32 m0, s25, 9216
    s_nop 0
    buffer_load_dwordx4 v255, s[12:15], s27 offen lds
    s_add_u32 s26, s26, 4096
    s_add_u32 s27, s27, 131072
    s_waitcnt lgkmcnt(9)
    v_mfma_f32_32x32x16_bf16 v[0:15], v[104:107], v[96:99], v[0:15]
    s_waitcnt lgkmcnt(8)
    v_mfma_f32_32x32x16_bf16 v[16:31], v[104:107], v[100:103], v[16:31]
    s_waitcnt vmcnt(20) lgkmcnt(0)
    s_barrier
    ds_read_b128 v[64:67], v191 offset:0
    ds_read_b64_tr_b16 v[72:73], v196 offset:16384
    v_mfma_f32_32x32x16_bf16 v[32:47], v[108:111], v[96:99], v[32:47]
    ds_read_b64_tr_b16 v[74:75], v196 offset:16896
    ds_read_b128 v[68:71], v191 offset:4096
    s_add_u32 m0, s24, 32768
    s_nop 0
    buffer_load_dwordx4 v176, s[8:11], s26 offen offset:0 lds
    v_mfma_f32_32x32x16_bf16 v[48:63], v[108:111], v[100:103], v[48:63]
    ds_read_b64_tr_b16 v[76:77], v197 offset:16384
    ds_read_b64_tr_b16 v[78:79], v197 offset:16896
    v_mfma_f32_32x32x16_bf16 v[0:15], v[120:123], v[112:115], v[0:15]
    ds_read_b128 v[80:83], v191 offset:1024
    ds_read_b64_tr_b16 v[88:89], v196 offset:18432
    buffer_load_dwordx4 v176, s[8:11], s26 offen offset:1024 lds
    v_mfma_f32_32x32x16_bf16 v[16:31], v[120:123], v[116:119], v[16:31]
    ds_read_b64_tr_b16 v[90:91], v196 offset:18944
    ds_read_b128 v[84:87], v191 offset:5120
    v_mfma_f32_32x32x16_bf16 v[32:47], v[124:127], v[112:115], v[32:47]
    ds_read_b64_tr_b16 v[92:93], v197 offset:18432
    ds_read_b64_tr_b16 v[94:95], v197 offset:18944
    buffer_load_dwordx4 v176, s[8:11], s26 offen offset:2048 lds
    v_mfma_f32_32x32x16_bf16 v[48:63], v[124:127], v[116:119], v[48:63]
    buffer_load_dwordx4 v176, s[8:11], s26 offen offset:3072 lds
    s_waitcnt lgkmcnt(9)
    v_mfma_f32_32x32x16_bf16 v[0:15], v[72:75], v[64:67], v[0:15]
    ds_read_b128 v[96:99], v191 offset:2048
    ds_read_b64_tr_b16 v[104:105], v196 offset:20480
    s_waitcnt lgkmcnt(10)
    v_mfma_f32_32x32x16_bf16 v[16:31], v[72:75], v[68:71], v[16:31]
    ds_read_b64_tr_b16 v[106:107], v196 offset:20992
    ds_read_b128 v[100:103], v191 offset:6144
    s_waitcnt lgkmcnt(10)
    v_mfma_f32_32x32x16_bf16 v[32:47], v[76:79], v[64:67], v[32:47]
    ds_read_b64_tr_b16 v[108:109], v197 offset:20480
    ds_read_b64_tr_b16 v[110:111], v197 offset:20992
    s_add_u32 m0, s25, 32768
    s_nop 0
    buffer_load_dwordx4 v252, s[12:15], s27 offen lds
    v_mfma_f32_32x32x16_bf16 v[48:63], v[76:79], v[68:71], v[48:63]
    ds_read_b128 v[112:115], v191 offset:3072
    ds_read_b64_tr_b16 v[120:121], v196 offset:22528
    s_waitcnt lgkmcnt(11)
    v_mfma_f32_32x32x16_bf16 v[0:15], v[88:91], v[80:83], v[0:15]
    ds_read_b64_tr_b16 v[122:123], v196 offset:23040
    ds_read_b128 v[116:119], v191 offset:7168
    s_add_u32 m0, s25, 33792
    s_nop 0
    buffer_load_dwordx4 v253, s[12:15], s27 offen lds
    s_waitcnt lgkmcnt(12)
    v_mfma_f32_32x32x16_bf16 v[16:31], v[88:91], v[84:87], v[16:31]
    ds_read_b64_tr_b16 v[124:125], v197 offset:22528
    ds_read_b64_tr_b16 v[126:127], v197 offset:23040
    s_waitcnt lgkmcnt(12)
    v_mfma_f32_32x32x16_bf16 v[32:47], v[92:95], v[80:83], v[32:47]
    s_add_u32 m0, s25, 40960
    s_nop 0
    buffer_load_dwordx4 v254, s[12:15], s27 offen lds
    v_mfma_f32_32x32x16_bf16 v[48:63], v[92:95], v[84:87], v[48:63]
    s_add_u32 m0, s25, 41984
    s_nop 0
    buffer_load_dwordx4 v255, s[12:15], s27 offen lds
    s_add_u32 s26, s26, 4096
    s_add_u32 s27, s27, 131072
    s_waitcnt lgkmcnt(9)
    v_mfma_f32_32x32x16_bf16 v[0:15], v[104:107], v[96:99], v[0:15]
    s_waitcnt lgkmcnt(8)
    v_mfma_f32_32x32x16_bf16 v[16:31], v[104:107], v[100:103], v[16:31]
    s_waitcnt vmcnt(24) lgkmcnt(0)
    s_barrier
    ds_read_b128 v[64:67], v191 offset:32768
    ds_read_b64_tr_b16 v[72:73], v196 offset:49152
    v_mfma_f32_32x32x16_bf16 v[32:47], v[108:111], v[96:99], v[32:47]
    ds_read_b64_tr_b16 v[74:75], v196 offset:49664
    ds_read_b128 v[68:71], v191 offset:36864
    s_add_u32 m0, s24, 65536
    s_nop 0
    buffer_load_dwordx4 v176, s[8:11], s26 offen offset:0 lds
    v_mfma_f32_32x32x16_bf16 v[48:63], v[108:111], v[100:103], v[48:63]
    ds_read_b64_tr_b16 v[76:77], v197 offset:49152
    ds_read_b64_tr_b16 v[78:79], v197 offset:49664
    v_mfma_f32_32x32x16_bf16 v[0:15], v[120:123], v[112:115], v[0:15]
    ds_read_b128 v[80:83], v191 offset:33792
    ds_read_b64_tr_b16 v[88:89], v196 offset:51200
    buffer_load_dwordx4 v176, s[8:11], s26 offen offset:1024 lds
    v_mfma_f32_32x32x16_bf16 v[16:31], v[120:123], v[116:119], v[16:31]
    ds_read_b64_tr_b16 v[90:91], v196 offset:51712
    ds_read_b128 v[84:87], v191 offset:37888
    v_mfma_f32_32x32x16_bf16 v[32:47], v[124:127], v[112:115], v[32:47]
    ds_read_b64_tr_b16 v[92:93], v197 offset:51200
    ds_read_b64_tr_b16 v[94:95], v197 offset:51712
    buffer_load_dwordx4 v176, s[8:11], s26 offen offset:2048 lds
    v_mfma_f32_32x32x16_bf16 v[48:63], v[124:127], v[116:119], v[48:63]
    buffer_load_dwordx4 v176, s[8:11], s26 offen offset:3072 lds
    s_mov_b32 s28, 4
loop_mlp_kernel_13:
    s_waitcnt lgkmcnt(9)
    v_mfma_f32_32x32x16_bf16 v[0:15], v[72:75], v[64:67], v[0:15]
    ds_read_b128 v[96:99], v191 offset:34816
    ds_read_b64_tr_b16 v[104:105], v196 offset:53248
    s_waitcnt lgkmcnt(10)
    v_mfma_f32_32x32x16_bf16 v[16:31], v[72:75], v[68:71], v[16:31]
    ds_read_b64_tr_b16 v[106:107], v196 offset:53760
    ds_read_b128 v[100:103], v191 offset:38912
    s_waitcnt lgkmcnt(10)
    v_mfma_f32_32x32x16_bf16 v[32:47], v[76:79], v[64:67], v[32:47]
    ds_read_b64_tr_b16 v[108:109], v197 offset:53248
    ds_read_b64_tr_b16 v[110:111], v197 offset:53760
    s_add_u32 m0, s25, 65536
    s_nop 0
    buffer_load_dwordx4 v252, s[12:15], s27 offen lds
    v_mfma_f32_32x32x16_bf16 v[48:63], v[76:79], v[68:71], v[48:63]
    ds_read_b128 v[112:115], v191 offset:35840
    ds_read_b64_tr_b16 v[120:121], v196 offset:55296
    s_waitcnt lgkmcnt(11)
    v_mfma_f32_32x32x16_bf16 v[0:15], v[88:91], v[80:83], v[0:15]
    ds_read_b64_tr_b16 v[122:123], v196 offset:55808
    ds_read_b128 v[116:119], v191 offset:39936
    s_add_u32 m0, s25, 66560
    s_nop 0
    buffer_load_dwordx4 v253, s[12:15], s27 offen lds
    s_waitcnt lgkmcnt(12)
    v_mfma_f32_32x32x16_bf16 v[16:31], v[88:91], v[84:87], v[16:31]
    ds_read_b64_tr_b16 v[124:125], v197 offset:55296
    ds_read_b64_tr_b16 v[126:127], v197 offset:55808
    s_waitcnt lgkmcnt(12)
    v_mfma_f32_32x32x16_bf16 v[32:47], v[92:95], v[80:83], v[32:47]
    s_add_u32 m0, s25, 73728
    s_nop 0
    buffer_load_dwordx4 v254, s[12:15], s27 offen lds
    v_mfma_f32_32x32x16_bf16 v[48:63], v[92:95], v[84:87], v[48:63]
    s_add_u32 m0, s25, 74752
    s_nop 0
    buffer_load_dwordx4 v255, s[12:15], s27 offen lds
    s_add_u32 s26, s26, 4096
    s_add_u32 s27, s27, 131072
    s_waitcnt lgkmcnt(9)
    v_mfma_f32_32x32x16_bf16 v[0:15], v[104:107], v[96:99], v[0:15]
    s_waitcnt lgkmcnt(8)
    v_mfma_f32_32x32x16_bf16 v[16:31], v[104:107], v[100:103], v[16:31]
    s_waitcnt vmcnt(24) lgkmcnt(0)
    s_barrier
    ds_read_b128 v[64:67], v192 offset:0
    ds_read_b64_tr_b16 v[72:73], v198 offset:16384
    v_mfma_f32_32x32x16_bf16 v[32:47], v[108:111], v[96:99], v[32:47]
    ds_read_b64_tr_b16 v[74:75], v198 offset:16896
    ds_read_b128 v[68:71], v192 offset:4096
    s_add_u32 m0, s24, 98304
    s_nop 0
    buffer_load_dwordx4 v176, s[8:11], s26 offen offset:0 lds
    v_mfma_f32_32x32x16_bf16 v[48:63], v[108:111], v[100:103], v[48:63]
    ds_read_b64_tr_b16 v[76:77], v199 offset:16384
    ds_read_b64_tr_b16 v[78:79], v199 offset:16896
    v_mfma_f32_32x32x16_bf16 v[0:15], v[120:123], v[112:115], v[0:15]
    ds_read_b128 v[80:83], v192 offset:1024
    ds_read_b64_tr_b16 v[88:89], v198 offset:18432
    buffer_load_dwordx4 v176, s[8:11], s26 offen offset:1024 lds
    v_mfma_f32_32x32x16_bf16 v[16:31], v[120:123], v[116:119], v[16:31]
    ds_read_b64_tr_b16 v[90:91], v198 offset:18944
    ds_read_b128 v[84:87], v192 offset:5120
    v_mfma_f32_32x32x16_bf16 v[32:47], v[124:127], v[112:115], v[32:47]
    ds_read_b64_tr_b16 v[92:93], v199 offset:18432
    ds_read_b64_tr_b16 v[94:95], v199 offset:18944
    buffer_load_dwordx4 v176, s[8:11], s26 offen offset:2048 lds
    v_mfma_f32_32x32x16_bf16 v[48:63], v[124:127], v[116:119], v[48:63]
    buffer_load_dwordx4 v176, s[8:11], s26 offen offset:3072 lds
    s_waitcnt lgkmcnt(9)
    v_mfma_f32_32x32x16_bf16 v[0:15], v[72:75], v[64:67], v[0:15]
    ds_read_b128 v[96:99], v192 offset:2048
    ds_read_b64_tr_b16 v[104:105], v198 offset:20480
    s_waitcnt lgkmcnt(10)
    v_mfma_f32_32x32x16_bf16 v[16:31], v[72:75], v[68:71], v[16:31]
    ds_read_b64_tr_b16 v[106:107], v198 offset:20992
    ds_read_b128 v[100:103], v192 offset:6144
    s_waitcnt lgkmcnt(10)
    v_mfma_f32_32x32x16_bf16 v[32:47], v[76:79], v[64:67], v[32:47]
    ds_read_b64_tr_b16 v[108:109], v199 offset:20480
    ds_read_b64_tr_b16 v[110:111], v199 offset:20992
    s_add_u32 m0, s25, 98304
    s_nop 0
    buffer_load_dwordx4 v252, s[12:15], s27 offen lds
    v_mfma_f32_32x32x16_bf16 v[48:63], v[76:79], v[68:71], v[48:63]
    ds_read_b128 v[112:115], v192 offset:3072
    ds_read_b64_tr_b16 v[120:121], v198 offset:22528
    s_waitcnt lgkmcnt(11)
    v_mfma_f32_32x32x16_bf16 v[0:15], v[88:91], v[80:83], v[0:15]
    ds_read_b64_tr_b16 v[122:123], v198 offset:23040
    ds_read_b128 v[116:119], v192 offset:7168
    s_add_u32 m0, s25, 99328
    s_nop 0
    buffer_load_dwordx4 v253, s[12:15], s27 offen lds
    s_waitcnt lgkmcnt(12)
    v_mfma_f32_32x32x16_bf16 v[16:31], v[88:91], v[84:87], v[16:31]
    ds_read_b64_tr_b16 v[124:125], v199 offset:22528
    ds_read_b64_tr_b16 v[126:127], v199 offset:23040
    s_waitcnt lgkmcnt(12)
    v_mfma_f32_32x32x16_bf16 v[32:47], v[92:95], v[80:83], v[32:47]
    s_add_u32 m0, s25, 106496
    s_nop 0
    buffer_load_dwordx4 v254, s[12:15], s27 offen lds
    v_mfma_f32_32x32x16_bf16 v[48:63], v[92:95], v[84:87], v[48:63]
    s_add_u32 m0, s25, 107520
    s_nop 0
    buffer_load_dwordx4 v255, s[12:15], s27 offen lds
    s_add_u32 s26, s26, 4096
    s_add_u32 s27, s27, 131072
    s_waitcnt lgkmcnt(9)
    v_mfma_f32_32x32x16_bf16 v[0:15], v[104:107], v[96:99], v[0:15]
    s_waitcnt lgkmcnt(8)
    v_mfma_f32_32x32x16_bf16 v[16:31], v[104:107], v[100:103], v[16:31]
    s_waitcnt vmcnt(24) lgkmcnt(0)
    s_barrier
    ds_read_b128 v[64:67], v190 offset:0
    ds_read_b64_tr_b16 v[72:73], v194 offset:16384
    v_mfma_f32_32x32x16_bf16 v[32:47], v[108:111], v[96:99], v[32:47]
    ds_read_b64_tr_b16 v[74:75], v194 offset:16896
    ds_read_b128 v[68:71], v190 offset:4096
    s_add_u32 m0, s24, 131072
    s_nop 0
    buffer_load_dwordx4 v176, s[8:11], s26 offen offset:0 lds
    v_mfma_f32_32x32x16_bf16 v[48:63], v[108:111], v[100:103], v[48:63]
    ds_read_b64_tr_b16 v[76:77], v195 offset:16384
    ds_read_b64_tr_b16 v[78:79], v195 offset:16896
    v_mfma_f32_32x32x16_bf16 v[0:15], v[120:123], v[112:115], v[0:15]
    ds_read_b128 v[80:83], v190 offset:1024
    ds_read_b64_tr_b16 v[88:89], v194 offset:18432
    buffer_load_dwordx4 v176, s[8:11], s26 offen offset:1024 lds
    v_mfma_f32_32x32x16_bf16 v[16:31], v[120:123], v[116:119], v[16:31]
    ds_read_b64_tr_b16 v[90:91], v194 offset:18944
    ds_read_b128 v[84:87], v190 offset:5120
    v_mfma_f32_32x32x16_bf16 v[32:47], v[124:127], v[112:115], v[32:47]
    ds_read_b64_tr_b16 v[92:93], v195 offset:18432
    ds_read_b64_tr_b16 v[94:95], v195 offset:18944
    buffer_load_dwordx4 v176, s[8:11], s26 offen offset:2048 lds
    v_mfma_f32_32x32x16_bf16 v[48:63], v[124:127], v[116:119], v[48:63]
    buffer_load_dwordx4 v176, s[8:11], s26 offen offset:3072 lds
    s_waitcnt lgkmcnt(9)
    v_mfma_f32_32x32x16_bf16 v[0:15], v[72:75], v[64:67], v[0:15]
    ds_read_b128 v[96:99], v190 offset:2048
    ds_read_b64_tr_b16 v[104:105], v194 offset:20480
    s_waitcnt lgkmcnt(10)
    v_mfma_f32_32x32x16_bf16 v[16:31], v[72:75], v[68:71], v[16:31]
    ds_read_b64_tr_b16 v[106:107], v194 offset:20992
    ds_read_b128 v[100:103], v190 offset:6144
    s_waitcnt lgkmcnt(10)
    v_mfma_f32_32x32x16_bf16 v[32:47], v[76:79], v[64:67], v[32:47]
    ds_read_b64_tr_b16 v[108:109], v195 offset:20480
    ds_read_b64_tr_b16 v[110:111], v195 offset:20992
    s_add_u32 m0, s25, 131072
    s_nop 0
    buffer_load_dwordx4 v252, s[12:15], s27 offen lds
    v_mfma_f32_32x32x16_bf16 v[48:63], v[76:79], v[68:71], v[48:63]
    ds_read_b128 v[112:115], v190 offset:3072
    ds_read_b64_tr_b16 v[120:121], v194 offset:22528
    s_waitcnt lgkmcnt(11)
    v_mfma_f32_32x32x16_bf16 v[0:15], v[88:91], v[80:83], v[0:15]
    ds_read_b64_tr_b16 v[122:123], v194 offset:23040
    ds_read_b128 v[116:119], v190 offset:7168
    s_add_u32 m0, s25, 132096
    s_nop 0
    buffer_load_dwordx4 v253, s[12:15], s27 offen lds
    s_waitcnt lgkmcnt(12)
    v_mfma_f32_32x32x16_bf16 v[16:31], v[88:91], v[84:87], v[16:31]
    ds_read_b64_tr_b16 v[124:125], v195 offset:22528
    ds_read_b64_tr_b16 v[126:127], v195 offset:23040
    s_waitcnt lgkmcnt(12)
    v_mfma_f32_32x32x16_bf16 v[32:47], v[92:95], v[80:83], v[32:47]
    s_add_u32 m0, s25, 139264
    s_nop 0
    buffer_load_dwordx4 v254, s[12:15], s27 offen lds
    v_mfma_f32_32x32x16_bf16 v[48:63], v[92:95], v[84:87], v[48:63]
    s_add_u32 m0, s25, 140288
    s_nop 0
    buffer_load_dwordx4 v255, s[12:15], s27 offen lds
    s_add_u32 s26, s26, 4096
    s_add_u32 s27, s27, 131072
    s_waitcnt lgkmcnt(9)
    v_mfma_f32_32x32x16_bf16 v[0:15], v[104:107], v[96:99], v[0:15]
    s_waitcnt lgkmcnt(8)
    v_mfma_f32_32x32x16_bf16 v[16:31], v[104:107], v[100:103], v[16:31]
    s_waitcnt vmcnt(24) lgkmcnt(0)
    s_barrier
    ds_read_b128 v[64:67], v190 offset:32768
    ds_read_b64_tr_b16 v[72:73], v194 offset:49152
    v_mfma_f32_32x32x16_bf16 v[32:47], v[108:111], v[96:99], v[32:47]
    ds_read_b64_tr_b16 v[74:75], v194 offset:49664
    ds_read_b128 v[68:71], v190 offset:36864
    s_add_u32 m0, s24, 0
    s_nop 0
    buffer_load_dwordx4 v176, s[8:11], s26 offen offset:0 lds
    v_mfma_f32_32x32x16_bf16 v[48:63], v[108:111], v[100:103], v[48:63]
    ds_read_b64_tr_b16 v[76:77], v195 offset:49152
    ds_read_b64_tr_b16 v[78:79], v195 offset:49664
    v_mfma_f32_32x32x16_bf16 v[0:15], v[120:123], v[112:115], v[0:15]
    ds_read_b128 v[80:83], v190 offset:33792
    ds_read_b64_tr_b16 v[88:89], v194 offset:51200
    buffer_load_dwordx4 v176, s[8:11], s26 offen offset:1024 lds
    v_mfma_f32_32x32x16_bf16 v[16:31], v[120:123], v[116:119], v[16:31]
    ds_read_b64_tr_b16 v[90:91], v194 offset:51712
    ds_read_b128 v[84:87], v190 offset:37888
    v_mfma_f32_32x32x16_bf16 v[32:47], v[124:127], v[112:115], v[32:47]
    ds_read_b64_tr_b16 v[92:93], v195 offset:51200
    ds_read_b64_tr_b16 v[94:95], v195 offset:51712
    buffer_load_dwordx4 v176, s[8:11], s26 offen offset:2048 lds
    v_mfma_f32_32x32x16_bf16 v[48:63], v[124:127], v[116:119], v[48:63]
    buffer_load_dwordx4 v176, s[8:11], s26 offen offset:3072 lds
    s_waitcnt lgkmcnt(9)
    v_mfma_f32_32x32x16_bf16 v[0:15], v[72:75], v[64:67], v[0:15]
    ds_read_b128 v[96:99], v190 offset:34816
    ds_read_b64_tr_b16 v[104:105], v194 offset:53248
    s_waitcnt lgkmcnt(10)
    v_mfma_f32_32x32x16_bf16 v[16:31], v[72:75], v[68:71], v[16:31]
    ds_read_b64_tr_b16 v[106:107], v194 offset:53760
    ds_read_b128 v[100:103], v190 offset:38912
    s_waitcnt lgkmcnt(10)
    v_mfma_f32_32x32x16_bf16 v[32:47], v[76:79], v[64:67], v[32:47]
    ds_read_b64_tr_b16 v[108:109], v195 offset:53248
    ds_read_b64_tr_b16 v[110:111], v195 offset:53760
    s_add_u32 m0, s25, 0
    s_nop 0
    buffer_load_dwordx4 v252, s[12:15], s27 offen lds
    v_mfma_f32_32x32x16_bf16 v[48:63], v[76:79], v[68:71], v[48:63]
    ds_read_b128 v[112:115], v190 offset:35840
    ds_read_b64_tr_b16 v[120:121], v194 offset:55296
    s_waitcnt lgkmcnt(11)
    v_mfma_f32_32x32x16_bf16 v[0:15], v[88:91], v[80:83], v[0:15]
    ds_read_b64_tr_b16 v[122:123], v194 offset:55808
    ds_read_b128 v[116:119], v190 offset:39936
    s_add_u32 m0, s25, 1024
    s_nop 0
    buffer_load_dwordx4 v253, s[12:15], s27 offen lds
    s_waitcnt lgkmcnt(12)
    v_mfma_f32_32x32x16_bf16 v[16:31], v[88:91], v[84:87], v[16:31]
    ds_read_b64_tr_b16 v[124:125], v195 offset:55296
    ds_read_b64_tr_b16 v[126:127], v195 offset:55808
    s_waitcnt lgkmcnt(12)
    v_mfma_f32_32x32x16_bf16 v[32:47], v[92:95], v[80:83], v[32:47]
    s_add_u32 m0, s25, 8192
    s_nop 0
    buffer_load_dwordx4 v254, s[12:15], s27 offen lds
    v_mfma_f32_32x32x16_bf16 v[48:63], v[92:95], v[84:87], v[48:63]
    s_add_u32 m0, s25, 9216
    s_nop 0
    buffer_load_dwordx4 v255, s[12:15], s27 offen lds
    s_add_u32 s26, s26, 4096
    s_add_u32 s27, s27, 131072
    s_waitcnt lgkmcnt(9)
    v_mfma_f32_32x32x16_bf16 v[0:15], v[104:107], v[96:99], v[0:15]
    s_waitcnt lgkmcnt(8)
    v_mfma_f32_32x32x16_bf16 v[16:31], v[104:107], v[100:103], v[16:31]
    s_waitcnt vmcnt(24) lgkmcnt(0)
    s_barrier
    ds_read_b128 v[64:67], v191 offset:0
    ds_read_b64_tr_b16 v[72:73], v196 offset:16384
    v_mfma_f32_32x32x16_bf16 v[32:47], v[108:111], v[96:99], v[32:47]
    ds_read_b64_tr_b16 v[74:75], v196 offset:16896
    ds_read_b128 v[68:71], v191 offset:4096
    s_add_u32 m0, s24, 32768
    s_nop 0
    buffer_load_dwordx4 v176, s[8:11], s26 offen offset:0 lds
    v_mfma_f32_32x32x16_bf16 v[48:63], v[108:111], v[100:103], v[48:63]
    ds_read_b64_tr_b16 v[76:77], v197 offset:16384
    ds_read_b64_tr_b16 v[78:79], v197 offset:16896
    v_mfma_f32_32x32x16_bf16 v[0:15], v[120:123], v[112:115], v[0:15]
    ds_read_b128 v[80:83], v191 offset:1024
    ds_read_b64_tr_b16 v[88:89], v196 offset:18432
    buffer_load_dwordx4 v176, s[8:11], s26 offen offset:1024 lds
    v_mfma_f32_32x32x16_bf16 v[16:31], v[120:123], v[116:119], v[16:31]
    ds_read_b64_tr_b16 v[90:91], v196 offset:18944
    ds_read_b128 v[84:87], v191 offset:5120
    v_mfma_f32_32x32x16_bf16 v[32:47], v[124:127], v[112:115], v[32:47]
    ds_read_b64_tr_b16 v[92:93], v197 offset:18432
    ds_read_b64_tr_b16 v[94:95], v197 offset:18944
    buffer_load_dwordx4 v176, s[8:11], s26 offen offset:2048 lds
    v_mfma_f32_32x32x16_bf16 v[48:63], v[124:127], v[116:119], v[48:63]
    buffer_load_dwordx4 v176, s[8:11], s26 offen offset:3072 lds
    s_waitcnt lgkmcnt(9)
    v_mfma_f32_32x32x16_bf16 v[0:15], v[72:75], v[64:67], v[0:15]
    ds_read_b128 v[96:99], v191 offset:2048
    ds_read_b64_tr_b16 v[104:105], v196 offset:20480
    s_waitcnt lgkmcnt(10)
    v_mfma_f32_32x32x16_bf16 v[16:31], v[72:75], v[68:71], v[16:31]
    ds_read_b64_tr_b16 v[106:107], v196 offset:20992
    ds_read_b128 v[100:103], v191 offset:6144
    s_waitcnt lgkmcnt(10)
    v_mfma_f32_32x32x16_bf16 v[32:47], v[76:79], v[64:67], v[32:47]
    ds_read_b64_tr_b16 v[108:109], v197 offset:20480
    ds_read_b64_tr_b16 v[110:111], v197 offset:20992
    s_add_u32 m0, s25, 32768
    s_nop 0
    buffer_load_dwordx4 v252, s[12:15], s27 offen lds
    v_mfma_f32_32x32x16_bf16 v[48:63], v[76:79], v[68:71], v[48:63]
    ds_read_b128 v[112:115], v191 offset:3072
    ds_read_b64_tr_b16 v[120:121], v196 offset:22528
    s_waitcnt lgkmcnt(11)
    v_mfma_f32_32x32x16_bf16 v[0:15], v[88:91], v[80:83], v[0:15]
    ds_read_b64_tr_b16 v[122:123], v196 offset:23040
    ds_read_b128 v[116:119], v191 offset:7168
    s_add_u32 m0, s25, 33792
    s_nop 0
    buffer_load_dwordx4 v253, s[12:15], s27 offen lds
    s_waitcnt lgkmcnt(12)
    v_mfma_f32_32x32x16_bf16 v[16:31], v[88:91], v[84:87], v[16:31]
    ds_read_b64_tr_b16 v[124:125], v197 offset:22528
    ds_read_b64_tr_b16 v[126:127], v197 offset:23040
    s_waitcnt lgkmcnt(12)
    v_mfma_f32_32x32x16_bf16 v[32:47], v[92:95], v[80:83], v[32:47]
    s_add_u32 m0, s25, 40960
    s_nop 0
    buffer_load_dwordx4 v254, s[12:15], s27 offen lds
    v_mfma_f32_32x32x16_bf16 v[48:63], v[92:95], v[84:87], v[48:63]
    s_add_u32 m0, s25, 41984
    s_nop 0
    buffer_load_dwordx4 v255, s[12:15], s27 offen lds
    s_add_u32 s26, s26, 4096
    s_add_u32 s27, s27, 131072
    s_waitcnt lgkmcnt(9)
    v_mfma_f32_32x32x16_bf16 v[0:15], v[104:107], v[96:99], v[0:15]
    s_waitcnt lgkmcnt(8)
    v_mfma_f32_32x32x16_bf16 v[16:31], v[104:107], v[100:103], v[16:31]
    s_waitcnt vmcnt(24) lgkmcnt(0)
    s_barrier
    ds_read_b128 v[64:67], v191 offset:32768
    ds_read_b64_tr_b16 v[72:73], v196 offset:49152
    v_mfma_f32_32x32x16_bf16 v[32:47], v[108:111], v[96:99], v[32:47]
    ds_read_b64_tr_b16 v[74:75], v196 offset:49664
    ds_read_b128 v[68:71], v191 offset:36864
    s_add_u32 m0, s24, 65536
    s_nop 0
    buffer_load_dwordx4 v176, s[8:11], s26 offen offset:0 lds
    v_mfma_f32_32x32x16_bf16 v[48:63], v[108:111], v[100:103], v[48:63]
    ds_read_b64_tr_b16 v[76:77], v197 offset:49152
    ds_read_b64_tr_b16 v[78:79], v197 offset:49664
    v_mfma_f32_32x32x16_bf16 v[0:15], v[120:123], v[112:115], v[0:15]
    ds_read_b128 v[80:83], v191 offset:33792
    ds_read_b64_tr_b16 v[88:89], v196 offset:51200
    buffer_load_dwordx4 v176, s[8:11], s26 offen offset:1024 lds
    v_mfma_f32_32x32x16_bf16 v[16:31], v[120:123], v[116:119], v[16:31]
    ds_read_b64_tr_b16 v[90:91], v196 offset:51712
    ds_read_b128 v[84:87], v191 offset:37888
    v_mfma_f32_32x32x16_bf16 v[32:47], v[124:127], v[112:115], v[32:47]
    ds_read_b64_tr_b16 v[92:93], v197 offset:51200
    ds_read_b64_tr_b16 v[94:95], v197 offset:51712
    buffer_load_dwordx4 v176, s[8:11], s26 offen offset:2048 lds
    v_mfma_f32_32x32x16_bf16 v[48:63], v[124:127], v[116:119], v[48:63]
    buffer_load_dwordx4 v176, s[8:11], s26 offen offset:3072 lds
    s_sub_u32 s28, s28, 1
    s_cmp_lg_u32 s28, 0
    s_cbranch_scc1 loop_mlp_kernel_13
    s_waitcnt lgkmcnt(9)
    v_mfma_f32_32x32x16_bf16 v[0:15], v[72:75], v[64:67], v[0:15]
    ds_read_b128 v[96:99], v191 offset:34816
    ds_read_b64_tr_b16 v[104:105], v196 offset:53248
    s_waitcnt lgkmcnt(10)
    v_mfma_f32_32x32x16_bf16 v[16:31], v[72:75], v[68:71], v[16:31]
    ds_read_b64_tr_b16 v[106:107], v196 offset:53760
    ds_read_b128 v[100:103], v191 offset:38912
    s_waitcnt lgkmcnt(10)
    v_mfma_f32_32x32x16_bf16 v[32:47], v[76:79], v[64:67], v[32:47]
    ds_read_b64_tr_b16 v[108:109], v197 offset:53248
    ds_read_b64_tr_b16 v[110:111], v197 offset:53760
    s_add_u32 m0, s25, 65536
    s_nop 0
    buffer_load_dwordx4 v252, s[12:15], s27 offen lds
    v_mfma_f32_32x32x16_bf16 v[48:63], v[76:79], v[68:71], v[48:63]
    ds_read_b128 v[112:115], v191 offset:35840
    ds_read_b64_tr_b16 v[120:121], v196 offset:55296
    s_waitcnt lgkmcnt(11)
    v_mfma_f32_32x32x16_bf16 v[0:15], v[88:91], v[80:83], v[0:15]
    ds_read_b64_tr_b16 v[122:123], v196 offset:55808
    ds_read_b128 v[116:119], v191 offset:39936
    s_add_u32 m0, s25, 66560
    s_nop 0
    buffer_load_dwordx4 v253, s[12:15], s27 offen lds
    s_waitcnt lgkmcnt(12)
    v_mfma_f32_32x32x16_bf16 v[16:31], v[88:91], v[84:87], v[16:31]
    ds_read_b64_tr_b16 v[124:125], v197 offset:55296
    ds_read_b64_tr_b16 v[126:127], v197 offset:55808
    s_waitcnt lgkmcnt(12)
    v_mfma_f32_32x32x16_bf16 v[32:47], v[92:95], v[80:83], v[32:47]
    s_add_u32 m0, s25, 73728
    s_nop 0
    buffer_load_dwordx4 v254, s[12:15], s27 offen lds
    v_mfma_f32_32x32x16_bf16 v[48:63], v[92:95], v[84:87], v[48:63]
    s_add_u32 m0, s25, 74752
    s_nop 0
    buffer_load_dwordx4 v255, s[12:15], s27 offen lds
    s_add_u32 s26, s26, 4096
    s_add_u32 s27, s27, 131072
    s_waitcnt lgkmcnt(9)
    v_mfma_f32_32x32x16_bf16 v[0:15], v[104:107], v[96:99], v[0:15]
    s_waitcnt lgkmcnt(8)
    v_mfma_f32_32x32x16_bf16 v[16:31], v[104:107], v[100:103], v[16:31]
    s_waitcnt vmcnt(24) lgkmcnt(0)
    s_barrier
    ds_read_b128 v[64:67], v192 offset:0
    ds_read_b64_tr_b16 v[72:73], v198 offset:16384
    v_mfma_f32_32x32x16_bf16 v[32:47], v[108:111], v[96:99], v[32:47]
    ds_read_b64_tr_b16 v[74:75], v198 offset:16896
    ds_read_b128 v[68:71], v192 offset:4096
    v_mfma_f32_32x32x16_bf16 v[48:63], v[108:111], v[100:103], v[48:63]
    ds_read_b64_tr_b16 v[76:77], v199 offset:16384
    ds_read_b64_tr_b16 v[78:79], v199 offset:16896
    v_mfma_f32_32x32x16_bf16 v[0:15], v[120:123], v[112:115], v[0:15]
    ds_read_b128 v[80:83], v192 offset:1024
    ds_read_b64_tr_b16 v[88:89], v198 offset:18432
    v_mfma_f32_32x32x16_bf16 v[16:31], v[120:123], v[116:119], v[16:31]
    ds_read_b64_tr_b16 v[90:91], v198 offset:18944
    ds_read_b128 v[84:87], v192 offset:5120
    v_mfma_f32_32x32x16_bf16 v[32:47], v[124:127], v[112:115], v[32:47]
    ds_read_b64_tr_b16 v[92:93], v199 offset:18432
    ds_read_b64_tr_b16 v[94:95], v199 offset:18944
    v_mfma_f32_32x32x16_bf16 v[48:63], v[124:127], v[116:119], v[48:63]
    s_waitcnt lgkmcnt(9)
    v_mfma_f32_32x32x16_bf16 v[0:15], v[72:75], v[64:67], v[0:15]
    ds_read_b128 v[96:99], v192 offset:2048
    ds_read_b64_tr_b16 v[104:105], v198 offset:20480
    s_waitcnt lgkmcnt(10)
    v_mfma_f32_32x32x16_bf16 v[16:31], v[72:75], v[68:71], v[16:31]
    ds_read_b64_tr_b16 v[106:107], v198 offset:20992
    ds_read_b128 v[100:103], v192 offset:6144
    s_waitcnt lgkmcnt(10)
    v_mfma_f32_32x32x16_bf16 v[32:47], v[76:79], v[64:67], v[32:47]
    ds_read_b64_tr_b16 v[108:109], v199 offset:20480
    ds_read_b64_tr_b16 v[110:111], v199 offset:20992
    buffer_load_dwordx4 v[128:131], v225, s[40:43], s58 offen offset:0
    v_mfma_f32_32x32x16_bf16 v[48:63], v[76:79], v[68:71], v[48:63]
    ds_read_b128 v[112:115], v192 offset:3072
    ds_read_b64_tr_b16 v[120:121], v198 offset:22528
    buffer_load_dwordx4 v[132:135], v225, s[40:43], s58 offen offset:1024
    s_waitcnt lgkmcnt(11)
    v_mfma_f32_32x32x16_bf16 v[0:15], v[88:91], v[80:83], v[0:15]
    ds_read_b64_tr_b16 v[122:123], v198 offset:23040
    ds_read_b128 v[116:119], v192 offset:7168
    buffer_load_dwordx4 v[136:139], v225, s[40:43], s59 offen offset:0
    s_waitcnt lgkmcnt(12)
    v_mfma_f32_32x32x16_bf16 v[16:31], v[88:91], v[84:87], v[16:31]
    ds_read_b64_tr_b16 v[124:125], v199 offset:22528
    ds_read_b64_tr_b16 v[126:127], v199 offset:23040
    buffer_load_dwordx4 v[140:143], v225, s[40:43], s59 offen offset:1024
    s_waitcnt lgkmcnt(12)
    v_mfma_f32_32x32x16_bf16 v[32:47], v[92:95], v[80:83], v[32:47]
    buffer_load_dword v178, v189, s[40:43], s7 offen offset:0
    v_mfma_f32_32x32x16_bf16 v[48:63], v[92:95], v[84:87], v[48:63]
    buffer_load_dword v180, v189, s[40:43], s7 offen offset:128
    s_waitcnt lgkmcnt(9)
    v_mfma_f32_32x32x16_bf16 v[0:15], v[104:107], v[96:99], v[0:15]
    s_waitcnt lgkmcnt(8)
    v_mfma_f32_32x32x16_bf16 v[16:31], v[104:107], v[100:103], v[16:31]
    s_waitcnt vmcnt(22) lgkmcnt(0)
    s_barrier
    ds_read_b128 v[64:67], v190 offset:0
    ds_read_b64_tr_b16 v[72:73], v194 offset:16384
    v_mfma_f32_32x32x16_bf16 v[32:47], v[108:111], v[96:99], v[32:47]
    ds_read_b64_tr_b16 v[74:75], v194 offset:16896
    ds_read_b128 v[68:71], v190 offset:4096
    v_mfma_f32_32x32x16_bf16 v[48:63], v[108:111], v[100:103], v[48:63]
    ds_read_b64_tr_b16 v[76:77], v195 offset:16384
    ds_read_b64_tr_b16 v[78:79], v195 offset:16896
    v_mfma_f32_32x32x16_bf16 v[0:15], v[120:123], v[112:115], v[0:15]
    ds_read_b128 v[80:83], v190 offset:1024
    ds_read_b64_tr_b16 v[88:89], v194 offset:18432
    v_mfma_f32_32x32x16_bf16 v[16:31], v[120:123], v[116:119], v[16:31]
    ds_read_b64_tr_b16 v[90:91], v194 offset:18944
    ds_read_b128 v[84:87], v190 offset:5120
    v_mfma_f32_32x32x16_bf16 v[32:47], v[124:127], v[112:115], v[32:47]
    ds_read_b64_tr_b16 v[92:93], v195 offset:18432
    ds_read_b64_tr_b16 v[94:95], v195 offset:18944
    v_mfma_f32_32x32x16_bf16 v[48:63], v[124:127], v[116:119], v[48:63]
    s_waitcnt lgkmcnt(9)
    v_mfma_f32_32x32x16_bf16 v[0:15], v[72:75], v[64:67], v[0:15]
    ds_read_b128 v[96:99], v190 offset:2048
    ds_read_b64_tr_b16 v[104:105], v194 offset:20480
    s_waitcnt lgkmcnt(10)
    v_mfma_f32_32x32x16_bf16 v[16:31], v[72:75], v[68:71], v[16:31]
    ds_read_b64_tr_b16 v[106:107], v194 offset:20992
    ds_read_b128 v[100:103], v190 offset:6144
    s_waitcnt lgkmcnt(10)
    v_mfma_f32_32x32x16_bf16 v[32:47], v[76:79], v[64:67], v[32:47]
    ds_read_b64_tr_b16 v[108:109], v195 offset:20480
    ds_read_b64_tr_b16 v[110:111], v195 offset:20992
    v_mfma_f32_32x32x16_bf16 v[48:63], v[76:79], v[68:71], v[48:63]
    ds_read_b128 v[112:115], v190 offset:3072
    ds_read_b64_tr_b16 v[120:121], v194 offset:22528
    s_waitcnt lgkmcnt(11)
    v_mfma_f32_32x32x16_bf16 v[0:15], v[88:91], v[80:83], v[0:15]
    ds_read_b64_tr_b16 v[122:123], v194 offset:23040
    ds_read_b128 v[116:119], v190 offset:7168
    s_waitcnt lgkmcnt(12)
    v_mfma_f32_32x32x16_bf16 v[16:31], v[88:91], v[84:87], v[16:31]
    ds_read_b64_tr_b16 v[124:125], v195 offset:22528
    ds_read_b64_tr_b16 v[126:127], v195 offset:23040
    s_waitcnt lgkmcnt(12)
    v_mfma_f32_32x32x16_bf16 v[32:47], v[92:95], v[80:83], v[32:47]
    v_mfma_f32_32x32x16_bf16 v[48:63], v[92:95], v[84:87], v[48:63]
    s_waitcnt lgkmcnt(9)
    v_mfma_f32_32x32x16_bf16 v[0:15], v[104:107], v[96:99], v[0:15]
    s_waitcnt lgkmcnt(8)
    v_mfma_f32_32x32x16_bf16 v[16:31], v[104:107], v[100:103], v[16:31]
    s_waitcnt vmcnt(14) lgkmcnt(0)
    s_barrier
    ds_read_b128 v[64:67], v190 offset:32768
    ds_read_b64_tr_b16 v[72:73], v194 offset:49152
    v_mfma_f32_32x32x16_bf16 v[32:47], v[108:111], v[96:99], v[32:47]
    ds_read_b64_tr_b16 v[74:75], v194 offset:49664
    ds_read_b128 v[68:71], v190 offset:36864
    v_mfma_f32_32x32x16_bf16 v[48:63], v[108:111], v[100:103], v[48:63]
    ds_read_b64_tr_b16 v[76:77], v195 offset:49152
    ds_read_b64_tr_b16 v[78:79], v195 offset:49664
    v_mfma_f32_32x32x16_bf16 v[0:15], v[120:123], v[112:115], v[0:15]
    ds_read_b128 v[80:83], v190 offset:33792
    ds_read_b64_tr_b16 v[88:89], v194 offset:51200
    v_mfma_f32_32x32x16_bf16 v[16:31], v[120:123], v[116:119], v[16:31]
    ds_read_b64_tr_b16 v[90:91], v194 offset:51712
    ds_read_b128 v[84:87], v190 offset:37888
    v_mfma_f32_32x32x16_bf16 v[32:47], v[124:127], v[112:115], v[32:47]
    ds_read_b64_tr_b16 v[92:93], v195 offset:51200
    ds_read_b64_tr_b16 v[94:95], v195 offset:51712
    v_mfma_f32_32x32x16_bf16 v[48:63], v[124:127], v[116:119], v[48:63]
    s_waitcnt lgkmcnt(9)
    v_mfma_f32_32x32x16_bf16 v[0:15], v[72:75], v[64:67], v[0:15]
    ds_read_b128 v[96:99], v190 offset:34816
    ds_read_b64_tr_b16 v[104:105], v194 offset:53248
    s_waitcnt lgkmcnt(10)
    v_mfma_f32_32x32x16_bf16 v[16:31], v[72:75], v[68:71], v[16:31]
    ds_read_b64_tr_b16 v[106:107], v194 offset:53760
    ds_read_b128 v[100:103], v190 offset:38912
    s_waitcnt lgkmcnt(10)
    v_mfma_f32_32x32x16_bf16 v[32:47], v[76:79], v[64:67], v[32:47]
    ds_read_b64_tr_b16 v[108:109], v195 offset:53248
    ds_read_b64_tr_b16 v[110:111], v195 offset:53760
    v_mfma_f32_32x32x16_bf16 v[48:63], v[76:79], v[68:71], v[48:63]
    ds_read_b128 v[112:115], v190 offset:35840
    ds_read_b64_tr_b16 v[120:121], v194 offset:55296
    s_waitcnt lgkmcnt(11)
    v_mfma_f32_32x32x16_bf16 v[0:15], v[88:91], v[80:83], v[0:15]
    ds_read_b64_tr_b16 v[122:123], v194 offset:55808
    ds_read_b128 v[116:119], v190 offset:39936
    s_waitcnt lgkmcnt(12)
    v_mfma_f32_32x32x16_bf16 v[16:31], v[88:91], v[84:87], v[16:31]
    ds_read_b64_tr_b16 v[124:125], v195 offset:55296
    ds_read_b64_tr_b16 v[126:127], v195 offset:55808
    s_waitcnt lgkmcnt(12)
    v_mfma_f32_32x32x16_bf16 v[32:47], v[92:95], v[80:83], v[32:47]
    v_mfma_f32_32x32x16_bf16 v[48:63], v[92:95], v[84:87], v[48:63]
    s_waitcnt lgkmcnt(9)
    v_mfma_f32_32x32x16_bf16 v[0:15], v[104:107], v[96:99], v[0:15]
    s_waitcnt lgkmcnt(8)
    v_mfma_f32_32x32x16_bf16 v[16:31], v[104:107], v[100:103], v[16:31]
    s_waitcnt vmcnt(6) lgkmcnt(0)
    s_barrier
    ds_read_b128 v[64:67], v191 offset:0
    ds_read_b64_tr_b16 v[72:73], v196 offset:16384
    v_mfma_f32_32x32x16_bf16 v[32:47], v[108:111], v[96:99], v[32:47]
    ds_read_b64_tr_b16 v[74:75], v196 offset:16896
    ds_read_b128 v[68:71], v191 offset:4096
    v_mfma_f32_32x32x16_bf16 v[48:63], v[108:111], v[100:103], v[48:63]
    ds_read_b64_tr_b16 v[76:77], v197 offset:16384
    ds_read_b64_tr_b16 v[78:79], v197 offset:16896
    v_mfma_f32_32x32x16_bf16 v[0:15], v[120:123], v[112:115], v[0:15]
    ds_read_b128 v[80:83], v191 offset:1024
    ds_read_b64_tr_b16 v[88:89], v196 offset:18432
    v_mfma_f32_32x32x16_bf16 v[16:31], v[120:123], v[116:119], v[16:31]
    ds_read_b64_tr_b16 v[90:91], v196 offset:18944
    ds_read_b128 v[84:87], v191 offset:5120
    v_mfma_f32_32x32x16_bf16 v[32:47], v[124:127], v[112:115], v[32:47]
    ds_read_b64_tr_b16 v[92:93], v197 offset:18432
    ds_read_b64_tr_b16 v[94:95], v197 offset:18944
    v_mfma_f32_32x32x16_bf16 v[48:63], v[124:127], v[116:119], v[48:63]
    s_waitcnt lgkmcnt(9)
    v_mfma_f32_32x32x16_bf16 v[0:15], v[72:75], v[64:67], v[0:15]
    ds_read_b128 v[96:99], v191 offset:2048
    ds_read_b64_tr_b16 v[104:105], v196 offset:20480
    s_waitcnt lgkmcnt(10)
    v_mfma_f32_32x32x16_bf16 v[16:31], v[72:75], v[68:71], v[16:31]
    ds_read_b64_tr_b16 v[106:107], v196 offset:20992
    ds_read_b128 v[100:103], v191 offset:6144
    s_waitcnt lgkmcnt(10)
    v_mfma_f32_32x32x16_bf16 v[32:47], v[76:79], v[64:67], v[32:47]
    ds_read_b64_tr_b16 v[108:109], v197 offset:20480
    ds_read_b64_tr_b16 v[110:111], v197 offset:20992
    v_mfma_f32_32x32x16_bf16 v[48:63], v[76:79], v[68:71], v[48:63]
    ds_read_b128 v[112:115], v191 offset:3072
    ds_read_b64_tr_b16 v[120:121], v196 offset:22528
    s_waitcnt lgkmcnt(11)
    v_mfma_f32_32x32x16_bf16 v[0:15], v[88:91], v[80:83], v[0:15]
    ds_read_b64_tr_b16 v[122:123], v196 offset:23040
    ds_read_b128 v[116:119], v191 offset:7168
    s_waitcnt lgkmcnt(12)
    v_mfma_f32_32x32x16_bf16 v[16:31], v[88:91], v[84:87], v[16:31]
    ds_read_b64_tr_b16 v[124:125], v197 offset:22528
    ds_read_b64_tr_b16 v[126:127], v197 offset:23040
    s_waitcnt lgkmcnt(12)
    v_mfma_f32_32x32x16_bf16 v[32:47], v[92:95], v[80:83], v[32:47]
    v_mfma_f32_32x32x16_bf16 v[48:63], v[92:95], v[84:87], v[48:63]
    s_waitcnt lgkmcnt(9)
    v_mfma_f32_32x32x16_bf16 v[0:15], v[104:107], v[96:99], v[0:15]
    s_waitcnt lgkmcnt(8)
    v_mfma_f32_32x32x16_bf16 v[16:31], v[104:107], v[100:103], v[16:31]
    s_waitcnt lgkmcnt(6)
    v_mfma_f32_32x32x16_bf16 v[32:47], v[108:111], v[96:99], v[32:47]
    v_mfma_f32_32x32x16_bf16 v[48:63], v[108:111], v[100:103], v[48:63]
    s_waitcnt lgkmcnt(3)
    v_mfma_f32_32x32x16_bf16 v[0:15], v[120:123], v[112:115], v[0:15]
    s_waitcnt lgkmcnt(2)
    v_mfma_f32_32x32x16_bf16 v[16:31], v[120:123], v[116:119], v[16:31]
    s_waitcnt lgkmcnt(0)
    v_mfma_f32_32x32x16_bf16 v[32:47], v[124:127], v[112:115], v[32:47]
    v_mfma_f32_32x32x16_bf16 v[48:63], v[124:127], v[116:119], v[48:63]
    s_waitcnt vmcnt(0) lgkmcnt(0)
    s_nop 14
    s_add_u32 s8, s4, 50331648
    s_addc_u32 s9, s5, 0
    s_and_b32 s9, s9, 0xffff
    s_mov_b32 s10, 4194304
    s_mov_b32 s11, 0x00020000
    s_mov_b32 s44, s38
    s_and_b32 s45, s39, 0xffff
    s_mov_b32 s46, 4194304
    s_mov_b32 s47, 0x00020000
    v_cvt_pk_bf16_f32 v64, v32, v33
    v_cvt_pk_bf16_f32 v65, v34, v35
    v_cvt_pk_bf16_f32 v66, v36, v37
    v_cvt_pk_bf16_f32 v67, v38, v39
    buffer_store_dwordx4 v[64:67], v225, s[8:11], s56 offen offset:0 sc1
    v_cvt_pk_bf16_f32 v68, v40, v41
    v_cvt_pk_bf16_f32 v69, v42, v43
    v_cvt_pk_bf16_f32 v70, v44, v45
    v_cvt_pk_bf16_f32 v71, v46, v47
    buffer_store_dwordx4 v[68:71], v225, s[8:11], s56 offen offset:1024 sc1
    v_cvt_pk_bf16_f32 v72, v48, v49
    v_cvt_pk_bf16_f32 v73, v50, v51
    v_cvt_pk_bf16_f32 v74, v52, v53
    v_cvt_pk_bf16_f32 v75, v54, v55
    buffer_store_dwordx4 v[72:75], v225, s[8:11], s56 offen offset:2048 sc1
    v_cvt_pk_bf16_f32 v76, v56, v57
    v_cvt_pk_bf16_f32 v77, v58, v59
    v_cvt_pk_bf16_f32 v78, v60, v61
    v_cvt_pk_bf16_f32 v79, v62, v63
    buffer_store_dwordx4 v[76:79], v225, s[8:11], s56 offen offset:3072 sc1
    v_lshlrev_b32 v242, 16, v128
    v_and_b32 v243, 0xffff0000, v128
    v_pk_add_f32 v[0:1], v[0:1], v[242:243]
    v_lshlrev_b32 v242, 16, v129
    v_and_b32 v243, 0xffff0000, v129
    v_pk_add_f32 v[2:3], v[2:3], v[242:243]
    v_lshlrev_b32 v242, 16, v130
    v_and_b32 v243, 0xffff0000, v130
    v_pk_add_f32 v[4:5], v[4:5], v[242:243]
    v_lshlrev_b32 v242, 16, v131
    v_and_b32 v243, 0xffff0000, v131
    v_pk_add_f32 v[6:7], v[6:7], v[242:243]
    v_lshlrev_b32 v242, 16, v132
    v_and_b32 v243, 0xffff0000, v132
    v_pk_add_f32 v[8:9], v[8:9], v[242:243]
    v_lshlrev_b32 v242, 16, v133
    v_and_b32 v243, 0xffff0000, v133
    v_pk_add_f32 v[10:11], v[10:11], v[242:243]
    v_lshlrev_b32 v242, 16, v134
    v_and_b32 v243, 0xffff0000, v134
    v_pk_add_f32 v[12:13], v[12:13], v[242:243]
    v_lshlrev_b32 v242, 16, v135
    v_and_b32 v243, 0xffff0000, v135
    v_pk_add_f32 v[14:15], v[14:15], v[242:243]
    v_lshlrev_b32 v242, 16, v136
    v_and_b32 v243, 0xffff0000, v136
    v_pk_add_f32 v[16:17], v[16:17], v[242:243]
    v_lshlrev_b32 v242, 16, v137
    v_and_b32 v243, 0xffff0000, v137
    v_pk_add_f32 v[18:19], v[18:19], v[242:243]
    v_lshlrev_b32 v242, 16, v138
    v_and_b32 v243, 0xffff0000, v138
    v_pk_add_f32 v[20:21], v[20:21], v[242:243]
    v_lshlrev_b32 v242, 16, v139
    v_and_b32 v243, 0xffff0000, v139
    v_pk_add_f32 v[22:23], v[22:23], v[242:243]
    v_lshlrev_b32 v242, 16, v140
    v_and_b32 v243, 0xffff0000, v140
    v_pk_add_f32 v[24:25], v[24:25], v[242:243]
    v_lshlrev_b32 v242, 16, v141
    v_and_b32 v243, 0xffff0000, v141
    v_pk_add_f32 v[26:27], v[26:27], v[242:243]
    v_lshlrev_b32 v242, 16, v142
    v_and_b32 v243, 0xffff0000, v142
    v_pk_add_f32 v[28:29], v[28:29], v[242:243]
    v_lshlrev_b32 v242, 16, v143
    v_and_b32 v243, 0xffff0000, v143
    v_pk_add_f32 v[30:31], v[30:31], v[242:243]
    v_pk_add_f32 v[0:1], v[0:1], v[178:179] op_sel_hi:[1,0]
    v_pk_add_f32 v[2:3], v[2:3], v[178:179] op_sel_hi:[1,0]
    v_pk_add_f32 v[4:5], v[4:5], v[178:179] op_sel_hi:[1,0]
    v_pk_add_f32 v[6:7], v[6:7], v[178:179] op_sel_hi:[1,0]
    v_pk_add_f32 v[8:9], v[8:9], v[178:179] op_sel_hi:[1,0]
    v_pk_add_f32 v[10:11], v[10:11], v[178:179] op_sel_hi:[1,0]
    v_pk_add_f32 v[12:13], v[12:13], v[178:179] op_sel_hi:[1,0]
    v_pk_add_f32 v[14:15], v[14:15], v[178:179] op_sel_hi:[1,0]
    v_pk_add_f32 v[16:17], v[16:17], v[180:181] op_sel_hi:[1,0]
    v_pk_add_f32 v[18:19], v[18:19], v[180:181] op_sel_hi:[1,0]
    v_pk_add_f32 v[20:21], v[20:21], v[180:181] op_sel_hi:[1,0]
    v_pk_add_f32 v[22:23], v[22:23], v[180:181] op_sel_hi:[1,0]
    v_pk_add_f32 v[24:25], v[24:25], v[180:181] op_sel_hi:[1,0]
    v_pk_add_f32 v[26:27], v[26:27], v[180:181] op_sel_hi:[1,0]
    v_pk_add_f32 v[28:29], v[28:29], v[180:181] op_sel_hi:[1,0]
    v_pk_add_f32 v[30:31], v[30:31], v[180:181] op_sel_hi:[1,0]
    s_mov_b32 s50, 0x40000
poll_mlp_kernel_14:
    buffer_load_dwordx4 v[144:147], v225, s[8:11], s57 offen offset:0 sc1
    buffer_load_dwordx4 v[148:151], v225, s[8:11], s57 offen offset:1024 sc1
    buffer_load_dwordx4 v[152:155], v225, s[8:11], s57 offen offset:2048 sc1
    buffer_load_dwordx4 v[156:159], v225, s[8:11], s57 offen offset:3072 sc1
    s_waitcnt vmcnt(0)
    v_max_u32 v240, v144, v145
    v_max3_u32 v240, v240, v146, v147
    v_max3_u32 v240, v240, v148, v149
    v_max3_u32 v240, v240, v150, v151
    v_max3_u32 v240, v240, v152, v153
    v_max3_u32 v240, v240, v154, v155
    v_max3_u32 v240, v240, v156, v157
    v_max3_u32 v240, v240, v158, v159
    v_cmp_eq_u32 vcc, -1, v240
    s_cbranch_vccz rdy_mlp_kernel_15
    s_sub_u32 s50, s50, 1
    s_cmp_lg_u32 s50, 0
    s_cbranch_scc1 poll_mlp_kernel_14
rdy_mlp_kernel_15:
    v_lshlrev_b32 v242, 16, v144
    v_and_b32 v243, 0xffff0000, v144
    v_pk_add_f32 v[0:1], v[0:1], v[242:243]
    v_lshlrev_b32 v242, 16, v145
    v_and_b32 v243, 0xffff0000, v145
    v_pk_add_f32 v[2:3], v[2:3], v[242:243]
    v_lshlrev_b32 v242, 16, v146
    v_and_b32 v243, 0xffff0000, v146
    v_pk_add_f32 v[4:5], v[4:5], v[242:243]
    v_lshlrev_b32 v242, 16, v147
    v_and_b32 v243, 0xffff0000, v147
    v_pk_add_f32 v[6:7], v[6:7], v[242:243]
    v_lshlrev_b32 v242, 16, v148
    v_and_b32 v243, 0xffff0000, v148
    v_pk_add_f32 v[8:9], v[8:9], v[242:243]
    v_lshlrev_b32 v242, 16, v149
    v_and_b32 v243, 0xffff0000, v149
    v_pk_add_f32 v[10:11], v[10:11], v[242:243]
    v_lshlrev_b32 v242, 16, v150
    v_and_b32 v243, 0xffff0000, v150
    v_pk_add_f32 v[12:13], v[12:13], v[242:243]
    v_lshlrev_b32 v242, 16, v151
    v_and_b32 v243, 0xffff0000, v151
    v_pk_add_f32 v[14:15], v[14:15], v[242:243]
    v_lshlrev_b32 v242, 16, v152
    v_and_b32 v243, 0xffff0000, v152
    v_pk_add_f32 v[16:17], v[16:17], v[242:243]
    v_lshlrev_b32 v242, 16, v153
    v_and_b32 v243, 0xffff0000, v153
    v_pk_add_f32 v[18:19], v[18:19], v[242:243]
    v_lshlrev_b32 v242, 16, v154
    v_and_b32 v243, 0xffff0000, v154
    v_pk_add_f32 v[20:21], v[20:21], v[242:243]
    v_lshlrev_b32 v242, 16, v155
    v_and_b32 v243, 0xffff0000, v155
    v_pk_add_f32 v[22:23], v[22:23], v[242:243]
    v_lshlrev_b32 v242, 16, v156
    v_and_b32 v243, 0xffff0000, v156
    v_pk_add_f32 v[24:25], v[24:25], v[242:243]
    v_lshlrev_b32 v242, 16, v157
    v_and_b32 v243, 0xffff0000, v157
    v_pk_add_f32 v[26:27], v[26:27], v[242:243]
    v_lshlrev_b32 v242, 16, v158
    v_and_b32 v243, 0xffff0000, v158
    v_pk_add_f32 v[28:29], v[28:29], v[242:243]
    v_lshlrev_b32 v242, 16, v159
    v_and_b32 v243, 0xffff0000, v159
    v_pk_add_f32 v[30:31], v[30:31], v[242:243]
    v_cvt_pk_bf16_f32 v128, v0, v1
    v_cvt_pk_bf16_f32 v129, v2, v3
    v_cvt_pk_bf16_f32 v130, v4, v5
    v_cvt_pk_bf16_f32 v131, v6, v7
    v_cvt_pk_bf16_f32 v132, v8, v9
    v_cvt_pk_bf16_f32 v133, v10, v11
    v_cvt_pk_bf16_f32 v134, v12, v13
    v_cvt_pk_bf16_f32 v135, v14, v15
    v_cvt_pk_bf16_f32 v136, v16, v17
    v_cvt_pk_bf16_f32 v137, v18, v19
    v_cvt_pk_bf16_f32 v138, v20, v21
    v_cvt_pk_bf16_f32 v139, v22, v23
    v_cvt_pk_bf16_f32 v140, v24, v25
    v_cvt_pk_bf16_f32 v141, v26, v27
    v_cvt_pk_bf16_f32 v142, v28, v29
    v_cvt_pk_bf16_f32 v143, v30, v31
    buffer_store_dwordx4 v[128:131], v181, s[44:47], 0 offen offset:0
    buffer_store_dwordx4 v[132:135], v181, s[44:47], 0 offen offset:32
    buffer_store_dwordx4 v[136:139], v182, s[44:47], 0 offen offset:0
    buffer_store_dwordx4 v[140:143], v182, s[44:47], 0 offen offset:32
    s_endpgm
.section .rodata,"a"
.p2align 6
.amdhsa_kernel qkv_kernel
  .amdhsa_next_free_vgpr 168
  .amdhsa_next_free_sgpr 56
  .amdhsa_accum_offset 168
  .amdhsa_group_segment_fixed_size 0
  .amdhsa_kernarg_size 80
  .amdhsa_user_sgpr_count 2
  .amdhsa_user_sgpr_kernarg_segment_ptr 1
  .amdhsa_system_sgpr_workgroup_id_x 1
.end_amdhsa_kernel
.p2align 6
.amdhsa_kernel attn_kernel
  .amdhsa_next_free_vgpr 192
  .amdhsa_next_free_sgpr 56
  .amdhsa_accum_offset 192
  .amdhsa_group_segment_fixed_size 0
  .amdhsa_kernarg_size 80
  .amdhsa_user_sgpr_count 2
  .amdhsa_user_sgpr_kernarg_segment_ptr 1
  .amdhsa_system_sgpr_workgroup_id_x 1
.end_amdhsa_kernel
.p2align 6
.amdhsa_kernel mlp_kernel
  .amdhsa_next_free_vgpr 368
  .amdhsa_next_free_sgpr 60
  .amdhsa_accum_offset 256
  .amdhsa_group_segment_fixed_size 0
  .amdhsa_kernarg_size 80
  .amdhsa_user_sgpr_count 2
  .amdhsa_user_sgpr_kernarg_segment_ptr 1
  .amdhsa_system_sgpr_workgroup_id_x 1
.end_amdhsa_kernel
```
